```python
import torch

def _softmax(x, axis=-1):
    return torch.softmax(x, dim=axis)
def _gelu(x):
    return torch.nn.functional.gelu(x, approximate="tanh")
def _silu(x):
    return torch.nn.functional.silu(x)
def _sigmoid(x):
    return torch.sigmoid(x)
def _layernorm(x, axis=-1, eps=1e-5):
    m = x.mean(dim=axis, keepdim=True)
    v = x.var(dim=axis, keepdim=True, unbiased=False)
    return (x - m) / torch.sqrt(v + eps)
def _scatter_add(tgt, idx, src, axis=0):
    return tgt.clone().index_add_(axis, idx, src)
def _segment_sum(src, seg, n):
    out = torch.zeros((n,) + src.shape[1:], dtype=src.dtype)
    return out.index_add_(0, seg, src)
def _pad(x, pw):
    flat = tuple(v for pair in reversed(pw) for v in pair)
    return torch.nn.functional.pad(x, flat)

kernel_name = 'recurrent_scan__sliding_block_cached__dense_activation_relu__prompt'

def setup_inputs():

    _w = (lambda a: (lambda t: t.to(torch.bfloat16) if t.is_floating_point() else t)(torch.as_tensor(a)))
    def _A_setup():
        B, Sq, D = 1, 2048, 576
        Hq, Hkv, Sk, Dh = 32, 16, 2048, 128
        assert Hq % Hkv == 0, (Hq, Hkv)
        return {
            "x": _w((lambda *s: torch.randn(*s, dtype=torch.bfloat16) * 0.05)(B, Sq, D)),
            "k_cache": _w((lambda *s: torch.randn(*s, dtype=torch.bfloat16) * 0.8)(B, Hkv, Sk, Dh)),
            "v_cache": _w((lambda *s: torch.randn(*s, dtype=torch.bfloat16) * 0.2)(B, Hkv, Sk, Dh)),
            "wq": _w((lambda *s: torch.randn(*s, dtype=torch.bfloat16) * 0.8)(D, Hq * Dh) * (D ** -0.5)),
            "wo": _w((lambda *s: torch.randn(*s, dtype=torch.bfloat16) * 0.2)(Hq * Dh, D) * ((Hq * Dh) ** -0.5)),
        }
    _A_in = _A_setup()

    def _B_setup():
        B, S, D, Dff = 1, 2048, 576, 4608
        return {
            "x": _w((lambda *s: torch.randn(*s, dtype=torch.bfloat16) * 0.05)(B, S, D)),
            "w1": _w((lambda *s: torch.randn(*s, dtype=torch.bfloat16) * 0.1)(D, Dff)),
            "w2": _w((lambda *s: torch.randn(*s, dtype=torch.bfloat16) * 0.1)(Dff, D)),
        }
    _B_in = _B_setup()

    return {
        "A_x": _A_in["x"],
        "A_k_cache": _A_in["k_cache"],
        "A_v_cache": _A_in["v_cache"],
        "A_wq": _A_in["wq"],
        "A_wo": _A_in["wo"],
        "B_x": _B_in["x"],
        "B_w1": _B_in["w1"],
        "B_w2": _B_in["w2"],
    }

def reference(A_x, A_k_cache, A_v_cache, A_wq, A_wo, B_x, B_w1, B_w2):
    def _A_ref(x, k_cache, v_cache, wq, wo):
        B, Sq, D = x.shape
        Hq, Dh = 32, 128
        Hkv, Sk = k_cache.shape[1], k_cache.shape[2]
        W = min(4096, max(256, Sk // 4))
        rep = Hq // Hkv
        q = (lambda x, *d: x.permute(*d))((x @ wq).reshape(B, Sq, Hq, Dh), 0, 2, 1, 3)
        k = (lambda x, n, axis: torch.repeat_interleave(x, n, dim=axis))(k_cache[:, :, Sk - W:, :], rep, axis=1)
        v = (lambda x, n, axis: torch.repeat_interleave(x, n, dim=axis))(v_cache[:, :, Sk - W:, :], rep, axis=1)
        scores = torch.einsum("bhqd,bhkd->bhqk", q, k) * (Dh ** -0.5)
        p = _softmax(scores, axis=-1)
        o = torch.einsum("bhqk,bhkd->bhqd", p, v)
        return (lambda x, *d: x.permute(*d))(o, 0, 2, 1, 3).reshape(B, Sq, Hq * Dh) @ wo

    def _B_ref(x, w1, w2):
        h = torch.einsum("bsd,df->bsf", x, w1)
        zero = torch.zeros_like(h)
        h = torch.maximum(h, zero)
        return torch.einsum("bsf,fd->bsd", h, w2)

    x = A_x
    xn = _layernorm(x, axis=-1)
    s = _A_ref(xn, A_k_cache, A_v_cache, A_wq, A_wo)
    g = _silu(_B_ref(xn, B_w1, B_w2))
    return x + s * g
```

```asm
; @launch grid=(256,1,1) block=(256,1,1) lds=163840
.amdgcn_target "amdgcn-amd-amdhsa--gfx950"
.text
.globl recurrent_scan__sliding_block_cached__dense_activation_relu__prompt_kernel
.p2align 8
.type recurrent_scan__sliding_block_cached__dense_activation_relu__prompt_kernel,@function
recurrent_scan__sliding_block_cached__dense_activation_relu__prompt_kernel:
TEXT_start:
    s_cmp_ge_u32 s2, 256
    s_cbranch_scc0 MAIN_go
    s_endpgm
MAIN_go:
    s_load_dwordx2 s[88:89], s[0:1], 0
    s_load_dwordx2 s[40:41], s[0:1], 8
    s_load_dwordx2 s[42:43], s[0:1], 16
    s_load_dwordx2 s[44:45], s[0:1], 24
    s_load_dwordx2 s[46:47], s[0:1], 32
    s_load_dwordx2 s[48:49], s[0:1], 48
    s_load_dwordx2 s[50:51], s[0:1], 56
    s_load_dwordx2 s[52:53], s[0:1], 80
    s_load_dwordx2 s[90:91], s[0:1], 64
    s_load_dwordx2 s[92:93], s[0:1], 72
    v_lshrrev_b32 v1, 6, v0
    s_nop 0
    v_readfirstlane_b32 s26, v1
    s_bfe_u32 s30, s2, 0x20003
    s_and_b32 s34, s2, 2
    s_lshl_b32 s34, s34, 1
    s_add_u32 s30, s30, s34
    s_and_b32 s34, s2, 1
    s_lshl_b32 s34, s34, 3
    s_add_u32 s30, s30, s34
    s_lshr_b32 s29, s2, 5
    s_and_b32 s34, s2, 4
    s_lshl_b32 s34, s34, 1
    s_add_u32 s29, s29, s34
    s_mov_b32 s7, 0x00020000
    s_mov_b32 s11, 0x00020000
    s_mov_b32 s14, 80740352
    s_mov_b32 s15, 0x00020000
    s_and_b32 s27, s26, 1
    s_lshr_b32 s28, s26, 1
    v_and_b32 v0, 63, v0
    v_lshrrev_b32 v2, 2, v0
    v_mul_u32_u24 v2, 1152, v2
    v_lshrrev_b32 v1, 4, v0
    v_sub_u32 v1, 0, v1
    v_xor_b32 v1, v1, v0
    v_and_b32 v1, 3, v1
    v_lshl_add_u32 v10, v1, 4, v2
    s_lshl_b32 s34, s29, 7
    s_lshl_b32 s24, s26, 5
    s_add_u32 s34, s34, s24
    s_mul_i32 s68, s34, 1152
    s_add_u32 s69, s68, 18432
    s_mov_b32 s66, 2359296
    s_mov_b32 s67, 0x00020000
    s_getpc_b64 s[72:73]
PC_here:
    s_add_u32 s72, s72, TEXT_start-PC_here
    s_addc_u32 s73, s73, -1
    s_mov_b64 s[84:85], s[72:73]
    s_mov_b32 s74, TEXT_end-TEXT_start
    s_mov_b32 s75, 0x00020000
    s_lshr_b32 s71, s2, 3
    s_lshl_b32 s71, s71, 2
    s_add_u32 s71, s71, s26
    s_lshl_b32 s71, s71, 10
    v_lshrrev_b32 v3, 3, v0
    v_lshlrev_b32 v3, 7, v3
    buffer_load_dword v254, v3, s[72:75], s71 offen
    s_waitcnt lgkmcnt(0)
    s_mov_b64 s[64:65], s[88:89]
    s_mov_b64 s[12:13], s[52:53]
    buffer_load_dwordx4 v[44:47], v10, s[64:67], s68 offen offset:0
    buffer_load_dwordx4 v[48:51], v10, s[64:67], s68 offen offset:64
    buffer_load_dwordx4 v[52:55], v10, s[64:67], s68 offen offset:128
    buffer_load_dwordx4 v[56:59], v10, s[64:67], s68 offen offset:192
    buffer_load_dwordx4 v[60:63], v10, s[64:67], s68 offen offset:256
    buffer_load_dwordx4 v[64:67], v10, s[64:67], s68 offen offset:320
    buffer_load_dwordx4 v[68:71], v10, s[64:67], s68 offen offset:384
    buffer_load_dwordx4 v[72:75], v10, s[64:67], s68 offen offset:448
    buffer_load_dwordx4 v[76:79], v10, s[64:67], s68 offen offset:512
    buffer_load_dwordx4 v[80:83], v10, s[64:67], s68 offen offset:576
    buffer_load_dwordx4 v[84:87], v10, s[64:67], s68 offen offset:640
    buffer_load_dwordx4 v[88:91], v10, s[64:67], s68 offen offset:704
    buffer_load_dwordx4 v[92:95], v10, s[64:67], s68 offen offset:768
    buffer_load_dwordx4 v[96:99], v10, s[64:67], s68 offen offset:832
    buffer_load_dwordx4 v[100:103], v10, s[64:67], s68 offen offset:896
    buffer_load_dwordx4 v[104:107], v10, s[64:67], s68 offen offset:960
    buffer_load_dwordx4 v[108:111], v10, s[64:67], s68 offen offset:1024
    buffer_load_dwordx4 v[112:115], v10, s[64:67], s68 offen offset:1088
    v_lshlrev_b32 v9, 4, v0
    v_lshrrev_b32 v2, 4, v0
    v_sub_u32 v2, 0, v2
    v_and_b32 v2, 3, v2
    v_lshrrev_b32 v3, 2, v0
    v_lshlrev_b32 v3, 6, v3
    v_bfe_u32 v4, v0, 1, 1
    v_xor_b32 v4, v4, v2
    v_lshl_add_u32 v6, v4, 4, v3
    v_and_b32 v4, 1, v0
    v_lshl_add_u32 v6, v4, 3, v6
    v_and_b32 v4, 3, v0
    v_xor_b32 v4, v4, v2
    v_lshl_add_u32 v7, v4, 4, v3
    v_bfe_u32 v3, v0, 2, 2
    v_sub_u32 v3, 0, v3
    v_lshrrev_b32 v4, 4, v0
    v_xor_b32 v3, v3, v4
    v_and_b32 v3, 3, v3
    v_and_b32 v4, 15, v0
    v_lshlrev_b32 v4, 6, v4
    v_lshl_add_u32 v8, v3, 4, v4
    s_lshl_b32 m0, s26, 11
    s_mov_b32 s62, 1040356334
    s_lshl_b32 s35, s29, 12
    s_add_u32 s35, s35, 3145728
    s_and_b32 s34, s30, 7
    s_lshl_b32 s81, s34, 9
    s_add_u32 s81, s81, s35
    s_lshl_b32 s34, s34, 2
    s_add_u32 s35, s35, s34
    s_cmp_eq_u32 s26, 0
    s_cselect_b32 s38, 0xff, 0
    s_mov_b32 s39, 0
    s_and_b32 s54, s30, 7
    s_lshl_b32 s54, s54, 2
    s_lshr_b32 s63, s30, 3
    s_lshl_b32 s34, s63, 1
    s_add_u32 s54, s54, s34
    s_lshl_b32 s34, s63, 5
    s_add_u32 s35, s35, s34
    s_lshl_b32 s95, s26, 10
    s_add_u32 s95, s95, s81
    s_lshl_b32 s80, s29, 2
    s_cmp_eq_u32 s30, 0
    s_cselect_b32 s95, s95, 0x40000000
    s_cselect_b32 s80, s80, 0x40000000
    s_mov_b64 s[76:77], s[92:93]
    s_mov_b32 s78, 256
    s_mov_b32 s79, 0x00020000
    v_mov_b32 v12, 0
    v_mov_b32 v13, 0
    v_mov_b32 v14, 0
    v_mov_b32 v15, 0
    s_mul_i32 s99, s63, 0
    s_add_u32 s99, s99, 98304
    v_mov_b32 v11, 1
    buffer_store_dwordx4 v[12:15], v9, s[12:15], s95 offen sc1
    s_mov_b64 s[72:73], s[44:45]
    s_mov_b32 s74, 4718592
    s_and_b32 s71, s29, 7
    s_lshl_b32 s71, s71, 2
    s_add_u32 s71, s71, s26
    s_mul_i32 s71, s71, 147456
    s_lshl_b32 s34, s54, 8
    s_add_u32 s71, s71, s34
    v_lshrrev_b32 v3, 1, v0
    v_min_u32 v3, 17, v3
    v_lshlrev_b32 v3, 13, v3
    v_and_b32 v2, 1, v0
    v_lshl_add_u32 v3, v2, 8, v3
    s_mov_b32 s94, 0xffff0000
    s_lshl_b32 s34, s26, 10
    s_add_u32 s34, s34, 0x10000
    v_add_u32 v4, s34, v9
    v_add_u32 v5, 0x10000, v4
    s_lshl_b32 s34, s28, 11
    s_add_u32 s34, s34, 0x10000
    v_add_u32 v250, s34, v8
    v_xor_b32 v251, 1024, v250
    v_add_u32 v252, 0x10000, v250
    v_add_u32 v253, 0x10000, v251
    v_mov_b32 v240, 0x3f803f80
    s_waitcnt vmcnt(18)
    v_dot2_f32_bf16 v236, v44, v240, 0
    v_dot2_f32_bf16 v238, v44, v44, 0
    v_dot2_f32_bf16 v237, v45, v240, 0
    v_dot2_f32_bf16 v239, v45, v45, 0
    v_dot2_f32_bf16 v236, v46, v240, v236
    v_dot2_f32_bf16 v238, v46, v46, v238
    v_dot2_f32_bf16 v237, v47, v240, v237
    v_dot2_f32_bf16 v239, v47, v47, v239
    buffer_load_dwordx4 v[116:119], v10, s[64:67], s69 offen offset:0
    s_waitcnt vmcnt(18)
    v_dot2_f32_bf16 v236, v48, v240, v236
    v_dot2_f32_bf16 v238, v48, v48, v238
    v_dot2_f32_bf16 v237, v49, v240, v237
    v_dot2_f32_bf16 v239, v49, v49, v239
    v_dot2_f32_bf16 v236, v50, v240, v236
    v_dot2_f32_bf16 v238, v50, v50, v238
    v_dot2_f32_bf16 v237, v51, v240, v237
    v_dot2_f32_bf16 v239, v51, v51, v239
    buffer_load_dwordx4 v[120:123], v10, s[64:67], s69 offen offset:64
    s_waitcnt vmcnt(18)
    v_dot2_f32_bf16 v236, v52, v240, v236
    v_dot2_f32_bf16 v238, v52, v52, v238
    v_dot2_f32_bf16 v237, v53, v240, v237
    v_dot2_f32_bf16 v239, v53, v53, v239
    v_dot2_f32_bf16 v236, v54, v240, v236
    v_dot2_f32_bf16 v238, v54, v54, v238
    v_dot2_f32_bf16 v237, v55, v240, v237
    v_dot2_f32_bf16 v239, v55, v55, v239
    buffer_load_dwordx4 v[124:127], v10, s[64:67], s69 offen offset:128
    s_waitcnt vmcnt(18)
    v_dot2_f32_bf16 v236, v56, v240, v236
    v_dot2_f32_bf16 v238, v56, v56, v238
    v_dot2_f32_bf16 v237, v57, v240, v237
    v_dot2_f32_bf16 v239, v57, v57, v239
    v_dot2_f32_bf16 v236, v58, v240, v236
    v_dot2_f32_bf16 v238, v58, v58, v238
    v_dot2_f32_bf16 v237, v59, v240, v237
    v_dot2_f32_bf16 v239, v59, v59, v239
    buffer_load_dwordx4 v[128:131], v10, s[64:67], s69 offen offset:192
    s_waitcnt vmcnt(18)
    v_dot2_f32_bf16 v236, v60, v240, v236
    v_dot2_f32_bf16 v238, v60, v60, v238
    v_dot2_f32_bf16 v237, v61, v240, v237
    v_dot2_f32_bf16 v239, v61, v61, v239
    v_dot2_f32_bf16 v236, v62, v240, v236
    v_dot2_f32_bf16 v238, v62, v62, v238
    v_dot2_f32_bf16 v237, v63, v240, v237
    v_dot2_f32_bf16 v239, v63, v63, v239
    buffer_load_dwordx4 v[132:135], v10, s[64:67], s69 offen offset:256
    s_waitcnt vmcnt(18)
    v_dot2_f32_bf16 v236, v64, v240, v236
    v_dot2_f32_bf16 v238, v64, v64, v238
    v_dot2_f32_bf16 v237, v65, v240, v237
    v_dot2_f32_bf16 v239, v65, v65, v239
    v_dot2_f32_bf16 v236, v66, v240, v236
    v_dot2_f32_bf16 v238, v66, v66, v238
    v_dot2_f32_bf16 v237, v67, v240, v237
    v_dot2_f32_bf16 v239, v67, v67, v239
    buffer_load_dwordx4 v[136:139], v10, s[64:67], s69 offen offset:320
    s_waitcnt vmcnt(18)
    v_dot2_f32_bf16 v236, v68, v240, v236
    v_dot2_f32_bf16 v238, v68, v68, v238
    v_dot2_f32_bf16 v237, v69, v240, v237
    v_dot2_f32_bf16 v239, v69, v69, v239
    v_dot2_f32_bf16 v236, v70, v240, v236
    v_dot2_f32_bf16 v238, v70, v70, v238
    v_dot2_f32_bf16 v237, v71, v240, v237
    v_dot2_f32_bf16 v239, v71, v71, v239
    buffer_load_dwordx4 v[140:143], v10, s[64:67], s69 offen offset:384
    s_waitcnt vmcnt(18)
    v_dot2_f32_bf16 v236, v72, v240, v236
    v_dot2_f32_bf16 v238, v72, v72, v238
    v_dot2_f32_bf16 v237, v73, v240, v237
    v_dot2_f32_bf16 v239, v73, v73, v239
    v_dot2_f32_bf16 v236, v74, v240, v236
    v_dot2_f32_bf16 v238, v74, v74, v238
    v_dot2_f32_bf16 v237, v75, v240, v237
    v_dot2_f32_bf16 v239, v75, v75, v239
    buffer_load_dwordx4 v[144:147], v10, s[64:67], s69 offen offset:448
    s_waitcnt vmcnt(18)
    v_dot2_f32_bf16 v236, v76, v240, v236
    v_dot2_f32_bf16 v238, v76, v76, v238
    v_dot2_f32_bf16 v237, v77, v240, v237
    v_dot2_f32_bf16 v239, v77, v77, v239
    v_dot2_f32_bf16 v236, v78, v240, v236
    v_dot2_f32_bf16 v238, v78, v78, v238
    v_dot2_f32_bf16 v237, v79, v240, v237
    v_dot2_f32_bf16 v239, v79, v79, v239
    s_waitcnt vmcnt(17)
    v_dot2_f32_bf16 v236, v80, v240, v236
    v_dot2_f32_bf16 v238, v80, v80, v238
    v_dot2_f32_bf16 v237, v81, v240, v237
    v_dot2_f32_bf16 v239, v81, v81, v239
    v_dot2_f32_bf16 v236, v82, v240, v236
    v_dot2_f32_bf16 v238, v82, v82, v238
    v_dot2_f32_bf16 v237, v83, v240, v237
    v_dot2_f32_bf16 v239, v83, v83, v239
    s_waitcnt vmcnt(16)
    v_dot2_f32_bf16 v236, v84, v240, v236
    v_dot2_f32_bf16 v238, v84, v84, v238
    v_dot2_f32_bf16 v237, v85, v240, v237
    v_dot2_f32_bf16 v239, v85, v85, v239
    v_dot2_f32_bf16 v236, v86, v240, v236
    v_dot2_f32_bf16 v238, v86, v86, v238
    v_dot2_f32_bf16 v237, v87, v240, v237
    v_dot2_f32_bf16 v239, v87, v87, v239
    s_waitcnt vmcnt(15)
    v_dot2_f32_bf16 v236, v88, v240, v236
    v_dot2_f32_bf16 v238, v88, v88, v238
    v_dot2_f32_bf16 v237, v89, v240, v237
    v_dot2_f32_bf16 v239, v89, v89, v239
    v_dot2_f32_bf16 v236, v90, v240, v236
    v_dot2_f32_bf16 v238, v90, v90, v238
    v_dot2_f32_bf16 v237, v91, v240, v237
    v_dot2_f32_bf16 v239, v91, v91, v239
    s_waitcnt vmcnt(14)
    v_dot2_f32_bf16 v236, v92, v240, v236
    v_dot2_f32_bf16 v238, v92, v92, v238
    v_dot2_f32_bf16 v237, v93, v240, v237
    v_dot2_f32_bf16 v239, v93, v93, v239
    v_dot2_f32_bf16 v236, v94, v240, v236
    v_dot2_f32_bf16 v238, v94, v94, v238
    v_dot2_f32_bf16 v237, v95, v240, v237
    v_dot2_f32_bf16 v239, v95, v95, v239
    s_waitcnt vmcnt(13)
    v_dot2_f32_bf16 v236, v96, v240, v236
    v_dot2_f32_bf16 v238, v96, v96, v238
    v_dot2_f32_bf16 v237, v97, v240, v237
    v_dot2_f32_bf16 v239, v97, v97, v239
    v_dot2_f32_bf16 v236, v98, v240, v236
    v_dot2_f32_bf16 v238, v98, v98, v238
    v_dot2_f32_bf16 v237, v99, v240, v237
    v_dot2_f32_bf16 v239, v99, v99, v239
    s_waitcnt vmcnt(12)
    v_dot2_f32_bf16 v236, v100, v240, v236
    v_dot2_f32_bf16 v238, v100, v100, v238
    v_dot2_f32_bf16 v237, v101, v240, v237
    v_dot2_f32_bf16 v239, v101, v101, v239
    v_dot2_f32_bf16 v236, v102, v240, v236
    v_dot2_f32_bf16 v238, v102, v102, v238
    v_dot2_f32_bf16 v237, v103, v240, v237
    v_dot2_f32_bf16 v239, v103, v103, v239
    s_waitcnt vmcnt(11)
    v_dot2_f32_bf16 v236, v104, v240, v236
    v_dot2_f32_bf16 v238, v104, v104, v238
    v_dot2_f32_bf16 v237, v105, v240, v237
    v_dot2_f32_bf16 v239, v105, v105, v239
    v_dot2_f32_bf16 v236, v106, v240, v236
    v_dot2_f32_bf16 v238, v106, v106, v238
    v_dot2_f32_bf16 v237, v107, v240, v237
    v_dot2_f32_bf16 v239, v107, v107, v239
    s_waitcnt vmcnt(10)
    v_dot2_f32_bf16 v236, v108, v240, v236
    v_dot2_f32_bf16 v238, v108, v108, v238
    v_dot2_f32_bf16 v237, v109, v240, v237
    v_dot2_f32_bf16 v239, v109, v109, v239
    v_dot2_f32_bf16 v236, v110, v240, v236
    v_dot2_f32_bf16 v238, v110, v110, v238
    v_dot2_f32_bf16 v237, v111, v240, v237
    v_dot2_f32_bf16 v239, v111, v111, v239
    s_waitcnt vmcnt(9)
    v_dot2_f32_bf16 v236, v112, v240, v236
    v_dot2_f32_bf16 v238, v112, v112, v238
    v_dot2_f32_bf16 v237, v113, v240, v237
    v_dot2_f32_bf16 v239, v113, v113, v239
    v_dot2_f32_bf16 v236, v114, v240, v236
    v_dot2_f32_bf16 v238, v114, v114, v238
    v_dot2_f32_bf16 v237, v115, v240, v237
    v_dot2_f32_bf16 v239, v115, v115, v239
    s_nop 1
    v_add_f32 v236, v236, v237
    v_add_f32 v238, v238, v239
    s_nop 0
    v_add_f32_dpp v236, v236, v236 quad_perm:[1,0,3,2] row_mask:0xf bank_mask:0xf
    v_add_f32_dpp v238, v238, v238 quad_perm:[1,0,3,2] row_mask:0xf bank_mask:0xf
    s_nop 0
    v_add_f32_dpp v236, v236, v236 quad_perm:[2,3,0,1] row_mask:0xf bank_mask:0xf
    v_add_f32_dpp v238, v238, v238 quad_perm:[2,3,0,1] row_mask:0xf bank_mask:0xf
    v_mul_f32 v236, 0.001736111111111111, v236
    v_mul_f32 v238, 0.001736111111111111, v238
    v_fma_f32 v238, -v236, v236, v238
    v_max_f32 v238, 0, v238
    v_cvt_pk_bf16_f32 v238, v238, v236
    v_and_b32 v236, s94, v238
    v_lshlrev_b32 v238, 16, v238
    v_add_f32 v238, 0x3727c5ac, v238
    v_cvt_pk_bf16_f32 v238, v238, v238
    v_lshlrev_b32 v238, 16, v238
    v_sqrt_f32 v238, v238
    s_nop 0
    v_cvt_pk_bf16_f32 v238, v238, v238
    v_lshlrev_b32 v238, 16, v238
    v_rcp_f32 v242, v238
    s_nop 0
    v_mul_f32 v242, s62, v242
    v_mul_f32 v244, v236, v242
    v_sub_f32 v244, 0, v244
    v_mov_b32 v243, v242
    v_mov_b32 v245, v244
    v_lshlrev_b32 v236, 16, v44
    v_and_b32 v237, s94, v44
    v_pk_fma_f32 v[236:237], v[236:237], v[242:243], v[244:245]
    v_cvt_pk_bf16_f32 v44, v236, v237
    v_lshlrev_b32 v238, 16, v45
    v_and_b32 v239, s94, v45
    v_pk_fma_f32 v[238:239], v[238:239], v[242:243], v[244:245]
    v_cvt_pk_bf16_f32 v45, v238, v239
    v_lshlrev_b32 v236, 16, v46
    v_and_b32 v237, s94, v46
    v_pk_fma_f32 v[236:237], v[236:237], v[242:243], v[244:245]
    v_cvt_pk_bf16_f32 v46, v236, v237
    v_lshlrev_b32 v238, 16, v47
    v_and_b32 v239, s94, v47
    v_pk_fma_f32 v[238:239], v[238:239], v[242:243], v[244:245]
    v_cvt_pk_bf16_f32 v47, v238, v239
    ds_write_b128 v4, v[44:47] offset:0
    buffer_load_dwordx4 v[148:151], v10, s[64:67], s69 offen offset:512
    buffer_load_dwordx4 v[152:155], v10, s[64:67], s69 offen offset:576
    v_lshlrev_b32 v236, 16, v48
    v_and_b32 v237, s94, v48
    v_pk_fma_f32 v[236:237], v[236:237], v[242:243], v[244:245]
    v_cvt_pk_bf16_f32 v48, v236, v237
    v_lshlrev_b32 v238, 16, v49
    v_and_b32 v239, s94, v49
    v_pk_fma_f32 v[238:239], v[238:239], v[242:243], v[244:245]
    v_cvt_pk_bf16_f32 v49, v238, v239
    v_lshlrev_b32 v236, 16, v50
    v_and_b32 v237, s94, v50
    v_pk_fma_f32 v[236:237], v[236:237], v[242:243], v[244:245]
    v_cvt_pk_bf16_f32 v50, v236, v237
    v_lshlrev_b32 v238, 16, v51
    v_and_b32 v239, s94, v51
    v_pk_fma_f32 v[238:239], v[238:239], v[242:243], v[244:245]
    v_cvt_pk_bf16_f32 v51, v238, v239
    ds_write_b128 v4, v[48:51] offset:4096
    buffer_load_dwordx4 v[156:159], v10, s[64:67], s69 offen offset:640
    buffer_load_dwordx4 v[160:163], v10, s[64:67], s69 offen offset:704
    v_lshlrev_b32 v236, 16, v52
    v_and_b32 v237, s94, v52
    v_pk_fma_f32 v[236:237], v[236:237], v[242:243], v[244:245]
    v_cvt_pk_bf16_f32 v52, v236, v237
    v_lshlrev_b32 v238, 16, v53
    v_and_b32 v239, s94, v53
    v_pk_fma_f32 v[238:239], v[238:239], v[242:243], v[244:245]
    v_cvt_pk_bf16_f32 v53, v238, v239
    v_lshlrev_b32 v236, 16, v54
    v_and_b32 v237, s94, v54
    v_pk_fma_f32 v[236:237], v[236:237], v[242:243], v[244:245]
    v_cvt_pk_bf16_f32 v54, v236, v237
    v_lshlrev_b32 v238, 16, v55
    v_and_b32 v239, s94, v55
    v_pk_fma_f32 v[238:239], v[238:239], v[242:243], v[244:245]
    v_cvt_pk_bf16_f32 v55, v238, v239
    ds_write_b128 v4, v[52:55] offset:8192
    buffer_load_dwordx4 v[164:167], v10, s[64:67], s69 offen offset:768
    buffer_load_dwordx4 v[168:171], v10, s[64:67], s69 offen offset:832
    v_lshlrev_b32 v236, 16, v56
    v_and_b32 v237, s94, v56
    v_pk_fma_f32 v[236:237], v[236:237], v[242:243], v[244:245]
    v_cvt_pk_bf16_f32 v56, v236, v237
    v_lshlrev_b32 v238, 16, v57
    v_and_b32 v239, s94, v57
    v_pk_fma_f32 v[238:239], v[238:239], v[242:243], v[244:245]
    v_cvt_pk_bf16_f32 v57, v238, v239
    v_lshlrev_b32 v236, 16, v58
    v_and_b32 v237, s94, v58
    v_pk_fma_f32 v[236:237], v[236:237], v[242:243], v[244:245]
    v_cvt_pk_bf16_f32 v58, v236, v237
    v_lshlrev_b32 v238, 16, v59
    v_and_b32 v239, s94, v59
    v_pk_fma_f32 v[238:239], v[238:239], v[242:243], v[244:245]
    v_cvt_pk_bf16_f32 v59, v238, v239
    ds_write_b128 v4, v[56:59] offset:12288
    buffer_load_dwordx4 v[172:175], v10, s[64:67], s69 offen offset:896
    buffer_load_dwordx4 v[176:179], v10, s[64:67], s69 offen offset:960
    v_lshlrev_b32 v236, 16, v60
    v_and_b32 v237, s94, v60
    v_pk_fma_f32 v[236:237], v[236:237], v[242:243], v[244:245]
    v_cvt_pk_bf16_f32 v60, v236, v237
    v_lshlrev_b32 v238, 16, v61
    v_and_b32 v239, s94, v61
    v_pk_fma_f32 v[238:239], v[238:239], v[242:243], v[244:245]
    v_cvt_pk_bf16_f32 v61, v238, v239
    v_lshlrev_b32 v236, 16, v62
    v_and_b32 v237, s94, v62
    v_pk_fma_f32 v[236:237], v[236:237], v[242:243], v[244:245]
    v_cvt_pk_bf16_f32 v62, v236, v237
    v_lshlrev_b32 v238, 16, v63
    v_and_b32 v239, s94, v63
    v_pk_fma_f32 v[238:239], v[238:239], v[242:243], v[244:245]
    v_cvt_pk_bf16_f32 v63, v238, v239
    ds_write_b128 v4, v[60:63] offset:16384
    buffer_load_dwordx4 v[180:183], v10, s[64:67], s69 offen offset:1024
    buffer_load_dwordx4 v[184:187], v10, s[64:67], s69 offen offset:1088
    v_lshlrev_b32 v236, 16, v64
    v_and_b32 v237, s94, v64
    v_pk_fma_f32 v[236:237], v[236:237], v[242:243], v[244:245]
    v_cvt_pk_bf16_f32 v64, v236, v237
    v_lshlrev_b32 v238, 16, v65
    v_and_b32 v239, s94, v65
    v_pk_fma_f32 v[238:239], v[238:239], v[242:243], v[244:245]
    v_cvt_pk_bf16_f32 v65, v238, v239
    v_lshlrev_b32 v236, 16, v66
    v_and_b32 v237, s94, v66
    v_pk_fma_f32 v[236:237], v[236:237], v[242:243], v[244:245]
    v_cvt_pk_bf16_f32 v66, v236, v237
    v_lshlrev_b32 v238, 16, v67
    v_and_b32 v239, s94, v67
    v_pk_fma_f32 v[238:239], v[238:239], v[242:243], v[244:245]
    v_cvt_pk_bf16_f32 v67, v238, v239
    ds_write_b128 v4, v[64:67] offset:20480
    buffer_load_dword v254, v3, s[72:75], s71 offen offset:0
    v_lshlrev_b32 v236, 16, v68
    v_and_b32 v237, s94, v68
    v_pk_fma_f32 v[236:237], v[236:237], v[242:243], v[244:245]
    v_cvt_pk_bf16_f32 v68, v236, v237
    v_lshlrev_b32 v238, 16, v69
    v_and_b32 v239, s94, v69
    v_pk_fma_f32 v[238:239], v[238:239], v[242:243], v[244:245]
    v_cvt_pk_bf16_f32 v69, v238, v239
    v_lshlrev_b32 v236, 16, v70
    v_and_b32 v237, s94, v70
    v_pk_fma_f32 v[236:237], v[236:237], v[242:243], v[244:245]
    v_cvt_pk_bf16_f32 v70, v236, v237
    v_lshlrev_b32 v238, 16, v71
    v_and_b32 v239, s94, v71
    v_pk_fma_f32 v[238:239], v[238:239], v[242:243], v[244:245]
    v_cvt_pk_bf16_f32 v71, v238, v239
    ds_write_b128 v4, v[68:71] offset:24576
    v_lshlrev_b32 v236, 16, v72
    v_and_b32 v237, s94, v72
    v_pk_fma_f32 v[236:237], v[236:237], v[242:243], v[244:245]
    v_cvt_pk_bf16_f32 v72, v236, v237
    v_lshlrev_b32 v238, 16, v73
    v_and_b32 v239, s94, v73
    v_pk_fma_f32 v[238:239], v[238:239], v[242:243], v[244:245]
    v_cvt_pk_bf16_f32 v73, v238, v239
    v_lshlrev_b32 v236, 16, v74
    v_and_b32 v237, s94, v74
    v_pk_fma_f32 v[236:237], v[236:237], v[242:243], v[244:245]
    v_cvt_pk_bf16_f32 v74, v236, v237
    v_lshlrev_b32 v238, 16, v75
    v_and_b32 v239, s94, v75
    v_pk_fma_f32 v[238:239], v[238:239], v[242:243], v[244:245]
    v_cvt_pk_bf16_f32 v75, v238, v239
    ds_write_b128 v4, v[72:75] offset:28672
    v_lshlrev_b32 v236, 16, v76
    v_and_b32 v237, s94, v76
    v_pk_fma_f32 v[236:237], v[236:237], v[242:243], v[244:245]
    v_cvt_pk_bf16_f32 v76, v236, v237
    v_lshlrev_b32 v238, 16, v77
    v_and_b32 v239, s94, v77
    v_pk_fma_f32 v[238:239], v[238:239], v[242:243], v[244:245]
    v_cvt_pk_bf16_f32 v77, v238, v239
    v_lshlrev_b32 v236, 16, v78
    v_and_b32 v237, s94, v78
    v_pk_fma_f32 v[236:237], v[236:237], v[242:243], v[244:245]
    v_cvt_pk_bf16_f32 v78, v236, v237
    v_lshlrev_b32 v238, 16, v79
    v_and_b32 v239, s94, v79
    v_pk_fma_f32 v[238:239], v[238:239], v[242:243], v[244:245]
    v_cvt_pk_bf16_f32 v79, v238, v239
    ds_write_b128 v4, v[76:79] offset:32768
    v_lshlrev_b32 v236, 16, v80
    v_and_b32 v237, s94, v80
    v_pk_fma_f32 v[236:237], v[236:237], v[242:243], v[244:245]
    v_cvt_pk_bf16_f32 v80, v236, v237
    v_lshlrev_b32 v238, 16, v81
    v_and_b32 v239, s94, v81
    v_pk_fma_f32 v[238:239], v[238:239], v[242:243], v[244:245]
    v_cvt_pk_bf16_f32 v81, v238, v239
    v_lshlrev_b32 v236, 16, v82
    v_and_b32 v237, s94, v82
    v_pk_fma_f32 v[236:237], v[236:237], v[242:243], v[244:245]
    v_cvt_pk_bf16_f32 v82, v236, v237
    v_lshlrev_b32 v238, 16, v83
    v_and_b32 v239, s94, v83
    v_pk_fma_f32 v[238:239], v[238:239], v[242:243], v[244:245]
    v_cvt_pk_bf16_f32 v83, v238, v239
    ds_write_b128 v4, v[80:83] offset:36864
    v_lshlrev_b32 v236, 16, v84
    v_and_b32 v237, s94, v84
    v_pk_fma_f32 v[236:237], v[236:237], v[242:243], v[244:245]
    v_cvt_pk_bf16_f32 v84, v236, v237
    v_lshlrev_b32 v238, 16, v85
    v_and_b32 v239, s94, v85
    v_pk_fma_f32 v[238:239], v[238:239], v[242:243], v[244:245]
    v_cvt_pk_bf16_f32 v85, v238, v239
    v_lshlrev_b32 v236, 16, v86
    v_and_b32 v237, s94, v86
    v_pk_fma_f32 v[236:237], v[236:237], v[242:243], v[244:245]
    v_cvt_pk_bf16_f32 v86, v236, v237
    v_lshlrev_b32 v238, 16, v87
    v_and_b32 v239, s94, v87
    v_pk_fma_f32 v[238:239], v[238:239], v[242:243], v[244:245]
    v_cvt_pk_bf16_f32 v87, v238, v239
    ds_write_b128 v4, v[84:87] offset:40960
    v_lshlrev_b32 v236, 16, v88
    v_and_b32 v237, s94, v88
    v_pk_fma_f32 v[236:237], v[236:237], v[242:243], v[244:245]
    v_cvt_pk_bf16_f32 v88, v236, v237
    v_lshlrev_b32 v238, 16, v89
    v_and_b32 v239, s94, v89
    v_pk_fma_f32 v[238:239], v[238:239], v[242:243], v[244:245]
    v_cvt_pk_bf16_f32 v89, v238, v239
    v_lshlrev_b32 v236, 16, v90
    v_and_b32 v237, s94, v90
    v_pk_fma_f32 v[236:237], v[236:237], v[242:243], v[244:245]
    v_cvt_pk_bf16_f32 v90, v236, v237
    v_lshlrev_b32 v238, 16, v91
    v_and_b32 v239, s94, v91
    v_pk_fma_f32 v[238:239], v[238:239], v[242:243], v[244:245]
    v_cvt_pk_bf16_f32 v91, v238, v239
    ds_write_b128 v4, v[88:91] offset:45056
    v_lshlrev_b32 v236, 16, v92
    v_and_b32 v237, s94, v92
    v_pk_fma_f32 v[236:237], v[236:237], v[242:243], v[244:245]
    v_cvt_pk_bf16_f32 v92, v236, v237
    v_lshlrev_b32 v238, 16, v93
    v_and_b32 v239, s94, v93
    v_pk_fma_f32 v[238:239], v[238:239], v[242:243], v[244:245]
    v_cvt_pk_bf16_f32 v93, v238, v239
    v_lshlrev_b32 v236, 16, v94
    v_and_b32 v237, s94, v94
    v_pk_fma_f32 v[236:237], v[236:237], v[242:243], v[244:245]
    v_cvt_pk_bf16_f32 v94, v236, v237
    v_lshlrev_b32 v238, 16, v95
    v_and_b32 v239, s94, v95
    v_pk_fma_f32 v[238:239], v[238:239], v[242:243], v[244:245]
    v_cvt_pk_bf16_f32 v95, v238, v239
    ds_write_b128 v4, v[92:95] offset:49152
    v_lshlrev_b32 v236, 16, v96
    v_and_b32 v237, s94, v96
    v_pk_fma_f32 v[236:237], v[236:237], v[242:243], v[244:245]
    v_cvt_pk_bf16_f32 v96, v236, v237
    v_lshlrev_b32 v238, 16, v97
    v_and_b32 v239, s94, v97
    v_pk_fma_f32 v[238:239], v[238:239], v[242:243], v[244:245]
    v_cvt_pk_bf16_f32 v97, v238, v239
    v_lshlrev_b32 v236, 16, v98
    v_and_b32 v237, s94, v98
    v_pk_fma_f32 v[236:237], v[236:237], v[242:243], v[244:245]
    v_cvt_pk_bf16_f32 v98, v236, v237
    v_lshlrev_b32 v238, 16, v99
    v_and_b32 v239, s94, v99
    v_pk_fma_f32 v[238:239], v[238:239], v[242:243], v[244:245]
    v_cvt_pk_bf16_f32 v99, v238, v239
    ds_write_b128 v4, v[96:99] offset:53248
    v_lshlrev_b32 v236, 16, v100
    v_and_b32 v237, s94, v100
    v_pk_fma_f32 v[236:237], v[236:237], v[242:243], v[244:245]
    v_cvt_pk_bf16_f32 v100, v236, v237
    v_lshlrev_b32 v238, 16, v101
    v_and_b32 v239, s94, v101
    v_pk_fma_f32 v[238:239], v[238:239], v[242:243], v[244:245]
    v_cvt_pk_bf16_f32 v101, v238, v239
    v_lshlrev_b32 v236, 16, v102
    v_and_b32 v237, s94, v102
    v_pk_fma_f32 v[236:237], v[236:237], v[242:243], v[244:245]
    v_cvt_pk_bf16_f32 v102, v236, v237
    v_lshlrev_b32 v238, 16, v103
    v_and_b32 v239, s94, v103
    v_pk_fma_f32 v[238:239], v[238:239], v[242:243], v[244:245]
    v_cvt_pk_bf16_f32 v103, v238, v239
    ds_write_b128 v4, v[100:103] offset:57344
    v_lshlrev_b32 v236, 16, v104
    v_and_b32 v237, s94, v104
    v_pk_fma_f32 v[236:237], v[236:237], v[242:243], v[244:245]
    v_cvt_pk_bf16_f32 v104, v236, v237
    v_lshlrev_b32 v238, 16, v105
    v_and_b32 v239, s94, v105
    v_pk_fma_f32 v[238:239], v[238:239], v[242:243], v[244:245]
    v_cvt_pk_bf16_f32 v105, v238, v239
    v_lshlrev_b32 v236, 16, v106
    v_and_b32 v237, s94, v106
    v_pk_fma_f32 v[236:237], v[236:237], v[242:243], v[244:245]
    v_cvt_pk_bf16_f32 v106, v236, v237
    v_lshlrev_b32 v238, 16, v107
    v_and_b32 v239, s94, v107
    v_pk_fma_f32 v[238:239], v[238:239], v[242:243], v[244:245]
    v_cvt_pk_bf16_f32 v107, v238, v239
    ds_write_b128 v4, v[104:107] offset:61440
    v_lshlrev_b32 v236, 16, v108
    v_and_b32 v237, s94, v108
    v_pk_fma_f32 v[236:237], v[236:237], v[242:243], v[244:245]
    v_cvt_pk_bf16_f32 v108, v236, v237
    v_lshlrev_b32 v238, 16, v109
    v_and_b32 v239, s94, v109
    v_pk_fma_f32 v[238:239], v[238:239], v[242:243], v[244:245]
    v_cvt_pk_bf16_f32 v109, v238, v239
    v_lshlrev_b32 v236, 16, v110
    v_and_b32 v237, s94, v110
    v_pk_fma_f32 v[236:237], v[236:237], v[242:243], v[244:245]
    v_cvt_pk_bf16_f32 v110, v236, v237
    v_lshlrev_b32 v238, 16, v111
    v_and_b32 v239, s94, v111
    v_pk_fma_f32 v[238:239], v[238:239], v[242:243], v[244:245]
    v_cvt_pk_bf16_f32 v111, v238, v239
    ds_write_b128 v5, v[108:111] offset:0
    v_lshlrev_b32 v236, 16, v112
    v_and_b32 v237, s94, v112
    v_pk_fma_f32 v[236:237], v[236:237], v[242:243], v[244:245]
    v_cvt_pk_bf16_f32 v112, v236, v237
    v_lshlrev_b32 v238, 16, v113
    v_and_b32 v239, s94, v113
    v_pk_fma_f32 v[238:239], v[238:239], v[242:243], v[244:245]
    v_cvt_pk_bf16_f32 v113, v238, v239
    v_lshlrev_b32 v236, 16, v114
    v_and_b32 v237, s94, v114
    v_pk_fma_f32 v[236:237], v[236:237], v[242:243], v[244:245]
    v_cvt_pk_bf16_f32 v114, v236, v237
    v_lshlrev_b32 v238, 16, v115
    v_and_b32 v239, s94, v115
    v_pk_fma_f32 v[238:239], v[238:239], v[242:243], v[244:245]
    v_cvt_pk_bf16_f32 v115, v238, v239
    ds_write_b128 v5, v[112:115] offset:4096
    s_waitcnt lgkmcnt(0)
    s_barrier
    v_mov_b32 v240, 0x3f803f80
    s_waitcnt vmcnt(18)
    v_dot2_f32_bf16 v236, v116, v240, 0
    v_dot2_f32_bf16 v238, v116, v116, 0
    v_dot2_f32_bf16 v237, v117, v240, 0
    ds_read_b128 a[0:3], v250 offset:0
    v_dot2_f32_bf16 v239, v117, v117, 0
    v_dot2_f32_bf16 v236, v118, v240, v236
    v_dot2_f32_bf16 v238, v118, v118, v238
    v_dot2_f32_bf16 v237, v119, v240, v237
    ds_read_b128 a[144:147], v251 offset:0
    v_dot2_f32_bf16 v239, v119, v119, v239
    s_waitcnt vmcnt(17)
    v_dot2_f32_bf16 v236, v120, v240, v236
    v_dot2_f32_bf16 v238, v120, v120, v238
    s_lshl_b32 s59, s28, 18
    s_lshl_b32 s60, s27, 15
    s_add_u32 s59, s59, s60
    s_lshl_b32 s60, s54, 8
    s_add_u32 s59, s59, s60
    s_add_u32 s4, s44, s59
    s_addc_u32 s5, s45, 0
    s_sub_u32 s6, 4718592, s59
    s_sub_u32 s8, s4, 768
    s_subb_u32 s9, s5, 0
    s_add_u32 s10, s6, 768
    s_mov_b32 s16, 0
    s_mov_b32 s17, 524288
    s_mov_b32 s18, 4290248768
    v_lshrrev_b32 v2, 4, v0
    v_bfe_u32 v1, v0, 2, 2
    v_lshl_add_u32 v2, v2, 3, v1
    v_mul_u32_u24 v2, 8192, v2
    v_and_or_b32 v1, v7, 48, v2
    buffer_load_dwordx4 v1, s[4:7], s16 offen lds
    buffer_load_dwordx4 v1, s[8:11], s16 offen offset:1024 lds
    s_add_u32 s19, m0, 8192
    s_sub_u32 s21, s19, s99
    s_min_u32 m0, s19, s21
    s_add_u32 s16, s16, s17
    s_add_u32 s20, s16, s18
    s_min_u32 s16, s16, s20
    v_dot2_f32_bf16 v237, v121, v240, v237
    ds_read_b128 a[4:7], v250 offset:4096
    v_dot2_f32_bf16 v239, v121, v121, v239
    v_dot2_f32_bf16 v236, v122, v240, v236
    v_dot2_f32_bf16 v238, v122, v122, v238
    v_dot2_f32_bf16 v237, v123, v240, v237
    ds_read_b128 a[148:151], v251 offset:4096
    v_dot2_f32_bf16 v239, v123, v123, v239
    s_waitcnt vmcnt(18)
    v_dot2_f32_bf16 v236, v124, v240, v236
    v_dot2_f32_bf16 v238, v124, v124, v238
    v_dot2_f32_bf16 v237, v125, v240, v237
    ds_read_b128 a[8:11], v250 offset:8192
    v_dot2_f32_bf16 v239, v125, v125, v239
    v_dot2_f32_bf16 v236, v126, v240, v236
    v_dot2_f32_bf16 v238, v126, v126, v238
    v_dot2_f32_bf16 v237, v127, v240, v237
    ds_read_b128 a[152:155], v251 offset:8192
    v_dot2_f32_bf16 v239, v127, v127, v239
    s_waitcnt vmcnt(17)
    v_dot2_f32_bf16 v236, v128, v240, v236
    v_dot2_f32_bf16 v238, v128, v128, v238
    v_dot2_f32_bf16 v237, v129, v240, v237
    ds_read_b128 a[12:15], v250 offset:12288
    v_dot2_f32_bf16 v239, v129, v129, v239
    v_dot2_f32_bf16 v236, v130, v240, v236
    v_dot2_f32_bf16 v238, v130, v130, v238
    buffer_load_dwordx4 v1, s[4:7], s16 offen lds
    buffer_load_dwordx4 v1, s[8:11], s16 offen offset:1024 lds
    s_add_u32 s19, m0, 8192
    s_sub_u32 s21, s19, s99
    s_min_u32 m0, s19, s21
    s_add_u32 s16, s16, s17
    s_add_u32 s20, s16, s18
    s_min_u32 s16, s16, s20
    v_dot2_f32_bf16 v237, v131, v240, v237
    ds_read_b128 a[156:159], v251 offset:12288
    v_dot2_f32_bf16 v239, v131, v131, v239
    s_waitcnt vmcnt(18)
    v_dot2_f32_bf16 v236, v132, v240, v236
    v_dot2_f32_bf16 v238, v132, v132, v238
    v_dot2_f32_bf16 v237, v133, v240, v237
    ds_read_b128 a[16:19], v250 offset:16384
    v_dot2_f32_bf16 v239, v133, v133, v239
    v_dot2_f32_bf16 v236, v134, v240, v236
    v_dot2_f32_bf16 v238, v134, v134, v238
    v_dot2_f32_bf16 v237, v135, v240, v237
    ds_read_b128 a[160:163], v251 offset:16384
    v_dot2_f32_bf16 v239, v135, v135, v239
    s_waitcnt vmcnt(17)
    v_dot2_f32_bf16 v236, v136, v240, v236
    v_dot2_f32_bf16 v238, v136, v136, v238
    v_dot2_f32_bf16 v237, v137, v240, v237
    ds_read_b128 a[20:23], v250 offset:20480
    v_dot2_f32_bf16 v239, v137, v137, v239
    v_dot2_f32_bf16 v236, v138, v240, v236
    v_dot2_f32_bf16 v238, v138, v138, v238
    v_dot2_f32_bf16 v237, v139, v240, v237
    ds_read_b128 a[164:167], v251 offset:20480
    v_dot2_f32_bf16 v239, v139, v139, v239
    s_waitcnt vmcnt(16)
    v_dot2_f32_bf16 v236, v140, v240, v236
    v_dot2_f32_bf16 v238, v140, v140, v238
    buffer_load_dwordx4 v1, s[4:7], s16 offen lds
    buffer_load_dwordx4 v1, s[8:11], s16 offen offset:1024 lds
    s_add_u32 s19, m0, 8192
    s_sub_u32 s21, s19, s99
    s_min_u32 m0, s19, s21
    s_add_u32 s16, s16, s17
    s_add_u32 s20, s16, s18
    s_min_u32 s16, s16, s20
    v_dot2_f32_bf16 v237, v141, v240, v237
    ds_read_b128 a[24:27], v250 offset:24576
    v_dot2_f32_bf16 v239, v141, v141, v239
    v_dot2_f32_bf16 v236, v142, v240, v236
    v_dot2_f32_bf16 v238, v142, v142, v238
    v_dot2_f32_bf16 v237, v143, v240, v237
    ds_read_b128 a[168:171], v251 offset:24576
    v_dot2_f32_bf16 v239, v143, v143, v239
    s_waitcnt vmcnt(17)
    v_dot2_f32_bf16 v236, v144, v240, v236
    v_dot2_f32_bf16 v238, v144, v144, v238
    v_dot2_f32_bf16 v237, v145, v240, v237
    ds_read_b128 a[28:31], v250 offset:28672
    v_dot2_f32_bf16 v239, v145, v145, v239
    v_dot2_f32_bf16 v236, v146, v240, v236
    v_dot2_f32_bf16 v238, v146, v146, v238
    v_dot2_f32_bf16 v237, v147, v240, v237
    ds_read_b128 a[172:175], v251 offset:28672
    v_dot2_f32_bf16 v239, v147, v147, v239
    s_waitcnt vmcnt(16)
    v_dot2_f32_bf16 v236, v148, v240, v236
    v_dot2_f32_bf16 v238, v148, v148, v238
    v_dot2_f32_bf16 v237, v149, v240, v237
    ds_read_b128 a[32:35], v250 offset:32768
    v_dot2_f32_bf16 v239, v149, v149, v239
    v_dot2_f32_bf16 v236, v150, v240, v236
    v_dot2_f32_bf16 v238, v150, v150, v238
    v_dot2_f32_bf16 v237, v151, v240, v237
    ds_read_b128 a[176:179], v251 offset:32768
    v_dot2_f32_bf16 v239, v151, v151, v239
    s_waitcnt vmcnt(15)
    v_dot2_f32_bf16 v236, v152, v240, v236
    v_dot2_f32_bf16 v238, v152, v152, v238
    v_dot2_f32_bf16 v237, v153, v240, v237
    ds_read_b128 a[36:39], v250 offset:36864
    v_dot2_f32_bf16 v239, v153, v153, v239
    v_dot2_f32_bf16 v236, v154, v240, v236
    v_dot2_f32_bf16 v238, v154, v154, v238
    v_dot2_f32_bf16 v237, v155, v240, v237
    ds_read_b128 a[180:183], v251 offset:36864
    v_dot2_f32_bf16 v239, v155, v155, v239
    s_waitcnt vmcnt(14)
    v_dot2_f32_bf16 v236, v156, v240, v236
    v_dot2_f32_bf16 v238, v156, v156, v238
    v_dot2_f32_bf16 v237, v157, v240, v237
    ds_read_b128 a[40:43], v250 offset:40960
    v_dot2_f32_bf16 v239, v157, v157, v239
    v_dot2_f32_bf16 v236, v158, v240, v236
    v_dot2_f32_bf16 v238, v158, v158, v238
    v_dot2_f32_bf16 v237, v159, v240, v237
    ds_read_b128 a[184:187], v251 offset:40960
    v_dot2_f32_bf16 v239, v159, v159, v239
    s_waitcnt vmcnt(13)
    v_dot2_f32_bf16 v236, v160, v240, v236
    v_dot2_f32_bf16 v238, v160, v160, v238
    v_dot2_f32_bf16 v237, v161, v240, v237
    ds_read_b128 a[44:47], v250 offset:45056
    v_dot2_f32_bf16 v239, v161, v161, v239
    v_dot2_f32_bf16 v236, v162, v240, v236
    v_dot2_f32_bf16 v238, v162, v162, v238
    v_dot2_f32_bf16 v237, v163, v240, v237
    ds_read_b128 a[188:191], v251 offset:45056
    v_dot2_f32_bf16 v239, v163, v163, v239
    s_waitcnt vmcnt(12)
    v_dot2_f32_bf16 v236, v164, v240, v236
    v_dot2_f32_bf16 v238, v164, v164, v238
    v_dot2_f32_bf16 v237, v165, v240, v237
    ds_read_b128 a[48:51], v250 offset:49152
    v_dot2_f32_bf16 v239, v165, v165, v239
    v_dot2_f32_bf16 v236, v166, v240, v236
    v_dot2_f32_bf16 v238, v166, v166, v238
    v_dot2_f32_bf16 v237, v167, v240, v237
    ds_read_b128 a[192:195], v251 offset:49152
    v_dot2_f32_bf16 v239, v167, v167, v239
    s_waitcnt vmcnt(11)
    v_dot2_f32_bf16 v236, v168, v240, v236
    v_dot2_f32_bf16 v238, v168, v168, v238
    v_dot2_f32_bf16 v237, v169, v240, v237
    ds_read_b128 a[52:55], v250 offset:53248
    v_dot2_f32_bf16 v239, v169, v169, v239
    v_dot2_f32_bf16 v236, v170, v240, v236
    v_dot2_f32_bf16 v238, v170, v170, v238
    v_dot2_f32_bf16 v237, v171, v240, v237
    ds_read_b128 a[196:199], v251 offset:53248
    v_dot2_f32_bf16 v239, v171, v171, v239
    s_waitcnt vmcnt(10)
    v_dot2_f32_bf16 v236, v172, v240, v236
    v_dot2_f32_bf16 v238, v172, v172, v238
    v_dot2_f32_bf16 v237, v173, v240, v237
    ds_read_b128 a[56:59], v250 offset:57344
    v_dot2_f32_bf16 v239, v173, v173, v239
    v_dot2_f32_bf16 v236, v174, v240, v236
    v_dot2_f32_bf16 v238, v174, v174, v238
    v_dot2_f32_bf16 v237, v175, v240, v237
    ds_read_b128 a[200:203], v251 offset:57344
    v_dot2_f32_bf16 v239, v175, v175, v239
    s_waitcnt vmcnt(9)
    v_dot2_f32_bf16 v236, v176, v240, v236
    v_dot2_f32_bf16 v238, v176, v176, v238
    v_dot2_f32_bf16 v237, v177, v240, v237
    ds_read_b128 a[60:63], v250 offset:61440
    v_dot2_f32_bf16 v239, v177, v177, v239
    v_dot2_f32_bf16 v236, v178, v240, v236
    v_dot2_f32_bf16 v238, v178, v178, v238
    v_dot2_f32_bf16 v237, v179, v240, v237
    ds_read_b128 a[204:207], v251 offset:61440
    v_dot2_f32_bf16 v239, v179, v179, v239
    s_waitcnt vmcnt(8)
    v_dot2_f32_bf16 v236, v180, v240, v236
    v_dot2_f32_bf16 v238, v180, v180, v238
    v_dot2_f32_bf16 v237, v181, v240, v237
    ds_read_b128 a[64:67], v252 offset:0
    v_dot2_f32_bf16 v239, v181, v181, v239
    v_dot2_f32_bf16 v236, v182, v240, v236
    v_dot2_f32_bf16 v238, v182, v182, v238
    v_dot2_f32_bf16 v237, v183, v240, v237
    ds_read_b128 a[208:211], v253 offset:0
    v_dot2_f32_bf16 v239, v183, v183, v239
    s_waitcnt vmcnt(7)
    v_dot2_f32_bf16 v236, v184, v240, v236
    v_dot2_f32_bf16 v238, v184, v184, v238
    v_dot2_f32_bf16 v237, v185, v240, v237
    ds_read_b128 a[68:71], v252 offset:4096
    v_dot2_f32_bf16 v239, v185, v185, v239
    v_dot2_f32_bf16 v236, v186, v240, v236
    v_dot2_f32_bf16 v238, v186, v186, v238
    v_dot2_f32_bf16 v237, v187, v240, v237
    ds_read_b128 a[212:215], v253 offset:4096
    v_dot2_f32_bf16 v239, v187, v187, v239
    s_nop 0
    v_add_f32 v236, v236, v237
    s_nop 0
    v_add_f32 v238, v238, v239
    v_add_f32_dpp v236, v236, v236 quad_perm:[1,0,3,2] row_mask:0xf bank_mask:0xf
    s_nop 0
    v_add_f32_dpp v238, v238, v238 quad_perm:[1,0,3,2] row_mask:0xf bank_mask:0xf
    v_add_f32_dpp v236, v236, v236 quad_perm:[2,3,0,1] row_mask:0xf bank_mask:0xf
    s_nop 0
    v_add_f32_dpp v238, v238, v238 quad_perm:[2,3,0,1] row_mask:0xf bank_mask:0xf
    v_mul_f32 v236, 0.001736111111111111, v236
    v_mul_f32 v238, 0.001736111111111111, v238
    v_fma_f32 v238, -v236, v236, v238
    v_max_f32 v238, 0, v238
    v_cvt_pk_bf16_f32 v238, v238, v236
    v_and_b32 v236, s94, v238
    v_lshlrev_b32 v238, 16, v238
    v_add_f32 v238, 0x3727c5ac, v238
    v_cvt_pk_bf16_f32 v238, v238, v238
    v_lshlrev_b32 v238, 16, v238
    v_sqrt_f32 v238, v238
    s_nop 0
    v_cvt_pk_bf16_f32 v238, v238, v238
    v_lshlrev_b32 v238, 16, v238
    v_rcp_f32 v246, v238
    s_nop 0
    v_mul_f32 v246, s62, v246
    v_mul_f32 v248, v236, v246
    v_sub_f32 v248, 0, v248
    v_mov_b32 v247, v246
    v_mov_b32 v249, v248
    v_lshlrev_b32 v236, 16, v116
    v_and_b32 v237, s94, v116
    v_pk_fma_f32 v[236:237], v[236:237], v[246:247], v[248:249]
    v_cvt_pk_bf16_f32 v116, v236, v237
    v_lshlrev_b32 v238, 16, v117
    v_and_b32 v239, s94, v117
    v_pk_fma_f32 v[238:239], v[238:239], v[246:247], v[248:249]
    v_cvt_pk_bf16_f32 v117, v238, v239
    v_lshlrev_b32 v236, 16, v118
    v_and_b32 v237, s94, v118
    v_pk_fma_f32 v[236:237], v[236:237], v[246:247], v[248:249]
    v_cvt_pk_bf16_f32 v118, v236, v237
    v_lshlrev_b32 v238, 16, v119
    v_and_b32 v239, s94, v119
    v_pk_fma_f32 v[238:239], v[238:239], v[246:247], v[248:249]
    v_cvt_pk_bf16_f32 v119, v238, v239
    ds_write_b128 v5, v[116:119] offset:8192
    buffer_load_dwordx4 v1, s[4:7], s16 offen lds
    buffer_load_dwordx4 v1, s[8:11], s16 offen offset:1024 lds
    s_add_u32 s19, m0, 8192
    s_sub_u32 s21, s19, s99
    s_min_u32 m0, s19, s21
    s_add_u32 s16, s16, s17
    s_add_u32 s20, s16, s18
    s_min_u32 s16, s16, s20
    v_lshlrev_b32 v236, 16, v120
    v_and_b32 v237, s94, v120
    v_pk_fma_f32 v[236:237], v[236:237], v[246:247], v[248:249]
    v_cvt_pk_bf16_f32 v120, v236, v237
    v_lshlrev_b32 v238, 16, v121
    v_and_b32 v239, s94, v121
    v_pk_fma_f32 v[238:239], v[238:239], v[246:247], v[248:249]
    v_cvt_pk_bf16_f32 v121, v238, v239
    v_lshlrev_b32 v236, 16, v122
    v_and_b32 v237, s94, v122
    v_pk_fma_f32 v[236:237], v[236:237], v[246:247], v[248:249]
    v_cvt_pk_bf16_f32 v122, v236, v237
    v_lshlrev_b32 v238, 16, v123
    v_and_b32 v239, s94, v123
    v_pk_fma_f32 v[238:239], v[238:239], v[246:247], v[248:249]
    v_cvt_pk_bf16_f32 v123, v238, v239
    ds_write_b128 v5, v[120:123] offset:12288
    buffer_load_dwordx4 v1, s[4:7], s16 offen lds
    buffer_load_dwordx4 v1, s[8:11], s16 offen offset:1024 lds
    s_add_u32 s19, m0, 8192
    s_sub_u32 s21, s19, s99
    s_min_u32 m0, s19, s21
    s_add_u32 s16, s16, s17
    s_add_u32 s20, s16, s18
    s_min_u32 s16, s16, s20
    v_lshlrev_b32 v236, 16, v124
    v_and_b32 v237, s94, v124
    v_pk_fma_f32 v[236:237], v[236:237], v[246:247], v[248:249]
    v_cvt_pk_bf16_f32 v124, v236, v237
    v_lshlrev_b32 v238, 16, v125
    v_and_b32 v239, s94, v125
    v_pk_fma_f32 v[238:239], v[238:239], v[246:247], v[248:249]
    v_cvt_pk_bf16_f32 v125, v238, v239
    v_lshlrev_b32 v236, 16, v126
    v_and_b32 v237, s94, v126
    v_pk_fma_f32 v[236:237], v[236:237], v[246:247], v[248:249]
    v_cvt_pk_bf16_f32 v126, v236, v237
    v_lshlrev_b32 v238, 16, v127
    v_and_b32 v239, s94, v127
    v_pk_fma_f32 v[238:239], v[238:239], v[246:247], v[248:249]
    v_cvt_pk_bf16_f32 v127, v238, v239
    ds_write_b128 v5, v[124:127] offset:16384
    buffer_load_dwordx4 v1, s[4:7], s16 offen lds
    buffer_load_dwordx4 v1, s[8:11], s16 offen offset:1024 lds
    s_add_u32 s19, m0, 8192
    s_sub_u32 s21, s19, s99
    s_min_u32 m0, s19, s21
    s_add_u32 s16, s16, s17
    s_add_u32 s20, s16, s18
    s_min_u32 s16, s16, s20
    v_lshlrev_b32 v236, 16, v128
    v_and_b32 v237, s94, v128
    v_pk_fma_f32 v[236:237], v[236:237], v[246:247], v[248:249]
    v_cvt_pk_bf16_f32 v128, v236, v237
    v_lshlrev_b32 v238, 16, v129
    v_and_b32 v239, s94, v129
    v_pk_fma_f32 v[238:239], v[238:239], v[246:247], v[248:249]
    v_cvt_pk_bf16_f32 v129, v238, v239
    v_lshlrev_b32 v236, 16, v130
    v_and_b32 v237, s94, v130
    v_pk_fma_f32 v[236:237], v[236:237], v[246:247], v[248:249]
    v_cvt_pk_bf16_f32 v130, v236, v237
    v_lshlrev_b32 v238, 16, v131
    v_and_b32 v239, s94, v131
    v_pk_fma_f32 v[238:239], v[238:239], v[246:247], v[248:249]
    v_cvt_pk_bf16_f32 v131, v238, v239
    ds_write_b128 v5, v[128:131] offset:20480
    buffer_load_dwordx4 v1, s[4:7], s16 offen lds
    buffer_load_dwordx4 v1, s[8:11], s16 offen offset:1024 lds
    s_add_u32 s19, m0, 8192
    s_sub_u32 s21, s19, s99
    s_min_u32 m0, s19, s21
    s_add_u32 s16, s16, s17
    s_add_u32 s20, s16, s18
    s_min_u32 s16, s16, s20
    v_lshlrev_b32 v236, 16, v132
    v_and_b32 v237, s94, v132
    v_pk_fma_f32 v[236:237], v[236:237], v[246:247], v[248:249]
    v_cvt_pk_bf16_f32 v132, v236, v237
    v_lshlrev_b32 v238, 16, v133
    v_and_b32 v239, s94, v133
    v_pk_fma_f32 v[238:239], v[238:239], v[246:247], v[248:249]
    v_cvt_pk_bf16_f32 v133, v238, v239
    v_lshlrev_b32 v236, 16, v134
    v_and_b32 v237, s94, v134
    v_pk_fma_f32 v[236:237], v[236:237], v[246:247], v[248:249]
    v_cvt_pk_bf16_f32 v134, v236, v237
    v_lshlrev_b32 v238, 16, v135
    v_and_b32 v239, s94, v135
    v_pk_fma_f32 v[238:239], v[238:239], v[246:247], v[248:249]
    v_cvt_pk_bf16_f32 v135, v238, v239
    ds_write_b128 v5, v[132:135] offset:24576
    buffer_load_dwordx4 v1, s[4:7], s16 offen lds
    buffer_load_dwordx4 v1, s[8:11], s16 offen offset:1024 lds
    s_add_u32 s19, m0, 8192
    s_sub_u32 s21, s19, s99
    s_min_u32 m0, s19, s21
    s_add_u32 s16, s16, s17
    s_add_u32 s20, s16, s18
    s_min_u32 s16, s16, s20
    v_lshlrev_b32 v236, 16, v136
    v_and_b32 v237, s94, v136
    v_pk_fma_f32 v[236:237], v[236:237], v[246:247], v[248:249]
    v_cvt_pk_bf16_f32 v136, v236, v237
    v_lshlrev_b32 v238, 16, v137
    v_and_b32 v239, s94, v137
    v_pk_fma_f32 v[238:239], v[238:239], v[246:247], v[248:249]
    v_cvt_pk_bf16_f32 v137, v238, v239
    v_lshlrev_b32 v236, 16, v138
    v_and_b32 v237, s94, v138
    v_pk_fma_f32 v[236:237], v[236:237], v[246:247], v[248:249]
    v_cvt_pk_bf16_f32 v138, v236, v237
    v_lshlrev_b32 v238, 16, v139
    v_and_b32 v239, s94, v139
    v_pk_fma_f32 v[238:239], v[238:239], v[246:247], v[248:249]
    v_cvt_pk_bf16_f32 v139, v238, v239
    ds_write_b128 v5, v[136:139] offset:28672
    s_waitcnt lgkmcnt(0)
    s_barrier
    s_mov_b64 exec, s[38:39]
    buffer_store_dword v11, off, s[76:79], s80 sc1
    s_mov_b64 exec, -1
    v_lshlrev_b32 v236, 16, v140
    v_and_b32 v237, s94, v140
    v_pk_fma_f32 v[236:237], v[236:237], v[246:247], v[248:249]
    v_cvt_pk_bf16_f32 v140, v236, v237
    v_lshlrev_b32 v238, 16, v141
    v_and_b32 v239, s94, v141
    v_pk_fma_f32 v[238:239], v[238:239], v[246:247], v[248:249]
    v_cvt_pk_bf16_f32 v141, v238, v239
    v_lshlrev_b32 v236, 16, v142
    v_and_b32 v237, s94, v142
    v_pk_fma_f32 v[236:237], v[236:237], v[246:247], v[248:249]
    v_cvt_pk_bf16_f32 v142, v236, v237
    v_lshlrev_b32 v238, 16, v143
    v_and_b32 v239, s94, v143
    v_pk_fma_f32 v[238:239], v[238:239], v[246:247], v[248:249]
    v_cvt_pk_bf16_f32 v143, v238, v239
    ds_write_b128 v4, v[140:143] offset:32768
    ds_read_b128 a[72:75], v252 offset:8192
    ds_read_b128 a[216:219], v253 offset:8192
    ds_read_b128 a[76:79], v252 offset:12288
    ds_read_b128 a[220:223], v253 offset:12288
    v_lshlrev_b32 v236, 16, v144
    v_and_b32 v237, s94, v144
    v_pk_fma_f32 v[236:237], v[236:237], v[246:247], v[248:249]
    v_cvt_pk_bf16_f32 v144, v236, v237
    v_lshlrev_b32 v238, 16, v145
    v_and_b32 v239, s94, v145
    v_pk_fma_f32 v[238:239], v[238:239], v[246:247], v[248:249]
    v_cvt_pk_bf16_f32 v145, v238, v239
    v_lshlrev_b32 v236, 16, v146
    v_and_b32 v237, s94, v146
    v_pk_fma_f32 v[236:237], v[236:237], v[246:247], v[248:249]
    v_cvt_pk_bf16_f32 v146, v236, v237
    v_lshlrev_b32 v238, 16, v147
    v_and_b32 v239, s94, v147
    v_pk_fma_f32 v[238:239], v[238:239], v[246:247], v[248:249]
    v_cvt_pk_bf16_f32 v147, v238, v239
    ds_write_b128 v4, v[144:147] offset:36864
    ds_read_b128 a[80:83], v252 offset:16384
    ds_read_b128 a[224:227], v253 offset:16384
    ds_read_b128 a[84:87], v252 offset:20480
    ds_read_b128 a[228:231], v253 offset:20480
    v_lshlrev_b32 v236, 16, v148
    v_and_b32 v237, s94, v148
    v_pk_fma_f32 v[236:237], v[236:237], v[246:247], v[248:249]
    v_cvt_pk_bf16_f32 v148, v236, v237
    v_lshlrev_b32 v238, 16, v149
    v_and_b32 v239, s94, v149
    v_pk_fma_f32 v[238:239], v[238:239], v[246:247], v[248:249]
    v_cvt_pk_bf16_f32 v149, v238, v239
    v_lshlrev_b32 v236, 16, v150
    v_and_b32 v237, s94, v150
    v_pk_fma_f32 v[236:237], v[236:237], v[246:247], v[248:249]
    v_cvt_pk_bf16_f32 v150, v236, v237
    v_lshlrev_b32 v238, 16, v151
    v_and_b32 v239, s94, v151
    v_pk_fma_f32 v[238:239], v[238:239], v[246:247], v[248:249]
    v_cvt_pk_bf16_f32 v151, v238, v239
    ds_write_b128 v4, v[148:151] offset:40960
    ds_read_b128 a[88:91], v252 offset:24576
    ds_read_b128 a[232:235], v253 offset:24576
    ds_read_b128 a[92:95], v252 offset:28672
    ds_read_b128 a[236:239], v253 offset:28672
    v_lshlrev_b32 v236, 16, v152
    v_and_b32 v237, s94, v152
    v_pk_fma_f32 v[236:237], v[236:237], v[246:247], v[248:249]
    v_cvt_pk_bf16_f32 v152, v236, v237
    v_lshlrev_b32 v238, 16, v153
    v_and_b32 v239, s94, v153
    v_pk_fma_f32 v[238:239], v[238:239], v[246:247], v[248:249]
    v_cvt_pk_bf16_f32 v153, v238, v239
    v_lshlrev_b32 v236, 16, v154
    v_and_b32 v237, s94, v154
    v_pk_fma_f32 v[236:237], v[236:237], v[246:247], v[248:249]
    v_cvt_pk_bf16_f32 v154, v236, v237
    v_lshlrev_b32 v238, 16, v155
    v_and_b32 v239, s94, v155
    v_pk_fma_f32 v[238:239], v[238:239], v[246:247], v[248:249]
    v_cvt_pk_bf16_f32 v155, v238, v239
    ds_write_b128 v4, v[152:155] offset:45056
    v_lshlrev_b32 v236, 16, v156
    v_and_b32 v237, s94, v156
    v_pk_fma_f32 v[236:237], v[236:237], v[246:247], v[248:249]
    v_cvt_pk_bf16_f32 v156, v236, v237
    v_lshlrev_b32 v238, 16, v157
    v_and_b32 v239, s94, v157
    v_pk_fma_f32 v[238:239], v[238:239], v[246:247], v[248:249]
    v_cvt_pk_bf16_f32 v157, v238, v239
    v_lshlrev_b32 v236, 16, v158
    v_and_b32 v237, s94, v158
    v_pk_fma_f32 v[236:237], v[236:237], v[246:247], v[248:249]
    v_cvt_pk_bf16_f32 v158, v236, v237
    v_lshlrev_b32 v238, 16, v159
    v_and_b32 v239, s94, v159
    v_pk_fma_f32 v[238:239], v[238:239], v[246:247], v[248:249]
    v_cvt_pk_bf16_f32 v159, v238, v239
    ds_write_b128 v4, v[156:159] offset:49152
    v_lshlrev_b32 v236, 16, v160
    v_and_b32 v237, s94, v160
    v_pk_fma_f32 v[236:237], v[236:237], v[246:247], v[248:249]
    v_cvt_pk_bf16_f32 v160, v236, v237
    v_lshlrev_b32 v238, 16, v161
    v_and_b32 v239, s94, v161
    v_pk_fma_f32 v[238:239], v[238:239], v[246:247], v[248:249]
    v_cvt_pk_bf16_f32 v161, v238, v239
    v_lshlrev_b32 v236, 16, v162
    v_and_b32 v237, s94, v162
    v_pk_fma_f32 v[236:237], v[236:237], v[246:247], v[248:249]
    v_cvt_pk_bf16_f32 v162, v236, v237
    v_lshlrev_b32 v238, 16, v163
    v_and_b32 v239, s94, v163
    v_pk_fma_f32 v[238:239], v[238:239], v[246:247], v[248:249]
    v_cvt_pk_bf16_f32 v163, v238, v239
    ds_write_b128 v4, v[160:163] offset:53248
    s_waitcnt lgkmcnt(0)
    s_barrier
    v_lshlrev_b32 v236, 16, v164
    v_and_b32 v237, s94, v164
    v_pk_fma_f32 v[236:237], v[236:237], v[246:247], v[248:249]
    v_cvt_pk_bf16_f32 v164, v236, v237
    v_lshlrev_b32 v238, 16, v165
    v_and_b32 v239, s94, v165
    v_pk_fma_f32 v[238:239], v[238:239], v[246:247], v[248:249]
    v_cvt_pk_bf16_f32 v165, v238, v239
    v_lshlrev_b32 v236, 16, v166
    v_and_b32 v237, s94, v166
    v_pk_fma_f32 v[236:237], v[236:237], v[246:247], v[248:249]
    v_cvt_pk_bf16_f32 v166, v236, v237
    v_lshlrev_b32 v238, 16, v167
    v_and_b32 v239, s94, v167
    v_pk_fma_f32 v[238:239], v[238:239], v[246:247], v[248:249]
    v_cvt_pk_bf16_f32 v167, v238, v239
    ds_write_b128 v4, v[164:167] offset:57344
    ds_read_b128 a[96:99], v250 offset:32768
    ds_read_b128 a[240:243], v251 offset:32768
    ds_read_b128 a[100:103], v250 offset:36864
    ds_read_b128 a[244:247], v251 offset:36864
    v_lshlrev_b32 v236, 16, v168
    v_and_b32 v237, s94, v168
    v_pk_fma_f32 v[236:237], v[236:237], v[246:247], v[248:249]
    v_cvt_pk_bf16_f32 v168, v236, v237
    v_lshlrev_b32 v238, 16, v169
    v_and_b32 v239, s94, v169
    v_pk_fma_f32 v[238:239], v[238:239], v[246:247], v[248:249]
    v_cvt_pk_bf16_f32 v169, v238, v239
    v_lshlrev_b32 v236, 16, v170
    v_and_b32 v237, s94, v170
    v_pk_fma_f32 v[236:237], v[236:237], v[246:247], v[248:249]
    v_cvt_pk_bf16_f32 v170, v236, v237
    v_lshlrev_b32 v238, 16, v171
    v_and_b32 v239, s94, v171
    v_pk_fma_f32 v[238:239], v[238:239], v[246:247], v[248:249]
    v_cvt_pk_bf16_f32 v171, v238, v239
    ds_write_b128 v4, v[168:171] offset:61440
    ds_read_b128 a[104:107], v250 offset:40960
    ds_read_b128 a[248:251], v251 offset:40960
    ds_read_b128 a[108:111], v250 offset:45056
    ds_read_b128 a[252:255], v251 offset:45056
    v_lshlrev_b32 v236, 16, v172
    v_and_b32 v237, s94, v172
    v_pk_fma_f32 v[236:237], v[236:237], v[246:247], v[248:249]
    v_cvt_pk_bf16_f32 v172, v236, v237
    v_lshlrev_b32 v238, 16, v173
    v_and_b32 v239, s94, v173
    v_pk_fma_f32 v[238:239], v[238:239], v[246:247], v[248:249]
    v_cvt_pk_bf16_f32 v173, v238, v239
    v_lshlrev_b32 v236, 16, v174
    v_and_b32 v237, s94, v174
    v_pk_fma_f32 v[236:237], v[236:237], v[246:247], v[248:249]
    v_cvt_pk_bf16_f32 v174, v236, v237
    v_lshlrev_b32 v238, 16, v175
    v_and_b32 v239, s94, v175
    v_pk_fma_f32 v[238:239], v[238:239], v[246:247], v[248:249]
    v_cvt_pk_bf16_f32 v175, v238, v239
    ds_write_b128 v5, v[172:175] offset:0
    ds_read_b128 a[112:115], v250 offset:49152
    ds_read_b128 v[12:15], v251 offset:49152
    ds_read_b128 a[116:119], v250 offset:53248
    ds_read_b128 v[16:19], v251 offset:53248
    v_lshlrev_b32 v236, 16, v176
    v_and_b32 v237, s94, v176
    v_pk_fma_f32 v[236:237], v[236:237], v[246:247], v[248:249]
    v_cvt_pk_bf16_f32 v176, v236, v237
    v_lshlrev_b32 v238, 16, v177
    v_and_b32 v239, s94, v177
    v_pk_fma_f32 v[238:239], v[238:239], v[246:247], v[248:249]
    v_cvt_pk_bf16_f32 v177, v238, v239
    v_lshlrev_b32 v236, 16, v178
    v_and_b32 v237, s94, v178
    v_pk_fma_f32 v[236:237], v[236:237], v[246:247], v[248:249]
    v_cvt_pk_bf16_f32 v178, v236, v237
    v_lshlrev_b32 v238, 16, v179
    v_and_b32 v239, s94, v179
    v_pk_fma_f32 v[238:239], v[238:239], v[246:247], v[248:249]
    v_cvt_pk_bf16_f32 v179, v238, v239
    ds_write_b128 v5, v[176:179] offset:4096
    v_lshlrev_b32 v236, 16, v180
    v_and_b32 v237, s94, v180
    v_pk_fma_f32 v[236:237], v[236:237], v[246:247], v[248:249]
    v_cvt_pk_bf16_f32 v180, v236, v237
    v_lshlrev_b32 v238, 16, v181
    v_and_b32 v239, s94, v181
    v_pk_fma_f32 v[238:239], v[238:239], v[246:247], v[248:249]
    v_cvt_pk_bf16_f32 v181, v238, v239
    v_lshlrev_b32 v236, 16, v182
    v_and_b32 v237, s94, v182
    v_pk_fma_f32 v[236:237], v[236:237], v[246:247], v[248:249]
    v_cvt_pk_bf16_f32 v182, v236, v237
    v_lshlrev_b32 v238, 16, v183
    v_and_b32 v239, s94, v183
    v_pk_fma_f32 v[238:239], v[238:239], v[246:247], v[248:249]
    v_cvt_pk_bf16_f32 v183, v238, v239
    ds_write_b128 v5, v[180:183] offset:8192
    v_lshlrev_b32 v236, 16, v184
    v_and_b32 v237, s94, v184
    v_pk_fma_f32 v[236:237], v[236:237], v[246:247], v[248:249]
    v_cvt_pk_bf16_f32 v184, v236, v237
    v_lshlrev_b32 v238, 16, v185
    v_and_b32 v239, s94, v185
    v_pk_fma_f32 v[238:239], v[238:239], v[246:247], v[248:249]
    v_cvt_pk_bf16_f32 v185, v238, v239
    v_lshlrev_b32 v236, 16, v186
    v_and_b32 v237, s94, v186
    v_pk_fma_f32 v[236:237], v[236:237], v[246:247], v[248:249]
    v_cvt_pk_bf16_f32 v186, v236, v237
    v_lshlrev_b32 v238, 16, v187
    v_and_b32 v239, s94, v187
    v_pk_fma_f32 v[238:239], v[238:239], v[246:247], v[248:249]
    v_cvt_pk_bf16_f32 v187, v238, v239
    ds_write_b128 v5, v[184:187] offset:12288
    s_cmp_ge_u32 s30, 8
    s_cbranch_scc1 START_F
    buffer_load_dword v254, v3, s[72:75], s71 offen offset:128
    s_lshl_b32 s22, s27, 10
    s_add_u32 s22, s22, 90112
    s_add_u32 s22, s22, 8192
    s_sub_u32 s24, s22, s99
    s_min_u32 s22, s22, s24
    v_xor_b32 v3, s22, v7
    s_waitcnt vmcnt(11)
    s_barrier
    ds_read_b64_tr_b16 v[220:221], v3 offset:0
    ds_read_b64_tr_b16 v[222:223], v3 offset:2048
    ds_read_b64_tr_b16 v[224:225], v3 offset:8
    ds_read_b64_tr_b16 v[226:227], v3 offset:2056
    ds_read_b64_tr_b16 v[228:229], v3 offset:4096
    ds_read_b64_tr_b16 v[230:231], v3 offset:6144
    ds_read_b64_tr_b16 v[232:233], v3 offset:4104
    ds_read_b64_tr_b16 v[234:235], v3 offset:6152
    s_add_u32 s22, s22, 8192
    s_sub_u32 s24, s22, s99
    s_min_u32 s22, s22, s24
    v_xor_b32 v3, s22, v7
    s_waitcnt lgkmcnt(8)
    s_barrier
    s_lshr_b32 s98, s54, 1
    s_add_u32 s22, s22, 8192
    s_lshl_b32 s98, s98, 19
    s_sub_u32 s24, s22, s99
    s_add_u32 s98, s98, 393216
    s_cmp_eq_u32 s27, 0
    s_cselect_b32 s96, s40, s42
    s_cselect_b32 s97, s41, s43
    s_min_u32 s22, s22, s24
    s_add_u32 s96, s96, s98
    s_addc_u32 s97, s97, 0
    s_lshl_b32 s98, s29, 1
    s_add_u32 s19, m0, 8192
    s_lshl_b32 s70, s26, 14
    s_add_u32 s98, s98, s28
    v_lshrrev_b32 v10, 1, v0
    s_sub_u32 s21, s19, s99
    s_waitcnt lgkmcnt(6)
    v_mfma_f32_16x16x32_bf16 v[188:191], v[220:223], a[0:3], 0
    ds_read_b128 a[120:123], v250 offset:57344
    s_mov_b32 s31, 0
    v_mfma_f32_16x16x32_bf16 v[192:195], v[220:223], a[72:75], 0
    ds_read_b128 v[20:23], v251 offset:57344
    s_mov_b32 s36, -16
    v_mfma_f32_16x16x32_bf16 v[196:199], v[220:223], a[144:147], 0
    ds_read_b128 a[124:127], v250 offset:61440
    s_add_u32 s55, s54, 2
    v_mfma_f32_16x16x32_bf16 v[200:203], v[220:223], a[216:219], 0
    ds_read_b64_tr_b16 v[220:221], v3 offset:0
    s_mov_b32 s57, s30
    s_waitcnt lgkmcnt(8)
    v_mfma_f32_16x16x32_bf16 v[204:207], v[224:227], a[0:3], 0
    ds_read_b64_tr_b16 v[222:223], v3 offset:2048
    s_add_u32 s70, s70, 98304
    v_mfma_f32_16x16x32_bf16 v[208:211], v[224:227], a[72:75], 0
    ds_read_b128 v[24:27], v251 offset:61440
    s_mov_b32 s76, s96
    v_mfma_f32_16x16x32_bf16 v[212:215], v[224:227], a[144:147], 0
    ds_read_b128 a[128:131], v252 offset:0
    s_mov_b32 s77, s97
    v_mfma_f32_16x16x32_bf16 v[216:219], v[224:227], a[216:219], 0
    ds_read_b64_tr_b16 v[224:225], v3 offset:8
    s_mov_b32 s78, 131072
    s_waitcnt lgkmcnt(10)
    v_mfma_f32_16x16x32_bf16 v[188:191], v[228:231], a[4:7], v[188:191]
    ds_read_b64_tr_b16 v[226:227], v3 offset:2056
    s_mov_b32 s79, 0x00020000
    v_mfma_f32_16x16x32_bf16 v[192:195], v[228:231], a[76:79], v[192:195]
    buffer_load_dwordx4 v1, s[4:7], s16 offen lds
    v_mfma_f32_16x16x32_bf16 v[196:199], v[228:231], a[148:151], v[196:199]
    ds_read_b128 v[28:31], v253 offset:0
    s_mul_i32 s80, s98, 4096
    v_mfma_f32_16x16x32_bf16 v[200:203], v[228:231], a[220:223], v[200:203]
    ds_read_b64_tr_b16 v[228:229], v3 offset:4096
    v_lshlrev_b32 v10, 7, v10
    s_waitcnt lgkmcnt(11)
    v_mfma_f32_16x16x32_bf16 v[204:207], v[232:235], a[4:7], v[204:207]
    buffer_load_dwordx4 v1, s[8:11], s16 offen offset:1024 lds
    v_mfma_f32_16x16x32_bf16 v[208:211], v[232:235], a[76:79], v[208:211]
    ds_read_b64_tr_b16 v[230:231], v3 offset:6144
    s_add_u32 s16, s16, s17
    v_mfma_f32_16x16x32_bf16 v[212:215], v[232:235], a[148:151], v[212:215]
    ds_read_b128 a[132:135], v252 offset:4096
    s_add_u32 s20, s16, s18
    v_mfma_f32_16x16x32_bf16 v[216:219], v[232:235], a[220:223], v[216:219]
    ds_read_b64_tr_b16 v[232:233], v3 offset:4104
    s_min_u32 s16, s16, s20
    s_waitcnt lgkmcnt(9)
    v_mfma_f32_16x16x32_bf16 v[188:191], v[220:223], a[8:11], v[188:191]
    ds_read_b64_tr_b16 v[234:235], v3 offset:6152
    v_xor_b32 v3, s22, v7
    v_mfma_f32_16x16x32_bf16 v[192:195], v[220:223], a[80:83], v[192:195]
    s_add_u32 s22, s22, 8192
    ds_read_b128 v[32:35], v253 offset:4096
    v_mfma_f32_16x16x32_bf16 v[196:199], v[220:223], a[152:155], v[196:199]
    ds_read_b128 a[136:139], v252 offset:8192
    s_sub_u32 s24, s22, s99
    v_mfma_f32_16x16x32_bf16 v[200:203], v[220:223], a[224:227], v[200:203]
    ds_read_b128 v[36:39], v253 offset:8192
    s_min_u32 s22, s22, s24
    s_waitcnt lgkmcnt(9)
    v_mfma_f32_16x16x32_bf16 v[204:207], v[224:227], a[8:11], v[204:207]
    ds_read_b128 a[140:143], v252 offset:12288
    s_min_u32 m0, s19, s21
    v_mfma_f32_16x16x32_bf16 v[208:211], v[224:227], a[80:83], v[208:211]
    ds_read_b128 v[40:43], v253 offset:12288
    v_mfma_f32_16x16x32_bf16 v[212:215], v[224:227], a[152:155], v[212:215]
    ds_read_b64_tr_b16 v[220:221], v3 offset:0
    v_mfma_f32_16x16x32_bf16 v[216:219], v[224:227], a[224:227], v[216:219]
    ds_read_b64_tr_b16 v[222:223], v3 offset:2048
    ds_read_b64_tr_b16 v[224:225], v3 offset:8
    s_waitcnt lgkmcnt(3)
    s_mov_b32 s25, 4
    s_branch TA_Qp4e2
TA_SW23:
    s_lshr_b32 s59, s54, 1
    s_lshl_b32 s59, s59, 19
    s_lshl_b32 s60, s26, 6
    s_add_u32 s59, s59, s60
    s_add_u32 s59, s59, 393216
    s_add_u32 s4, s40, s59
    s_addc_u32 s5, s41, 0
    s_sub_u32 s6, 8388608, s59
    s_add_u32 s8, s42, s59
    s_addc_u32 s9, s43, 0
    s_sub_u32 s8, s8, 1024
    s_subb_u32 s9, s9, 0
    s_add_u32 s10, s6, 1024
    s_mov_b32 s16, 0
    s_mov_b32 s17, 4096
    s_mov_b32 s18, 0
    v_lshrrev_b32 v2, 2, v0
    v_mul_u32_u24 v2, 256, v2
    v_and_or_b32 v1, v7, 48, v2
    s_branch TA_SW23r
.p2align 3
TA_Qp41:
    v_mfma_f32_16x16x32_bf16 v[200:203], v[228:231], v[32:35], v[200:203]
    ds_read_b64_tr_b16 v[228:229], v3 offset:4096
    v_mfma_f32_16x16x32_bf16 v[204:207], v[232:235], a[60:63], v[204:207]
    ds_read_b64_tr_b16 v[230:231], v3 offset:6144
    s_add_u32 s22, s22, 8192
    v_mfma_f32_16x16x32_bf16 v[208:211], v[232:235], a[132:135], v[208:211]
    s_sub_u32 s24, s22, s99
    s_min_u32 s22, s22, s24
    v_mfma_f32_16x16x32_bf16 v[212:215], v[232:235], a[204:207], v[212:215]
    buffer_load_dwordx4 v1, s[4:7], s16 offen lds
    v_mfma_f32_16x16x32_bf16 v[216:219], v[232:235], v[32:35], v[216:219]
    ds_read_b64_tr_b16 v[232:233], v3 offset:4104
    s_waitcnt lgkmcnt(3)
    v_mfma_f32_16x16x32_bf16 v[188:191], v[220:223], a[64:67], v[188:191]
    ds_read_b64_tr_b16 v[234:235], v3 offset:6152
    v_xor_b32 v3, s22, v7
    v_mfma_f32_16x16x32_bf16 v[192:195], v[220:223], a[136:139], v[192:195]
    buffer_load_dwordx4 v1, s[8:11], s16 offen offset:1024 lds
    v_mfma_f32_16x16x32_bf16 v[196:199], v[220:223], a[208:211], v[196:199]
    s_waitcnt vmcnt(11)
    s_barrier
    s_add_u32 s19, m0, 8192
    v_mfma_f32_16x16x32_bf16 v[200:203], v[220:223], v[36:39], v[200:203]
    ds_read_b64_tr_b16 v[220:221], v3 offset:0
    s_sub_u32 s21, s19, s99
    v_mfma_f32_16x16x32_bf16 v[204:207], v[224:227], a[64:67], v[204:207]
    ds_read_b64_tr_b16 v[222:223], v3 offset:2048
    s_add_u32 s16, s16, s17
    v_mfma_f32_16x16x32_bf16 v[208:211], v[224:227], a[136:139], v[208:211]
    s_add_u32 s20, s16, s18
    s_min_u32 s16, s16, s20
    v_mfma_f32_16x16x32_bf16 v[212:215], v[224:227], a[208:211], v[212:215]
    v_mfma_f32_16x16x32_bf16 v[216:219], v[224:227], v[36:39], v[216:219]
    ds_read_b64_tr_b16 v[224:225], v3 offset:8
    s_waitcnt lgkmcnt(3)
    v_mfma_f32_16x16x32_bf16 v[188:191], v[228:231], a[68:71], v[188:191]
    ds_read_b64_tr_b16 v[226:227], v3 offset:2056
    v_mfma_f32_16x16x32_bf16 v[192:195], v[228:231], a[140:143], v[192:195]
    s_min_u32 m0, s19, s21
    v_mfma_f32_16x16x32_bf16 v[196:199], v[228:231], a[212:215], v[196:199]
    v_mfma_f32_16x16x32_bf16 v[200:203], v[228:231], v[40:43], v[200:203]
    ds_read_b64_tr_b16 v[228:229], v3 offset:4096
    v_mfma_f32_16x16x32_bf16 v[204:207], v[232:235], a[68:71], v[204:207]
    ds_read_b64_tr_b16 v[230:231], v3 offset:6144
    v_cvt_pk_bf16_f32 v140, v188, v189
    v_mfma_f32_16x16x32_bf16 v[208:211], v[232:235], a[140:143], v[208:211]
    s_add_u32 s22, s22, 8192
    v_cvt_pk_bf16_f32 v141, v190, v191
    v_cvt_pk_bf16_f32 v144, v192, v193
    v_mfma_f32_16x16x32_bf16 v[212:215], v[232:235], a[212:215], v[212:215]
    s_sub_u32 s24, s22, s99
    s_min_u32 s22, s22, s24
    v_cvt_pk_bf16_f32 v145, v194, v195
    v_cvt_pk_bf16_f32 v148, v196, v197
    v_mfma_f32_16x16x32_bf16 v[216:219], v[232:235], v[40:43], v[216:219]
    ds_read_b64_tr_b16 v[232:233], v3 offset:4104
    s_waitcnt lgkmcnt(3)
    v_cvt_pk_bf16_f32 v149, v198, v199
    v_mfma_f32_16x16x32_bf16 v[188:191], v[220:223], a[0:3], 0
    ds_read_b64_tr_b16 v[234:235], v3 offset:6152
    v_cvt_pk_bf16_f32 v152, v200, v201
    v_xor_b32 v3, s22, v7
    v_mfma_f32_16x16x32_bf16 v[192:195], v[220:223], a[72:75], 0
    v_cvt_pk_bf16_f32 v153, v202, v203
    v_cvt_pk_bf16_f32 v142, v204, v205
    v_mfma_f32_16x16x32_bf16 v[196:199], v[220:223], a[144:147], 0
    v_cvt_pk_bf16_f32 v143, v206, v207
    v_cvt_pk_bf16_f32 v146, v208, v209
    v_mfma_f32_16x16x32_bf16 v[200:203], v[220:223], a[216:219], 0
    ds_read_b64_tr_b16 v[220:221], v3 offset:0
    v_cvt_pk_bf16_f32 v147, v210, v211
    v_mfma_f32_16x16x32_bf16 v[204:207], v[224:227], a[0:3], 0
    ds_read_b64_tr_b16 v[222:223], v3 offset:2048
    v_cvt_pk_bf16_f32 v150, v212, v213
    v_mfma_f32_16x16x32_bf16 v[208:211], v[224:227], a[72:75], 0
    s_add_u32 s22, s22, 8192
    v_cvt_pk_bf16_f32 v151, v214, v215
    v_cvt_pk_bf16_f32 v154, v216, v217
    v_mfma_f32_16x16x32_bf16 v[212:215], v[224:227], a[144:147], 0
    s_sub_u32 s24, s22, s99
    s_min_u32 s22, s22, s24
    v_cvt_pk_bf16_f32 v155, v218, v219
    v_mfma_f32_16x16x32_bf16 v[216:219], v[224:227], a[216:219], 0
    ds_read_b64_tr_b16 v[224:225], v3 offset:8
    s_waitcnt lgkmcnt(3)
    v_mfma_f32_16x16x32_bf16 v[188:191], v[228:231], a[4:7], v[188:191]
    ds_read_b64_tr_b16 v[226:227], v3 offset:2056
    v_mfma_f32_16x16x32_bf16 v[192:195], v[228:231], a[76:79], v[192:195]
    buffer_load_dwordx4 v1, s[4:7], s16 offen lds
    v_mfma_f32_16x16x32_bf16 v[196:199], v[228:231], a[148:151], v[196:199]
    v_mfma_f32_16x16x32_bf16 v[200:203], v[228:231], a[220:223], v[200:203]
    ds_read_b64_tr_b16 v[228:229], v3 offset:4096
    v_mfma_f32_16x16x32_bf16 v[204:207], v[232:235], a[4:7], v[204:207]
    ds_read_b64_tr_b16 v[230:231], v3 offset:6144
    v_mfma_f32_16x16x32_bf16 v[208:211], v[232:235], a[76:79], v[208:211]
    buffer_load_dwordx4 v1, s[8:11], s16 offen offset:1024 lds
    v_mfma_f32_16x16x32_bf16 v[212:215], v[232:235], a[148:151], v[212:215]
    s_add_u32 s19, m0, 8192
    s_sub_u32 s21, s19, s99
    s_add_u32 s16, s16, s17
    v_mfma_f32_16x16x32_bf16 v[216:219], v[232:235], a[220:223], v[216:219]
    ds_read_b64_tr_b16 v[232:233], v3 offset:4104
    s_waitcnt lgkmcnt(3)
    v_mfma_f32_16x16x32_bf16 v[188:191], v[220:223], a[8:11], v[188:191]
    ds_read_b64_tr_b16 v[234:235], v3 offset:6152
    v_xor_b32 v3, s22, v7
    v_mfma_f32_16x16x32_bf16 v[192:195], v[220:223], a[80:83], v[192:195]
    s_add_u32 s20, s16, s18
    s_min_u32 s16, s16, s20
    v_mfma_f32_16x16x32_bf16 v[196:199], v[220:223], a[152:155], v[196:199]
    v_mfma_f32_16x16x32_bf16 v[200:203], v[220:223], a[224:227], v[200:203]
    ds_read_b64_tr_b16 v[220:221], v3 offset:0
    v_mfma_f32_16x16x32_bf16 v[204:207], v[224:227], a[8:11], v[204:207]
    ds_read_b64_tr_b16 v[222:223], v3 offset:2048
    s_add_u32 s22, s22, 8192
    v_mfma_f32_16x16x32_bf16 v[208:211], v[224:227], a[80:83], v[208:211]
    s_sub_u32 s24, s22, s99
    s_min_u32 s22, s22, s24
    s_min_u32 m0, s19, s21
    v_mfma_f32_16x16x32_bf16 v[212:215], v[224:227], a[152:155], v[212:215]
    v_mfma_f32_16x16x32_bf16 v[216:219], v[224:227], a[224:227], v[216:219]
    ds_read_b64_tr_b16 v[224:225], v3 offset:8
    s_waitcnt lgkmcnt(3)
TA_Qp4e2:
    v_mfma_f32_16x16x32_bf16 v[188:191], v[228:231], a[12:15], v[188:191]
    ds_read_b64_tr_b16 v[226:227], v3 offset:2056
    v_mfma_f32_16x16x32_bf16 v[192:195], v[228:231], a[84:87], v[192:195]
    s_cmp_eq_u32 s25, 1
    s_cselect_b32 s16, 704, s16
    v_mfma_f32_16x16x32_bf16 v[196:199], v[228:231], a[156:159], v[196:199]
    buffer_load_dwordx4 v1, s[4:7], s16 offen lds
    v_mfma_f32_16x16x32_bf16 v[200:203], v[228:231], a[228:231], v[200:203]
    ds_read_b64_tr_b16 v[228:229], v3 offset:4096
    v_mfma_f32_16x16x32_bf16 v[204:207], v[232:235], a[12:15], v[204:207]
    ds_read_b64_tr_b16 v[230:231], v3 offset:6144
    v_mfma_f32_16x16x32_bf16 v[208:211], v[232:235], a[84:87], v[208:211]
    buffer_load_dwordx4 v1, s[8:11], s16 offen offset:1024 lds
    v_mfma_f32_16x16x32_bf16 v[212:215], v[232:235], a[156:159], v[212:215]
    s_add_u32 s19, m0, 8192
    s_sub_u32 s21, s19, s99
    s_add_u32 s16, s16, s17
    v_mfma_f32_16x16x32_bf16 v[216:219], v[232:235], a[228:231], v[216:219]
    ds_read_b64_tr_b16 v[232:233], v3 offset:4104
    s_waitcnt lgkmcnt(3)
    v_mfma_f32_16x16x32_bf16 v[188:191], v[220:223], a[16:19], v[188:191]
    ds_read_b64_tr_b16 v[234:235], v3 offset:6152
    v_xor_b32 v3, s22, v7
    v_mfma_f32_16x16x32_bf16 v[192:195], v[220:223], a[88:91], v[192:195]
    s_set_gpr_idx_on s31, gpr_idx(DST)
    v_mov_b64 v[44:45], v[140:141]
    s_set_gpr_idx_off
    v_mfma_f32_16x16x32_bf16 v[196:199], v[220:223], a[160:163], v[196:199]
    s_waitcnt vmcnt(8)
    s_barrier
    s_add_u32 s20, s16, s18
    s_min_u32 s16, s16, s20
    v_mfma_f32_16x16x32_bf16 v[200:203], v[220:223], a[232:235], v[200:203]
    ds_read_b64_tr_b16 v[220:221], v3 offset:0
    s_min_u32 m0, s19, s21
    v_mfma_f32_16x16x32_bf16 v[204:207], v[224:227], a[16:19], v[204:207]
    ds_read_b64_tr_b16 v[222:223], v3 offset:2048
    s_add_u32 s22, s22, 8192
    v_mfma_f32_16x16x32_bf16 v[208:211], v[224:227], a[88:91], v[208:211]
    s_sub_u32 s24, s22, s99
    s_min_u32 s22, s22, s24
    v_mfma_f32_16x16x32_bf16 v[212:215], v[224:227], a[160:163], v[212:215]
    s_cmp_eq_u32 s25, 0
    s_cbranch_scc1 TA_SW23
TA_SW23r:
    v_mfma_f32_16x16x32_bf16 v[216:219], v[224:227], a[232:235], v[216:219]
    ds_read_b64_tr_b16 v[224:225], v3 offset:8
    s_waitcnt lgkmcnt(3)
    v_mfma_f32_16x16x32_bf16 v[188:191], v[228:231], a[20:23], v[188:191]
    ds_read_b64_tr_b16 v[226:227], v3 offset:2056
    v_mfma_f32_16x16x32_bf16 v[192:195], v[228:231], a[92:95], v[192:195]
    buffer_load_dwordx4 v1, s[4:7], s16 offen lds
    v_mfma_f32_16x16x32_bf16 v[196:199], v[228:231], a[164:167], v[196:199]
    v_mfma_f32_16x16x32_bf16 v[200:203], v[228:231], a[236:239], v[200:203]
    ds_read_b64_tr_b16 v[228:229], v3 offset:4096
    v_mfma_f32_16x16x32_bf16 v[204:207], v[232:235], a[20:23], v[204:207]
    ds_read_b64_tr_b16 v[230:231], v3 offset:6144
    v_mfma_f32_16x16x32_bf16 v[208:211], v[232:235], a[92:95], v[208:211]
    buffer_load_dwordx4 v1, s[8:11], s16 offen offset:1024 lds
    v_mfma_f32_16x16x32_bf16 v[212:215], v[232:235], a[164:167], v[212:215]
    s_add_u32 s19, m0, 8192
    s_sub_u32 s21, s19, s99
    s_add_u32 s16, s16, s17
    v_mfma_f32_16x16x32_bf16 v[216:219], v[232:235], a[236:239], v[216:219]
    ds_read_b64_tr_b16 v[232:233], v3 offset:4104
    s_waitcnt lgkmcnt(3)
    v_mfma_f32_16x16x32_bf16 v[188:191], v[220:223], a[24:27], v[188:191]
    ds_read_b64_tr_b16 v[234:235], v3 offset:6152
    v_xor_b32 v3, s22, v7
    v_mfma_f32_16x16x32_bf16 v[192:195], v[220:223], a[96:99], v[192:195]
    s_set_gpr_idx_on s31, gpr_idx(DST)
    v_mov_b64 v[46:47], v[142:143]
    s_set_gpr_idx_off
    v_mfma_f32_16x16x32_bf16 v[196:199], v[220:223], a[168:171], v[196:199]
    s_min_u32 m0, s19, s21
    s_add_u32 s20, s16, s18
    s_min_u32 s16, s16, s20
    v_mfma_f32_16x16x32_bf16 v[200:203], v[220:223], a[240:243], v[200:203]
    ds_read_b64_tr_b16 v[220:221], v3 offset:0
    v_mfma_f32_16x16x32_bf16 v[204:207], v[224:227], a[24:27], v[204:207]
    ds_read_b64_tr_b16 v[222:223], v3 offset:2048
    s_add_u32 s22, s22, 8192
    v_mfma_f32_16x16x32_bf16 v[208:211], v[224:227], a[96:99], v[208:211]
    s_sub_u32 s24, s22, s99
    s_min_u32 s22, s22, s24
    v_mfma_f32_16x16x32_bf16 v[212:215], v[224:227], a[168:171], v[212:215]
    buffer_load_dwordx4 v1, s[4:7], s16 offen lds
    v_mfma_f32_16x16x32_bf16 v[216:219], v[224:227], a[240:243], v[216:219]
    ds_read_b64_tr_b16 v[224:225], v3 offset:8
    s_waitcnt lgkmcnt(3)
    v_mfma_f32_16x16x32_bf16 v[188:191], v[228:231], a[28:31], v[188:191]
    ds_read_b64_tr_b16 v[226:227], v3 offset:2056
    v_mfma_f32_16x16x32_bf16 v[192:195], v[228:231], a[100:103], v[192:195]
    buffer_load_dwordx4 v1, s[8:11], s16 offen offset:1024 lds
    v_mfma_f32_16x16x32_bf16 v[196:199], v[228:231], a[172:175], v[196:199]
    s_add_u32 s19, m0, 8192
    s_sub_u32 s21, s19, s99
    s_add_u32 s16, s16, s17
    v_mfma_f32_16x16x32_bf16 v[200:203], v[228:231], a[244:247], v[200:203]
    ds_read_b64_tr_b16 v[228:229], v3 offset:4096
    s_add_u32 s20, s16, s18
    v_mfma_f32_16x16x32_bf16 v[204:207], v[232:235], a[28:31], v[204:207]
    ds_read_b64_tr_b16 v[230:231], v3 offset:6144
    s_min_u32 s16, s16, s20
    v_mfma_f32_16x16x32_bf16 v[208:211], v[232:235], a[100:103], v[208:211]
    s_set_gpr_idx_on s31, gpr_idx(DST)
    v_mov_b64 v[48:49], v[144:145]
    s_set_gpr_idx_off
    v_mfma_f32_16x16x32_bf16 v[212:215], v[232:235], a[172:175], v[212:215]
    v_mfma_f32_16x16x32_bf16 v[216:219], v[232:235], a[244:247], v[216:219]
    ds_read_b64_tr_b16 v[232:233], v3 offset:4104
    s_waitcnt lgkmcnt(3)
    v_mfma_f32_16x16x32_bf16 v[188:191], v[220:223], a[32:35], v[188:191]
    ds_read_b64_tr_b16 v[234:235], v3 offset:6152
    v_xor_b32 v3, s22, v7
    v_mfma_f32_16x16x32_bf16 v[192:195], v[220:223], a[104:107], v[192:195]
    s_min_u32 m0, s19, s21
    v_mfma_f32_16x16x32_bf16 v[196:199], v[220:223], a[176:179], v[196:199]
    buffer_load_dwordx4 v1, s[4:7], s16 offen lds
    v_mfma_f32_16x16x32_bf16 v[200:203], v[220:223], a[248:251], v[200:203]
    ds_read_b64_tr_b16 v[220:221], v3 offset:0
    v_mfma_f32_16x16x32_bf16 v[204:207], v[224:227], a[32:35], v[204:207]
    ds_read_b64_tr_b16 v[222:223], v3 offset:2048
    s_add_u32 s22, s22, 8192
    v_mfma_f32_16x16x32_bf16 v[208:211], v[224:227], a[104:107], v[208:211]
    s_sub_u32 s24, s22, s99
    s_min_u32 s22, s22, s24
    v_mfma_f32_16x16x32_bf16 v[212:215], v[224:227], a[176:179], v[212:215]
    buffer_load_dwordx4 v1, s[8:11], s16 offen offset:1024 lds
    v_mfma_f32_16x16x32_bf16 v[216:219], v[224:227], a[248:251], v[216:219]
    ds_read_b64_tr_b16 v[224:225], v3 offset:8
    s_waitcnt lgkmcnt(3)
    s_add_u32 s19, m0, 8192
    v_mfma_f32_16x16x32_bf16 v[188:191], v[228:231], a[36:39], v[188:191]
    ds_read_b64_tr_b16 v[226:227], v3 offset:2056
    s_sub_u32 s21, s19, s99
    v_mfma_f32_16x16x32_bf16 v[192:195], v[228:231], a[108:111], v[192:195]
    buffer_load_dword v254, v10, s[76:79], s80 offen
    v_mfma_f32_16x16x32_bf16 v[196:199], v[228:231], a[180:183], v[196:199]
    s_add_u32 s80, s80, 131072
    s_add_u32 s16, s16, s17
    s_add_u32 s20, s16, s18
    v_mfma_f32_16x16x32_bf16 v[200:203], v[228:231], a[252:255], v[200:203]
    ds_read_b64_tr_b16 v[228:229], v3 offset:4096
    s_min_u32 s16, s16, s20
    v_mfma_f32_16x16x32_bf16 v[204:207], v[232:235], a[36:39], v[204:207]
    ds_read_b64_tr_b16 v[230:231], v3 offset:6144
    v_mfma_f32_16x16x32_bf16 v[208:211], v[232:235], a[108:111], v[208:211]
    s_set_gpr_idx_on s31, gpr_idx(DST)
    v_mov_b64 v[50:51], v[146:147]
    s_set_gpr_idx_off
    v_mfma_f32_16x16x32_bf16 v[212:215], v[232:235], a[180:183], v[212:215]
    v_mfma_f32_16x16x32_bf16 v[216:219], v[232:235], a[252:255], v[216:219]
    ds_read_b64_tr_b16 v[232:233], v3 offset:4104
    s_waitcnt lgkmcnt(3)
    s_min_u32 m0, s19, s21
    v_mfma_f32_16x16x32_bf16 v[188:191], v[220:223], a[40:43], v[188:191]
    ds_read_b64_tr_b16 v[234:235], v3 offset:6152
    v_xor_b32 v3, s22, v7
    v_mfma_f32_16x16x32_bf16 v[192:195], v[220:223], a[112:115], v[192:195]
    buffer_load_dwordx4 v1, s[4:7], s16 offen lds
    v_mfma_f32_16x16x32_bf16 v[196:199], v[220:223], a[184:187], v[196:199]
    s_waitcnt vmcnt(10)
    s_barrier
    v_mfma_f32_16x16x32_bf16 v[200:203], v[220:223], v[12:15], v[200:203]
    ds_read_b64_tr_b16 v[220:221], v3 offset:0
    v_mfma_f32_16x16x32_bf16 v[204:207], v[224:227], a[40:43], v[204:207]
    ds_read_b64_tr_b16 v[222:223], v3 offset:2048
    s_add_u32 s22, s22, 8192
    v_mfma_f32_16x16x32_bf16 v[208:211], v[224:227], a[112:115], v[208:211]
    s_sub_u32 s24, s22, s99
    s_min_u32 s22, s22, s24
    v_mfma_f32_16x16x32_bf16 v[212:215], v[224:227], a[184:187], v[212:215]
    buffer_load_dwordx4 v1, s[8:11], s16 offen offset:1024 lds
    v_mfma_f32_16x16x32_bf16 v[216:219], v[224:227], v[12:15], v[216:219]
    ds_read_b64_tr_b16 v[224:225], v3 offset:8
    s_waitcnt lgkmcnt(3)
    s_add_u32 s19, m0, 8192
    v_mfma_f32_16x16x32_bf16 v[188:191], v[228:231], a[44:47], v[188:191]
    ds_read_b64_tr_b16 v[226:227], v3 offset:2056
    s_sub_u32 s21, s19, s99
    v_mfma_f32_16x16x32_bf16 v[192:195], v[228:231], a[116:119], v[192:195]
    s_set_gpr_idx_on s31, gpr_idx(DST)
    v_mov_b64 v[52:53], v[148:149]
    s_set_gpr_idx_off
    v_mfma_f32_16x16x32_bf16 v[196:199], v[228:231], a[188:191], v[196:199]
    s_add_u32 s16, s16, s17
    s_add_u32 s20, s16, s18
    s_min_u32 s16, s16, s20
    v_mfma_f32_16x16x32_bf16 v[200:203], v[228:231], v[16:19], v[200:203]
    ds_read_b64_tr_b16 v[228:229], v3 offset:4096
    v_mfma_f32_16x16x32_bf16 v[204:207], v[232:235], a[44:47], v[204:207]
    ds_read_b64_tr_b16 v[230:231], v3 offset:6144
    v_mfma_f32_16x16x32_bf16 v[208:211], v[232:235], a[116:119], v[208:211]
    s_min_u32 m0, s19, s21
    v_mfma_f32_16x16x32_bf16 v[212:215], v[232:235], a[188:191], v[212:215]
    v_mfma_f32_16x16x32_bf16 v[216:219], v[232:235], v[16:19], v[216:219]
    ds_read_b64_tr_b16 v[232:233], v3 offset:4104
    s_waitcnt lgkmcnt(3)
    v_mfma_f32_16x16x32_bf16 v[188:191], v[220:223], a[48:51], v[188:191]
    ds_read_b64_tr_b16 v[234:235], v3 offset:6152
    v_xor_b32 v3, s22, v7
    v_mfma_f32_16x16x32_bf16 v[192:195], v[220:223], a[120:123], v[192:195]
    buffer_load_dwordx4 v1, s[4:7], s16 offen lds
    v_mfma_f32_16x16x32_bf16 v[196:199], v[220:223], a[192:195], v[196:199]
    v_mfma_f32_16x16x32_bf16 v[200:203], v[220:223], v[20:23], v[200:203]
    ds_read_b64_tr_b16 v[220:221], v3 offset:0
    v_mfma_f32_16x16x32_bf16 v[204:207], v[224:227], a[48:51], v[204:207]
    ds_read_b64_tr_b16 v[222:223], v3 offset:2048
    s_add_u32 s22, s22, 8192
    v_mfma_f32_16x16x32_bf16 v[208:211], v[224:227], a[120:123], v[208:211]
    s_sub_u32 s24, s22, s99
    s_min_u32 s22, s22, s24
    v_mfma_f32_16x16x32_bf16 v[212:215], v[224:227], a[192:195], v[212:215]
    buffer_load_dwordx4 v1, s[8:11], s16 offen offset:1024 lds
    v_mfma_f32_16x16x32_bf16 v[216:219], v[224:227], v[20:23], v[216:219]
    ds_read_b64_tr_b16 v[224:225], v3 offset:8
    s_waitcnt lgkmcnt(3)
    s_add_u32 s19, m0, 8192
    v_mfma_f32_16x16x32_bf16 v[188:191], v[228:231], a[52:55], v[188:191]
    ds_read_b64_tr_b16 v[226:227], v3 offset:2056
    s_sub_u32 s21, s19, s99
    v_mfma_f32_16x16x32_bf16 v[192:195], v[228:231], a[124:127], v[192:195]
    s_set_gpr_idx_on s31, gpr_idx(DST)
    v_mov_b64 v[54:55], v[150:151]
    s_set_gpr_idx_off
    v_mfma_f32_16x16x32_bf16 v[196:199], v[228:231], a[196:199], v[196:199]
    s_add_u32 s16, s16, s17
    s_add_u32 s20, s16, s18
    s_min_u32 s16, s16, s20
    v_mfma_f32_16x16x32_bf16 v[200:203], v[228:231], v[24:27], v[200:203]
    ds_read_b64_tr_b16 v[228:229], v3 offset:4096
    v_mfma_f32_16x16x32_bf16 v[204:207], v[232:235], a[52:55], v[204:207]
    ds_read_b64_tr_b16 v[230:231], v3 offset:6144
    s_min_u32 m0, s19, s21
    v_mfma_f32_16x16x32_bf16 v[208:211], v[232:235], a[124:127], v[208:211]
    v_mfma_f32_16x16x32_bf16 v[212:215], v[232:235], a[196:199], v[212:215]
    buffer_load_dwordx4 v1, s[4:7], s16 offen lds
    v_mfma_f32_16x16x32_bf16 v[216:219], v[232:235], v[24:27], v[216:219]
    ds_read_b64_tr_b16 v[232:233], v3 offset:4104
    s_waitcnt lgkmcnt(3)
    v_mfma_f32_16x16x32_bf16 v[188:191], v[220:223], a[56:59], v[188:191]
    ds_read_b64_tr_b16 v[234:235], v3 offset:6152
    v_xor_b32 v3, s22, v7
    v_mfma_f32_16x16x32_bf16 v[192:195], v[220:223], a[128:131], v[192:195]
    buffer_load_dwordx4 v1, s[8:11], s16 offen offset:1024 lds
    v_mfma_f32_16x16x32_bf16 v[196:199], v[220:223], a[200:203], v[196:199]
    s_add_u32 s19, m0, 8192
    s_sub_u32 s21, s19, s99
    s_add_u32 s16, s16, s17
    v_mfma_f32_16x16x32_bf16 v[200:203], v[220:223], v[28:31], v[200:203]
    ds_read_b64_tr_b16 v[220:221], v3 offset:0
    s_add_u32 s20, s16, s18
    v_mfma_f32_16x16x32_bf16 v[204:207], v[224:227], a[56:59], v[204:207]
    ds_read_b64_tr_b16 v[222:223], v3 offset:2048
    s_min_u32 s16, s16, s20
    v_mfma_f32_16x16x32_bf16 v[208:211], v[224:227], a[128:131], v[208:211]
    s_set_gpr_idx_on s31, gpr_idx(DST)
    v_mov_b64 v[56:57], v[152:153]
    s_set_gpr_idx_off
    v_mfma_f32_16x16x32_bf16 v[212:215], v[224:227], a[200:203], v[212:215]
    s_set_gpr_idx_on s31, gpr_idx(DST)
    v_mov_b64 v[58:59], v[154:155]
    s_set_gpr_idx_off
    v_mfma_f32_16x16x32_bf16 v[216:219], v[224:227], v[28:31], v[216:219]
    ds_read_b64_tr_b16 v[224:225], v3 offset:8
    s_waitcnt lgkmcnt(3)
    v_mfma_f32_16x16x32_bf16 v[188:191], v[228:231], a[60:63], v[188:191]
    ds_read_b64_tr_b16 v[226:227], v3 offset:2056
    s_add_u32 s36, s36, 16
    v_mfma_f32_16x16x32_bf16 v[192:195], v[228:231], a[132:135], v[192:195]
    s_max_i32 s31, s36, 0
    v_mfma_f32_16x16x32_bf16 v[196:199], v[228:231], a[204:207], v[196:199]
    s_min_u32 m0, s19, s21
    s_sub_u32 s25, s25, 1
    s_cbranch_scc0 TA_Qp41
    v_mfma_f32_16x16x32_bf16 v[200:203], v[228:231], v[32:35], v[200:203]
    ds_read_b64_tr_b16 v[228:229], v3 offset:4096
    s_mov_b64 s[64:65], s[92:93]
    v_mfma_f32_16x16x32_bf16 v[204:207], v[232:235], a[60:63], v[204:207]
    ds_read_b64_tr_b16 v[230:231], v3 offset:6144
    s_mov_b32 s66, 256
    v_mfma_f32_16x16x32_bf16 v[208:211], v[232:235], a[132:135], v[208:211]
    s_mov_b32 s67, 0x00020000
    s_lshl_b32 s95, s29, 2
    v_mov_b32 v185, 1
    v_mfma_f32_16x16x32_bf16 v[212:215], v[232:235], a[204:207], v[212:215]
    s_mov_b64 exec, s[38:39]
    buffer_load_dword v185, off, s[64:67], s95 sc1
    s_mov_b64 exec, -1
    v_mfma_f32_16x16x32_bf16 v[216:219], v[232:235], v[32:35], v[216:219]
    ds_read_b64_tr_b16 v[232:233], v3 offset:4104
    s_mov_b32 s22, 81920
    s_waitcnt lgkmcnt(5)
    v_mfma_f32_16x16x32_bf16 v[188:191], v[220:223], a[64:67], v[188:191]
    ds_read_b64_tr_b16 v[234:235], v3 offset:6152
    v_xor_b32 v5, s22, v8
    v_mfma_f32_16x16x32_bf16 v[192:195], v[220:223], a[136:139], v[192:195]
    buffer_load_dwordx4 v1, s[4:7], s16 offen lds
    v_mfma_f32_16x16x32_bf16 v[196:199], v[220:223], a[208:211], v[196:199]
    s_waitcnt vmcnt(10)
    s_barrier
    s_add_u32 s19, m0, 8192
    v_mfma_f32_16x16x32_bf16 v[200:203], v[220:223], v[36:39], v[200:203]
    ds_read_b128 a[144:147], v5 offset:0
    s_sub_u32 s21, s19, s99
    s_waitcnt lgkmcnt(5)
    v_mfma_f32_16x16x32_bf16 v[204:207], v[224:227], a[64:67], v[204:207]
    buffer_load_dwordx4 v1, s[8:11], s16 offen offset:1024 lds
    v_mfma_f32_16x16x32_bf16 v[208:211], v[224:227], a[136:139], v[208:211]
    ds_read_b128 a[148:151], v5 offset:2048
    s_add_u32 s16, s16, s17
    v_mfma_f32_16x16x32_bf16 v[212:215], v[224:227], a[208:211], v[212:215]
    ds_read_b128 a[152:155], v5 offset:4096
    s_add_u32 s20, s16, s18
    v_mfma_f32_16x16x32_bf16 v[216:219], v[224:227], v[36:39], v[216:219]
    ds_read_b128 a[156:159], v5 offset:6144
    s_min_u32 s16, s16, s20
    s_waitcnt lgkmcnt(6)
    v_mfma_f32_16x16x32_bf16 v[188:191], v[228:231], a[68:71], v[188:191]
    s_min_u32 m0, s19, s21
    ds_read_b128 a[160:163], v5 offset:8192
    v_mfma_f32_16x16x32_bf16 v[192:195], v[228:231], a[140:143], v[192:195]
    buffer_load_dwordx4 v1, s[4:7], s16 offen lds
    v_mfma_f32_16x16x32_bf16 v[196:199], v[228:231], a[212:215], v[196:199]
    buffer_load_dwordx4 v1, s[8:11], s16 offen offset:1024 lds
    v_mfma_f32_16x16x32_bf16 v[200:203], v[228:231], v[40:43], v[200:203]
    ds_read_b128 a[164:167], v5 offset:10240
    s_mov_b32 s23, s22
    s_waitcnt lgkmcnt(6)
    v_mfma_f32_16x16x32_bf16 v[204:207], v[232:235], a[68:71], v[204:207]
    ds_read_b128 a[168:171], v5 offset:12288
    s_add_u32 s22, s22, 16384
    v_mfma_f32_16x16x32_bf16 v[208:211], v[232:235], a[140:143], v[208:211]
    ds_read_b128 a[172:175], v5 offset:14336
    s_sub_u32 s24, s22, s99
    v_mfma_f32_16x16x32_bf16 v[212:215], v[232:235], a[212:215], v[212:215]
    s_min_u32 s22, s22, s24
    v_xor_b32 v5, s22, v8
    v_cvt_pk_bf16_f32 v140, v188, v189
    v_mfma_f32_16x16x32_bf16 v[216:219], v[232:235], v[40:43], v[216:219]
    s_waitcnt vmcnt(8)
    s_barrier
    v_cvt_pk_bf16_f32 v144, v192, v193
    s_waitcnt lgkmcnt(7)
    v_mfma_f32_16x16x32_bf16 v[12:15], a[144:147], v[44:47], 0
    s_add_u32 s19, m0, 8192
    v_cvt_pk_bf16_f32 v148, v196, v197
    v_cvt_pk_bf16_f32 v152, v200, v201
    v_mfma_f32_16x16x32_bf16 v[16:19], a[144:147], v[48:51], 0
    s_add_u32 s16, s16, s17
    s_sub_u32 s21, s19, s99
    s_add_u32 s20, s16, s18
    v_mfma_f32_16x16x32_bf16 v[20:23], a[144:147], v[52:55], 0
    s_min_u32 m0, s19, s21
    s_min_u32 s16, s16, s20
    s_lshr_b32 s98, s55, 1
    v_mfma_f32_16x16x32_bf16 v[24:27], a[144:147], v[56:59], 0
    ds_read_b128 a[144:147], v5 offset:0
    s_lshl_b32 s98, s98, 19
    s_waitcnt lgkmcnt(7)
    v_mfma_f32_16x16x32_bf16 v[12:15], a[148:151], v[60:63], v[12:15]
    s_add_u32 s98, s98, 393216
    v_lshrrev_b32 v180, 4, v0
    s_mov_b32 s74, 131072
    v_mfma_f32_16x16x32_bf16 v[16:19], a[148:151], v[64:67], v[16:19]
    s_cmp_eq_u32 s27, 0
    s_cselect_b32 s96, s40, s42
    s_cselect_b32 s97, s41, s43
    v_mfma_f32_16x16x32_bf16 v[20:23], a[148:151], v[68:71], v[20:23]
    s_add_u32 s96, s96, s98
    s_addc_u32 s97, s97, 0
    s_lshl_b32 s98, s29, 1
    v_mfma_f32_16x16x32_bf16 v[24:27], a[148:151], v[72:75], v[24:27]
    ds_read_b128 a[148:151], v5 offset:2048
    s_add_u32 s98, s98, s28
    s_waitcnt lgkmcnt(7)
    v_mfma_f32_16x16x32_bf16 v[12:15], a[152:155], v[76:79], v[12:15]
    s_mov_b32 s72, s96
    s_mov_b32 s73, s97
    s_mov_b32 s75, 0x00020000
    v_mfma_f32_16x16x32_bf16 v[16:19], a[152:155], v[80:83], v[16:19]
    s_mul_i32 s71, s98, 512
    v_lshlrev_b32 v180, 7, v180
    v_cvt_pk_bf16_f32 v141, v190, v191
    v_mfma_f32_16x16x32_bf16 v[20:23], a[152:155], v[84:87], v[20:23]
    s_lshl_b32 s96, s54, 7
    v_cvt_pk_bf16_f32 v145, v194, v195
    v_cvt_pk_bf16_f32 v149, v198, v199
    v_mfma_f32_16x16x32_bf16 v[24:27], a[152:155], v[88:91], v[24:27]
    ds_read_b128 a[152:155], v5 offset:4096
    v_cvt_pk_bf16_f32 v153, v202, v203
    s_waitcnt lgkmcnt(7)
    v_mfma_f32_16x16x32_bf16 v[12:15], a[156:159], v[92:95], v[12:15]
    s_mul_i32 s96, s96, 1152
    v_xor_b32 v3, s23, v6
    v_xor_b32 v4, 32, v3
    v_mfma_f32_16x16x32_bf16 v[16:19], a[156:159], v[96:99], v[16:19]
    s_lshl_b32 s98, s29, 2
    v_mov_b32 v236, 0x3f803f80
    v_mov_b32 v237, 0x3f803f80
    v_mfma_f32_16x16x32_bf16 v[20:23], a[156:159], v[100:103], v[20:23]
    s_add_u32 s96, s46, s96
    s_addc_u32 s97, s47, 0
    v_max3_f32 v172, v12, v13, v14
    v_mfma_f32_16x16x32_bf16 v[24:27], a[156:159], v[104:107], v[24:27]
    ds_read_b128 a[156:159], v5 offset:6144
    v_max_f32 v172, v172, v15
    s_waitcnt lgkmcnt(7)
    v_mfma_f32_16x16x32_bf16 v[28:31], a[160:163], v[44:47], 0
    s_add_u32 s98, s98, s26
    v_mov_b32 v176, v172
    v_max3_f32 v173, v16, v17, v18
    v_mfma_f32_16x16x32_bf16 v[32:35], a[160:163], v[48:51], 0
    s_add_u32 s19, m0, 8192
    v_permlane32_swap_b32 v176, v172
    v_mfma_f32_16x16x32_bf16 v[36:39], a[160:163], v[52:55], 0
    s_mov_b32 s76, s96
    v_max_f32 v172, v172, v176
    v_mov_b32 v176, v172
    v_mfma_f32_16x16x32_bf16 v[40:43], a[160:163], v[56:59], 0
    ds_read_b128 a[160:163], v5 offset:8192
    v_max_f32 v173, v173, v19
    s_waitcnt lgkmcnt(7)
    v_mfma_f32_16x16x32_bf16 v[28:31], a[164:167], v[60:63], v[28:31]
    s_mov_b32 s77, s97
    v_permlane16_swap_b32 v176, v172
    v_mfma_f32_16x16x32_bf16 v[32:35], a[164:167], v[64:67], v[32:35]
    s_mov_b32 s78, 589824
    v_mov_b32 v177, v173
    v_max_f32 v172, v172, v176
    v_mfma_f32_16x16x32_bf16 v[36:39], a[164:167], v[68:71], v[36:39]
    s_mov_b32 s79, 0x00020000
    v_permlane32_swap_b32 v177, v173
    v_mfma_f32_16x16x32_bf16 v[40:43], a[164:167], v[72:75], v[40:43]
    ds_read_b128 a[164:167], v5 offset:10240
    v_max_f32 v173, v173, v177
    s_waitcnt lgkmcnt(7)
    v_mfma_f32_16x16x32_bf16 v[28:31], a[168:171], v[76:79], v[28:31]
    s_mul_i32 s80, s98, 2048
    v_max3_f32 v174, v20, v21, v22
    v_sub_f32 v12, v12, v172
    v_mfma_f32_16x16x32_bf16 v[32:35], a[168:171], v[80:83], v[32:35]
    s_sub_u32 s21, s19, s99
    v_sub_f32 v13, v13, v172
    v_sub_f32 v14, v14, v172
    v_mfma_f32_16x16x32_bf16 v[36:39], a[168:171], v[84:87], v[36:39]
    s_mov_b32 s23, s22
    v_sub_f32 v15, v15, v172
    v_sub_f32 v220, 0, v172
    v_mfma_f32_16x16x32_bf16 v[40:43], a[168:171], v[88:91], v[40:43]
    ds_read_b128 a[168:171], v5 offset:12288
    v_sub_f32 v221, 0, v172
    s_waitcnt lgkmcnt(7)
    v_mfma_f32_16x16x32_bf16 v[28:31], a[172:175], v[92:95], v[28:31]
    s_add_u32 s22, s22, 16384
    v_sub_f32 v222, 0, v172
    v_sub_f32 v223, 0, v172
    v_mfma_f32_16x16x32_bf16 v[32:35], a[172:175], v[96:99], v[32:35]
    s_sub_u32 s24, s22, s99
    v_mov_b32 v177, v173
    v_max_f32 v174, v174, v23
    v_mfma_f32_16x16x32_bf16 v[36:39], a[172:175], v[100:103], v[36:39]
    s_min_u32 s22, s22, s24
    v_exp_f32 v12, v12
    v_mfma_f32_16x16x32_bf16 v[40:43], a[172:175], v[104:107], v[40:43]
    ds_read_b128 a[172:175], v5 offset:14336
    v_exp_f32 v13, v13
    v_exp_f32 v14, v14
    v_exp_f32 v15, v15
    v_permlane16_swap_b32 v177, v173
    v_mov_b32 v178, v174
    v_max_f32 v173, v173, v177
    s_nop 0
    v_permlane32_swap_b32 v178, v174
    v_cvt_pk_bf16_f32 v188, v12, v13
    v_cvt_pk_bf16_f32 v189, v14, v15
    s_waitcnt lgkmcnt(7)
    v_mfma_f32_16x16x32_bf16 v[12:15], a[144:147], v[44:47], v[220:223]
    buffer_load_dwordx4 v1, s[4:7], s16 offen lds
    v_max_f32 v174, v174, v178
    v_max3_f32 v175, v24, v25, v26
    v_sub_f32 v16, v16, v173
    v_sub_f32 v17, v17, v173
    v_sub_f32 v18, v18, v173
    v_sub_f32 v19, v19, v173
    v_sub_f32 v224, 0, v173
    v_sub_f32 v225, 0, v173
    v_sub_f32 v226, 0, v173
    v_sub_f32 v227, 0, v173
    v_mov_b32 v178, v174
    v_max_f32 v175, v175, v27
    v_exp_f32 v16, v16
    v_exp_f32 v17, v17
    v_exp_f32 v18, v18
    v_exp_f32 v19, v19
    v_permlane16_swap_b32 v178, v174
    v_mov_b32 v179, v175
    v_max_f32 v174, v174, v178
    s_nop 0
    v_permlane32_swap_b32 v179, v175
    v_cvt_pk_bf16_f32 v192, v16, v17
    v_cvt_pk_bf16_f32 v193, v18, v19
    v_mfma_f32_16x16x32_bf16 v[16:19], a[144:147], v[48:51], v[224:227]
    v_max_f32 v175, v175, v179
    v_sub_f32 v20, v20, v174
    v_sub_f32 v21, v21, v174
    v_sub_f32 v22, v22, v174
    v_sub_f32 v23, v23, v174
    v_sub_f32 v228, 0, v174
    v_sub_f32 v229, 0, v174
    v_sub_f32 v230, 0, v174
    v_sub_f32 v231, 0, v174
    v_mov_b32 v179, v175
    v_exp_f32 v20, v20
    v_exp_f32 v21, v21
    v_exp_f32 v22, v22
    v_exp_f32 v23, v23
    v_permlane16_swap_b32 v179, v175
    v_max_f32 v175, v175, v179
    v_cvt_pk_bf16_f32 v196, v20, v21
    v_cvt_pk_bf16_f32 v197, v22, v23
    v_mfma_f32_16x16x32_bf16 v[20:23], a[144:147], v[52:55], v[228:231]
    v_sub_f32 v24, v24, v175
    v_sub_f32 v25, v25, v175
    v_sub_f32 v26, v26, v175
    v_sub_f32 v27, v27, v175
    v_sub_f32 v232, 0, v175
    v_sub_f32 v233, 0, v175
    v_sub_f32 v234, 0, v175
    v_sub_f32 v235, 0, v175
    v_exp_f32 v24, v24
    v_exp_f32 v25, v25
    v_exp_f32 v26, v26
    v_exp_f32 v27, v27
    v_cvt_pk_bf16_f32 v200, v24, v25
    v_cvt_pk_bf16_f32 v201, v26, v27
    v_mfma_f32_16x16x32_bf16 v[24:27], a[144:147], v[56:59], v[232:235]
    buffer_load_dword v181, v180, s[72:75], s71 offen
    s_waitcnt lgkmcnt(6)
    v_mfma_f32_16x16x32_bf16 v[12:15], a[148:151], v[60:63], v[12:15]
    ds_read_b64_tr_b16 a[144:145], v3 offset:1024
    v_sub_f32 v28, v28, v172
    v_mfma_f32_16x16x32_bf16 v[16:19], a[148:151], v[64:67], v[16:19]
    ds_read_b64_tr_b16 a[146:147], v3 offset:9216
    v_sub_f32 v29, v29, v172
    v_mfma_f32_16x16x32_bf16 v[20:23], a[148:151], v[68:71], v[20:23]
    s_add_u32 s71, s71, 16384
    v_sub_f32 v30, v30, v172
    v_sub_f32 v31, v31, v172
    v_mfma_f32_16x16x32_bf16 v[24:27], a[148:151], v[72:75], v[24:27]
    ds_read_b64_tr_b16 a[148:149], v4 offset:1024
    v_sub_f32 v32, v32, v173
    s_waitcnt lgkmcnt(8)
    v_mfma_f32_16x16x32_bf16 v[12:15], a[152:155], v[76:79], v[12:15]
    buffer_load_dwordx4 v1, s[8:11], s16 offen offset:1024 lds
    v_mfma_f32_16x16x32_bf16 v[16:19], a[152:155], v[80:83], v[16:19]
    ds_read_b64_tr_b16 a[150:151], v4 offset:9216
    v_sub_f32 v33, v33, v173
    v_mfma_f32_16x16x32_bf16 v[20:23], a[152:155], v[84:87], v[20:23]
    s_add_u32 s16, s16, s17
    v_exp_f32 v28, v28
    v_mfma_f32_16x16x32_bf16 v[24:27], a[152:155], v[88:91], v[24:27]
    ds_read_b64_tr_b16 a[152:153], v3 offset:3072
    v_sub_f32 v34, v34, v173
    s_waitcnt lgkmcnt(9)
    v_mfma_f32_16x16x32_bf16 v[12:15], a[156:159], v[92:95], v[12:15]
    ds_read_b64_tr_b16 a[154:155], v3 offset:11264
    v_sub_f32 v35, v35, v173
    v_mfma_f32_16x16x32_bf16 v[16:19], a[156:159], v[96:99], v[16:19]
    s_add_u32 s20, s16, s18
    v_exp_f32 v29, v29
    v_mfma_f32_16x16x32_bf16 v[20:23], a[156:159], v[100:103], v[20:23]
    s_min_u32 m0, s19, s21
    v_exp_f32 v30, v30
    v_mfma_f32_16x16x32_bf16 v[24:27], a[156:159], v[104:107], v[24:27]
    ds_read_b64_tr_b16 a[156:157], v4 offset:3072
    v_exp_f32 v31, v31
    v_cvt_pk_bf16_f32 v190, v28, v29
    v_cvt_pk_bf16_f32 v191, v30, v31
    s_waitcnt lgkmcnt(10)
    v_mfma_f32_16x16x32_bf16 v[28:31], a[160:163], v[44:47], v[220:223]
    ds_read_b64_tr_b16 a[158:159], v4 offset:11264
    v_exp_f32 v32, v32
    v_exp_f32 v33, v33
    v_exp_f32 v34, v34
    v_exp_f32 v35, v35
    v_cvt_pk_bf16_f32 v194, v32, v33
    v_cvt_pk_bf16_f32 v195, v34, v35
    v_mfma_f32_16x16x32_bf16 v[32:35], a[160:163], v[48:51], v[224:227]
    s_min_u32 s16, s16, s20
    v_sub_f32 v36, v36, v174
    v_sub_f32 v37, v37, v174
    v_sub_f32 v38, v38, v174
    v_sub_f32 v39, v39, v174
    v_exp_f32 v36, v36
    v_exp_f32 v37, v37
    v_exp_f32 v38, v38
    v_exp_f32 v39, v39
    v_cvt_pk_bf16_f32 v198, v36, v37
    v_cvt_pk_bf16_f32 v199, v38, v39
    v_mfma_f32_16x16x32_bf16 v[36:39], a[160:163], v[52:55], v[228:231]
    s_add_u32 s19, m0, 8192
    v_sub_f32 v40, v40, v175
    v_sub_f32 v41, v41, v175
    v_sub_f32 v42, v42, v175
    v_sub_f32 v43, v43, v175
    v_exp_f32 v40, v40
    v_exp_f32 v41, v41
    v_exp_f32 v42, v42
    v_exp_f32 v43, v43
    v_cvt_pk_bf16_f32 v202, v40, v41
    v_cvt_pk_bf16_f32 v203, v42, v43
    v_mfma_f32_16x16x32_bf16 v[40:43], a[160:163], v[56:59], v[232:235]
    ds_read_b64_tr_b16 a[160:161], v3 offset:5120
    v_mov_b32 v238, 0x3f803f80
    s_waitcnt lgkmcnt(11)
    v_mfma_f32_16x16x32_bf16 v[28:31], a[164:167], v[60:63], v[28:31]
    ds_read_b64_tr_b16 a[162:163], v3 offset:13312
    v_mov_b32 v239, 0x3f803f80
    v_mfma_f32_16x16x32_bf16 v[32:35], a[164:167], v[64:67], v[32:35]
    s_sub_u32 s21, s19, s99
    v_cvt_pk_bf16_f32 v142, v204, v205
    v_cvt_pk_bf16_f32 v143, v206, v207
    v_mfma_f32_16x16x32_bf16 v[36:39], a[164:167], v[68:71], v[36:39]
    v_mov_b64 v[108:109], v[140:141]
    v_mov_b64 v[110:111], v[142:143]
    v_mfma_f32_16x16x32_bf16 v[40:43], a[164:167], v[72:75], v[40:43]
    ds_read_b64_tr_b16 a[164:165], v4 offset:5120
    v_accvgpr_write_b32 a240, v108
    s_waitcnt lgkmcnt(12)
    v_mfma_f32_16x16x32_bf16 v[28:31], a[168:171], v[76:79], v[28:31]
    ds_read_b64_tr_b16 a[166:167], v4 offset:13312
    v_accvgpr_write_b32 a241, v109
    v_mfma_f32_16x16x32_bf16 v[32:35], a[168:171], v[80:83], v[32:35]
    v_accvgpr_write_b32 a242, v110
    v_accvgpr_write_b32 a243, v111
    v_mfma_f32_16x16x32_bf16 v[36:39], a[168:171], v[84:87], v[36:39]
    v_cvt_pk_bf16_f32 v146, v208, v209
    v_cvt_pk_bf16_f32 v147, v210, v211
    v_mfma_f32_16x16x32_bf16 v[40:43], a[168:171], v[88:91], v[40:43]
    ds_read_b64_tr_b16 a[168:169], v3 offset:7168
    v_mov_b64 v[112:113], v[144:145]
    s_waitcnt lgkmcnt(13)
    v_mfma_f32_16x16x32_bf16 v[28:31], a[172:175], v[92:95], v[28:31]
    ds_read_b64_tr_b16 a[170:171], v3 offset:15360
    v_mov_b64 v[114:115], v[146:147]
    v_mfma_f32_16x16x32_bf16 v[32:35], a[172:175], v[96:99], v[32:35]
    v_accvgpr_write_b32 a244, v112
    v_accvgpr_write_b32 a245, v113
    v_mfma_f32_16x16x32_bf16 v[36:39], a[172:175], v[100:103], v[36:39]
    v_accvgpr_write_b32 a246, v114
    v_accvgpr_write_b32 a247, v115
    v_mfma_f32_16x16x32_bf16 v[40:43], a[172:175], v[104:107], v[40:43]
    ds_read_b64_tr_b16 a[172:173], v4 offset:7168
    v_cvt_pk_bf16_f32 v150, v212, v213
    v_mfma_f32_16x16x32_bf16 a[128:131], v[236:239], v[188:191], 0
    ds_read_b64_tr_b16 a[174:175], v4 offset:15360
    v_cvt_pk_bf16_f32 v151, v214, v215
    v_mfma_f32_16x16x32_bf16 a[132:135], v[236:239], v[192:195], 0
    v_mov_b64 v[116:117], v[148:149]
    v_mov_b64 v[118:119], v[150:151]
    v_mfma_f32_16x16x32_bf16 a[136:139], v[236:239], v[196:199], 0
    v_accvgpr_write_b32 a248, v116
    v_accvgpr_write_b32 a249, v117
    v_mfma_f32_16x16x32_bf16 a[140:143], v[236:239], v[200:203], 0
    v_accvgpr_write_b32 a250, v118
    v_accvgpr_write_b32 a251, v119
    s_waitcnt lgkmcnt(14)
    v_mfma_f32_16x16x32_bf16 v[108:111], a[144:147], v[188:191], 0
    v_cvt_pk_bf16_f32 v154, v216, v217
    v_cvt_pk_bf16_f32 v155, v218, v219
    v_mfma_f32_16x16x32_bf16 v[112:115], a[144:147], v[192:195], 0
    v_mov_b64 v[120:121], v[152:153]
    v_mov_b64 v[122:123], v[154:155]
    v_mfma_f32_16x16x32_bf16 v[116:119], a[144:147], v[196:199], 0
    v_accvgpr_write_b32 a252, v120
    v_accvgpr_write_b32 a253, v121
    v_accvgpr_write_b32 a254, v122
    v_accvgpr_write_b32 a255, v123
    v_mfma_f32_16x16x32_bf16 v[120:123], a[144:147], v[200:203], 0
    v_lshrrev_b32 v183, 2, v0
    v_lshlrev_b32 v183, 7, v183
    s_waitcnt lgkmcnt(12)
    v_mfma_f32_16x16x32_bf16 v[124:127], a[148:151], v[188:191], 0
    buffer_load_dword v181, v183, s[76:79], s80 offen
    buffer_load_dwordx4 v1, s[4:7], s16 offen lds
    v_mfma_f32_16x16x32_bf16 v[128:131], a[148:151], v[192:195], 0
    buffer_load_dwordx4 v1, s[8:11], s16 offen offset:1024 lds
    v_mfma_f32_16x16x32_bf16 v[132:135], a[148:151], v[196:199], 0
    s_add_u32 s16, s16, s17
    v_exp_f32 v12, v12
    v_mfma_f32_16x16x32_bf16 v[136:139], a[148:151], v[200:203], 0
    s_add_u32 s20, s16, s18
    v_exp_f32 v13, v13
    s_waitcnt lgkmcnt(10)
    v_mfma_f32_16x16x32_bf16 v[140:143], a[152:155], v[188:191], 0
    s_add_u32 s80, s80, 131072
    v_exp_f32 v14, v14
    v_mfma_f32_16x16x32_bf16 v[144:147], a[152:155], v[192:195], 0
    s_min_u32 m0, s19, s21
    v_exp_f32 v15, v15
    v_mfma_f32_16x16x32_bf16 v[148:151], a[152:155], v[196:199], 0
    s_min_u32 s16, s16, s20
    v_exp_f32 v16, v16
    v_mfma_f32_16x16x32_bf16 v[152:155], a[152:155], v[200:203], 0
    v_exp_f32 v17, v17
    s_waitcnt lgkmcnt(8)
    v_mfma_f32_16x16x32_bf16 v[156:159], a[156:159], v[188:191], 0
    v_exp_f32 v18, v18
    v_mfma_f32_16x16x32_bf16 v[160:163], a[156:159], v[192:195], 0
    v_exp_f32 v19, v19
    v_mfma_f32_16x16x32_bf16 v[164:167], a[156:159], v[196:199], 0
    v_exp_f32 v20, v20
    v_mfma_f32_16x16x32_bf16 v[168:171], a[156:159], v[200:203], 0
    v_exp_f32 v21, v21
    s_waitcnt lgkmcnt(6)
    v_mfma_f32_16x16x32_bf16 a[0:3], a[160:163], v[188:191], 0
    v_exp_f32 v22, v22
    v_mfma_f32_16x16x32_bf16 a[4:7], a[160:163], v[192:195], 0
    s_waitcnt vmcnt(10)
    s_barrier
    v_xor_b32 v5, s22, v8
    v_mfma_f32_16x16x32_bf16 a[8:11], a[160:163], v[196:199], 0
    ds_read_b128 a[144:147], v5 offset:0
    v_lshlrev_b32 v184, 9, v0
    v_mfma_f32_16x16x32_bf16 a[12:15], a[160:163], v[200:203], 0
    ds_read_b128 a[148:151], v5 offset:2048
    v_mov_b32 v186, 0
    s_waitcnt lgkmcnt(6)
    v_mfma_f32_16x16x32_bf16 a[16:19], a[164:167], v[188:191], 0
    ds_read_b128 a[152:155], v5 offset:4096
    v_cvt_pk_bf16_f32 v204, v12, v13
    v_mfma_f32_16x16x32_bf16 a[20:23], a[164:167], v[192:195], 0
    ds_read_b128 a[156:159], v5 offset:6144
    v_cvt_pk_bf16_f32 v205, v14, v15
    v_mfma_f32_16x16x32_bf16 a[24:27], a[164:167], v[196:199], 0
    v_exp_f32 v23, v23
    v_mfma_f32_16x16x32_bf16 a[28:31], a[164:167], v[200:203], 0
    v_exp_f32 v24, v24
    s_waitcnt lgkmcnt(6)
    v_mfma_f32_16x16x32_bf16 a[32:35], a[168:171], v[188:191], 0
    v_exp_f32 v25, v25
    v_mfma_f32_16x16x32_bf16 a[36:39], a[168:171], v[192:195], 0
    v_exp_f32 v26, v26
    v_mfma_f32_16x16x32_bf16 a[40:43], a[168:171], v[196:199], 0
    v_exp_f32 v27, v27
    v_mfma_f32_16x16x32_bf16 a[44:47], a[168:171], v[200:203], 0
    v_exp_f32 v28, v28
    s_waitcnt lgkmcnt(4)
    v_mfma_f32_16x16x32_bf16 a[48:51], a[172:175], v[188:191], 0
    v_exp_f32 v29, v29
    v_mfma_f32_16x16x32_bf16 a[52:55], a[172:175], v[192:195], 0
    v_exp_f32 v30, v30
    v_mfma_f32_16x16x32_bf16 a[56:59], a[172:175], v[196:199], 0
    v_exp_f32 v31, v31
    v_mfma_f32_16x16x32_bf16 a[60:63], a[172:175], v[200:203], 0
    v_exp_f32 v32, v32
    v_exp_f32 v33, v33
    v_exp_f32 v34, v34
    v_exp_f32 v35, v35
    v_exp_f32 v36, v36
    v_exp_f32 v37, v37
    v_exp_f32 v38, v38
    v_cvt_pk_bf16_f32 v208, v16, v17
    v_cvt_pk_bf16_f32 v209, v18, v19
    v_cvt_pk_bf16_f32 v212, v20, v21
    v_cvt_pk_bf16_f32 v213, v22, v23
    v_cvt_pk_bf16_f32 v216, v24, v25
    v_cvt_pk_bf16_f32 v217, v26, v27
    v_cvt_pk_bf16_f32 v206, v28, v29
    v_cvt_pk_bf16_f32 v207, v30, v31
    s_waitcnt lgkmcnt(2)
    s_waitcnt vmcnt(10)
    v_readfirstlane_b32 s34, v185
    s_nop 0
    s_cmp_eq_u32 s34, 0
    s_cbranch_scc1 TA_RP3
TA_RB4:
    s_mov_b32 s25, 6
    s_branch TA_At1e8
.p2align 3
TA_At17:
    v_mfma_f32_16x16x32_bf16 a[132:135], v[236:239], v[192:195], a[132:135]
    v_exp_f32 v21, v21
    v_mfma_f32_16x16x32_bf16 a[136:139], v[236:239], v[196:199], a[136:139]
    buffer_load_dwordx4 v1, s[4:7], s16 offen lds
    v_mfma_f32_16x16x32_bf16 a[140:143], v[236:239], v[200:203], a[140:143]
    ds_read_b64_tr_b16 a[156:157], v4 offset:3072
    s_waitcnt lgkmcnt(3)
    v_mfma_f32_16x16x32_bf16 v[108:111], a[144:147], v[188:191], v[108:111]
    ds_read_b64_tr_b16 a[158:159], v4 offset:11264
    v_cvt_pk_bf16_f32 v212, v20, v21
    v_mfma_f32_16x16x32_bf16 v[112:115], a[144:147], v[192:195], v[112:115]
    s_mov_b32 s23, s22
    v_exp_f32 v22, v22
    v_mfma_f32_16x16x32_bf16 v[116:119], a[144:147], v[196:199], v[116:119]
    s_add_u32 s22, s22, 16384
    v_exp_f32 v23, v23
    v_mfma_f32_16x16x32_bf16 v[120:123], a[144:147], v[200:203], v[120:123]
    ds_read_b64_tr_b16 a[160:161], v3 offset:5120
    v_cvt_pk_bf16_f32 v213, v22, v23
    v_mfma_f32_16x16x32_bf16 v[124:127], a[148:151], v[188:191], v[124:127]
    ds_read_b64_tr_b16 a[162:163], v3 offset:13312
    s_sub_u32 s24, s22, s99
    v_mfma_f32_16x16x32_bf16 v[128:131], a[148:151], v[192:195], v[128:131]
    s_min_u32 s22, s22, s24
    v_exp_f32 v24, v24
    v_mfma_f32_16x16x32_bf16 v[132:135], a[148:151], v[196:199], v[132:135]
    buffer_load_dwordx4 v1, s[8:11], s16 offen offset:1024 lds
    v_mfma_f32_16x16x32_bf16 v[136:139], a[148:151], v[200:203], v[136:139]
    ds_read_b64_tr_b16 a[164:165], v4 offset:5120
    s_waitcnt lgkmcnt(3)
    v_mfma_f32_16x16x32_bf16 v[140:143], a[152:155], v[188:191], v[140:143]
    ds_read_b64_tr_b16 a[166:167], v4 offset:13312
    s_add_u32 s19, m0, 8192
    v_mfma_f32_16x16x32_bf16 v[144:147], a[152:155], v[192:195], v[144:147]
    s_sub_u32 s21, s19, s99
    v_exp_f32 v25, v25
    v_mfma_f32_16x16x32_bf16 v[148:151], a[152:155], v[196:199], v[148:151]
    s_min_u32 m0, s19, s21
    v_exp_f32 v26, v26
    v_mfma_f32_16x16x32_bf16 v[152:155], a[152:155], v[200:203], v[152:155]
    ds_read_b64_tr_b16 a[168:169], v3 offset:7168
    v_cvt_pk_bf16_f32 v216, v24, v25
    v_mfma_f32_16x16x32_bf16 v[156:159], a[156:159], v[188:191], v[156:159]
    ds_read_b64_tr_b16 a[170:171], v3 offset:15360
    v_xor_b32 v5, s22, v8
    v_mfma_f32_16x16x32_bf16 v[160:163], a[156:159], v[192:195], v[160:163]
    s_add_u32 s16, s16, s17
    v_exp_f32 v27, v27
    v_mfma_f32_16x16x32_bf16 v[164:167], a[156:159], v[196:199], v[164:167]
    s_add_u32 s20, s16, s18
    v_exp_f32 v28, v28
    v_mfma_f32_16x16x32_bf16 v[168:171], a[156:159], v[200:203], v[168:171]
    ds_read_b64_tr_b16 a[172:173], v4 offset:7168
    s_waitcnt lgkmcnt(3)
    v_mfma_f32_16x16x32_bf16 a[0:3], a[160:163], v[188:191], a[0:3]
    ds_read_b64_tr_b16 a[174:175], v4 offset:15360
    v_cvt_pk_bf16_f32 v217, v26, v27
    v_mfma_f32_16x16x32_bf16 a[4:7], a[160:163], v[192:195], a[4:7]
    s_min_u32 s16, s16, s20
    v_exp_f32 v29, v29
    v_mfma_f32_16x16x32_bf16 a[8:11], a[160:163], v[196:199], a[8:11]
    s_waitcnt vmcnt(11)
    s_barrier
    v_cvt_pk_bf16_f32 v206, v28, v29
    v_mfma_f32_16x16x32_bf16 a[12:15], a[160:163], v[200:203], a[12:15]
    ds_read_b128 a[144:147], v5 offset:0
    v_mfma_f32_16x16x32_bf16 a[16:19], a[164:167], v[188:191], a[16:19]
    v_exp_f32 v30, v30
    v_mfma_f32_16x16x32_bf16 a[20:23], a[164:167], v[192:195], a[20:23]
    v_exp_f32 v31, v31
    v_mfma_f32_16x16x32_bf16 a[24:27], a[164:167], v[196:199], a[24:27]
    v_exp_f32 v32, v32
    v_mfma_f32_16x16x32_bf16 a[28:31], a[164:167], v[200:203], a[28:31]
    ds_read_b128 a[148:151], v5 offset:2048
    s_waitcnt lgkmcnt(2)
    v_mfma_f32_16x16x32_bf16 a[32:35], a[168:171], v[188:191], a[32:35]
    v_exp_f32 v33, v33
    v_mfma_f32_16x16x32_bf16 a[36:39], a[168:171], v[192:195], a[36:39]
    v_exp_f32 v34, v34
    v_mfma_f32_16x16x32_bf16 a[40:43], a[168:171], v[196:199], a[40:43]
    v_exp_f32 v35, v35
    v_mfma_f32_16x16x32_bf16 a[44:47], a[168:171], v[200:203], a[44:47]
    ds_read_b128 a[152:155], v5 offset:4096
    v_cvt_pk_bf16_f32 v207, v30, v31
    v_mfma_f32_16x16x32_bf16 a[48:51], a[172:175], v[188:191], a[48:51]
    v_exp_f32 v36, v36
    v_mfma_f32_16x16x32_bf16 a[52:55], a[172:175], v[192:195], a[52:55]
    v_exp_f32 v37, v37
    v_mfma_f32_16x16x32_bf16 a[56:59], a[172:175], v[196:199], a[56:59]
    v_exp_f32 v38, v38
    v_mfma_f32_16x16x32_bf16 a[60:63], a[172:175], v[200:203], a[60:63]
    ds_read_b128 a[156:159], v5 offset:6144
    s_waitcnt lgkmcnt(2)
TA_At1e8:
    v_mfma_f32_16x16x32_bf16 v[12:15], a[144:147], v[44:47], v[220:223]
    buffer_load_dwordx4 v1, s[4:7], s16 offen lds
    v_mfma_f32_16x16x32_bf16 v[16:19], a[144:147], v[48:51], v[224:227]
    v_exp_f32 v39, v39
    v_mfma_f32_16x16x32_bf16 v[20:23], a[144:147], v[52:55], v[228:231]
    v_exp_f32 v40, v40
    v_mfma_f32_16x16x32_bf16 v[24:27], a[144:147], v[56:59], v[232:235]
    ds_read_b128 a[160:163], v5 offset:8192
    v_cvt_pk_bf16_f32 v210, v32, v33
    v_mfma_f32_16x16x32_bf16 v[12:15], a[148:151], v[60:63], v[12:15]
    buffer_load_dword v186, off, s[12:15], s81 offset:256 sc1
    v_mfma_f32_16x16x32_bf16 v[16:19], a[148:151], v[64:67], v[16:19]
    v_exp_f32 v41, v41
    v_mfma_f32_16x16x32_bf16 v[20:23], a[148:151], v[68:71], v[20:23]
    v_exp_f32 v42, v42
    v_mfma_f32_16x16x32_bf16 v[24:27], a[148:151], v[72:75], v[24:27]
    ds_read_b128 a[164:167], v5 offset:10240
    s_waitcnt lgkmcnt(2)
    v_mfma_f32_16x16x32_bf16 v[12:15], a[152:155], v[76:79], v[12:15]
    buffer_load_dwordx4 v1, s[8:11], s16 offen offset:1024 lds
    v_mfma_f32_16x16x32_bf16 v[16:19], a[152:155], v[80:83], v[16:19]
    s_add_u32 s19, m0, 8192
    v_exp_f32 v43, v43
    v_mfma_f32_16x16x32_bf16 v[20:23], a[152:155], v[84:87], v[20:23]
    s_sub_u32 s21, s19, s99
    v_cvt_pk_bf16_f32 v214, v36, v37
    v_cvt_pk_bf16_f32 v215, v38, v39
    v_mfma_f32_16x16x32_bf16 v[24:27], a[152:155], v[88:91], v[24:27]
    ds_read_b128 a[168:171], v5 offset:12288
    v_cvt_pk_bf16_f32 v211, v34, v35
    v_mfma_f32_16x16x32_bf16 v[12:15], a[156:159], v[92:95], v[12:15]
    s_min_u32 m0, s19, s21
    v_cvt_pk_bf16_f32 v218, v40, v41
    v_cvt_pk_bf16_f32 v219, v42, v43
    v_mfma_f32_16x16x32_bf16 v[16:19], a[156:159], v[96:99], v[16:19]
    s_add_u32 s16, s16, s17
    s_add_u32 s20, s16, s18
    s_min_u32 s16, s16, s20
    v_mfma_f32_16x16x32_bf16 v[20:23], a[156:159], v[100:103], v[20:23]
    v_mfma_f32_16x16x32_bf16 v[24:27], a[156:159], v[104:107], v[24:27]
    ds_read_b128 a[172:175], v5 offset:14336
    s_waitcnt lgkmcnt(2)
    v_mfma_f32_16x16x32_bf16 v[28:31], a[160:163], v[44:47], v[220:223]
    v_xor_b32 v3, s23, v6
    v_xor_b32 v4, 32, v3
    v_mfma_f32_16x16x32_bf16 v[32:35], a[160:163], v[48:51], v[224:227]
    v_exp_f32 v12, v12
    v_mfma_f32_16x16x32_bf16 v[36:39], a[160:163], v[52:55], v[228:231]
    v_exp_f32 v13, v13
    v_mfma_f32_16x16x32_bf16 v[40:43], a[160:163], v[56:59], v[232:235]
    v_exp_f32 v14, v14
    v_mfma_f32_16x16x32_bf16 v[28:31], a[164:167], v[60:63], v[28:31]
    v_exp_f32 v15, v15
    v_mfma_f32_16x16x32_bf16 v[32:35], a[164:167], v[64:67], v[32:35]
    v_exp_f32 v16, v16
    v_mfma_f32_16x16x32_bf16 v[36:39], a[164:167], v[68:71], v[36:39]
    v_exp_f32 v17, v17
    v_mfma_f32_16x16x32_bf16 v[40:43], a[164:167], v[72:75], v[40:43]
    ds_read_b64_tr_b16 a[144:145], v3 offset:1024
    s_waitcnt lgkmcnt(1)
    v_mfma_f32_16x16x32_bf16 v[28:31], a[168:171], v[76:79], v[28:31]
    ds_read_b64_tr_b16 a[146:147], v3 offset:9216
    v_cvt_pk_bf16_f32 v188, v12, v13
    v_mfma_f32_16x16x32_bf16 v[32:35], a[168:171], v[80:83], v[32:35]
    v_exp_f32 v18, v18
    v_mfma_f32_16x16x32_bf16 v[36:39], a[168:171], v[84:87], v[36:39]
    v_exp_f32 v19, v19
    v_mfma_f32_16x16x32_bf16 v[40:43], a[168:171], v[88:91], v[40:43]
    ds_read_b64_tr_b16 a[148:149], v4 offset:1024
    v_cvt_pk_bf16_f32 v189, v14, v15
    v_mfma_f32_16x16x32_bf16 v[28:31], a[172:175], v[92:95], v[28:31]
    ds_read_b64_tr_b16 a[150:151], v4 offset:9216
    v_cvt_pk_bf16_f32 v192, v16, v17
    v_mfma_f32_16x16x32_bf16 v[32:35], a[172:175], v[96:99], v[32:35]
    v_exp_f32 v20, v20
    v_mfma_f32_16x16x32_bf16 v[36:39], a[172:175], v[100:103], v[36:39]
    v_exp_f32 v21, v21
    v_mfma_f32_16x16x32_bf16 v[40:43], a[172:175], v[104:107], v[40:43]
    ds_read_b64_tr_b16 a[152:153], v3 offset:3072
    v_cvt_pk_bf16_f32 v193, v18, v19
    v_mfma_f32_16x16x32_bf16 a[128:131], v[236:239], v[204:207], a[128:131]
    ds_read_b64_tr_b16 a[154:155], v3 offset:11264
    v_cvt_pk_bf16_f32 v196, v20, v21
    v_mfma_f32_16x16x32_bf16 a[132:135], v[236:239], v[208:211], a[132:135]
    v_exp_f32 v22, v22
    v_mfma_f32_16x16x32_bf16 a[136:139], v[236:239], v[212:215], a[136:139]
    buffer_load_dwordx4 v1, s[4:7], s16 offen lds
    v_mfma_f32_16x16x32_bf16 a[140:143], v[236:239], v[216:219], a[140:143]
    ds_read_b64_tr_b16 a[156:157], v4 offset:3072
    s_waitcnt lgkmcnt(3)
    v_mfma_f32_16x16x32_bf16 v[108:111], a[144:147], v[204:207], v[108:111]
    ds_read_b64_tr_b16 a[158:159], v4 offset:11264
    v_mfma_f32_16x16x32_bf16 v[112:115], a[144:147], v[208:211], v[112:115]
    v_exp_f32 v23, v23
    v_mfma_f32_16x16x32_bf16 v[116:119], a[144:147], v[212:215], v[116:119]
    v_exp_f32 v24, v24
    v_mfma_f32_16x16x32_bf16 v[120:123], a[144:147], v[216:219], v[120:123]
    ds_read_b64_tr_b16 a[160:161], v3 offset:5120
    v_cvt_pk_bf16_f32 v197, v22, v23
    v_mfma_f32_16x16x32_bf16 v[124:127], a[148:151], v[204:207], v[124:127]
    ds_read_b64_tr_b16 a[162:163], v3 offset:13312
    v_mfma_f32_16x16x32_bf16 v[128:131], a[148:151], v[208:211], v[128:131]
    v_exp_f32 v25, v25
    v_mfma_f32_16x16x32_bf16 v[132:135], a[148:151], v[212:215], v[132:135]
    buffer_load_dwordx4 v1, s[8:11], s16 offen offset:1024 lds
    v_mfma_f32_16x16x32_bf16 v[136:139], a[148:151], v[216:219], v[136:139]
    ds_read_b64_tr_b16 a[164:165], v4 offset:5120
    s_waitcnt lgkmcnt(3)
    v_mfma_f32_16x16x32_bf16 v[140:143], a[152:155], v[204:207], v[140:143]
    ds_read_b64_tr_b16 a[166:167], v4 offset:13312
    v_cvt_pk_bf16_f32 v200, v24, v25
    v_mfma_f32_16x16x32_bf16 v[144:147], a[152:155], v[208:211], v[144:147]
    s_mov_b32 s23, s22
    v_exp_f32 v26, v26
    v_mfma_f32_16x16x32_bf16 v[148:151], a[152:155], v[212:215], v[148:151]
    s_add_u32 s22, s22, 16384
    s_sub_u32 s24, s22, s99
    s_min_u32 s22, s22, s24
    v_exp_f32 v27, v27
    v_mfma_f32_16x16x32_bf16 v[152:155], a[152:155], v[216:219], v[152:155]
    ds_read_b64_tr_b16 a[168:169], v3 offset:7168
    v_cvt_pk_bf16_f32 v201, v26, v27
    v_mfma_f32_16x16x32_bf16 v[156:159], a[156:159], v[204:207], v[156:159]
    ds_read_b64_tr_b16 a[170:171], v3 offset:15360
    v_xor_b32 v5, s22, v8
    v_mfma_f32_16x16x32_bf16 v[160:163], a[156:159], v[208:211], v[160:163]
    s_add_u32 s19, m0, 8192
    v_exp_f32 v28, v28
    v_mfma_f32_16x16x32_bf16 v[164:167], a[156:159], v[212:215], v[164:167]
    s_sub_u32 s21, s19, s99
    v_exp_f32 v29, v29
    v_mfma_f32_16x16x32_bf16 v[168:171], a[156:159], v[216:219], v[168:171]
    ds_read_b64_tr_b16 a[172:173], v4 offset:7168
    s_waitcnt lgkmcnt(3)
    v_mfma_f32_16x16x32_bf16 a[0:3], a[160:163], v[204:207], a[0:3]
    ds_read_b64_tr_b16 a[174:175], v4 offset:15360
    v_cvt_pk_bf16_f32 v190, v28, v29
    v_mfma_f32_16x16x32_bf16 a[4:7], a[160:163], v[208:211], a[4:7]
    s_min_u32 m0, s19, s21
    v_exp_f32 v30, v30
    v_mfma_f32_16x16x32_bf16 a[8:11], a[160:163], v[212:215], a[8:11]
    s_waitcnt vmcnt(11)
    s_barrier
    s_add_u32 s16, s16, s17
    v_mfma_f32_16x16x32_bf16 a[12:15], a[160:163], v[216:219], a[12:15]
    ds_read_b128 a[144:147], v5 offset:0
    s_add_u32 s20, s16, s18
    v_mfma_f32_16x16x32_bf16 a[16:19], a[164:167], v[204:207], a[16:19]
    s_min_u32 s16, s16, s20
    v_exp_f32 v31, v31
    v_mfma_f32_16x16x32_bf16 a[20:23], a[164:167], v[208:211], a[20:23]
    v_exp_f32 v32, v32
    v_mfma_f32_16x16x32_bf16 a[24:27], a[164:167], v[212:215], a[24:27]
    v_exp_f32 v33, v33
    v_mfma_f32_16x16x32_bf16 a[28:31], a[164:167], v[216:219], a[28:31]
    ds_read_b128 a[148:151], v5 offset:2048
    s_waitcnt lgkmcnt(2)
    v_mfma_f32_16x16x32_bf16 a[32:35], a[168:171], v[204:207], a[32:35]
    v_exp_f32 v34, v34
    v_mfma_f32_16x16x32_bf16 a[36:39], a[168:171], v[208:211], a[36:39]
    v_exp_f32 v35, v35
    v_mfma_f32_16x16x32_bf16 a[40:43], a[168:171], v[212:215], a[40:43]
    v_exp_f32 v36, v36
    v_mfma_f32_16x16x32_bf16 a[44:47], a[168:171], v[216:219], a[44:47]
    ds_read_b128 a[152:155], v5 offset:4096
    v_cvt_pk_bf16_f32 v191, v30, v31
    v_mfma_f32_16x16x32_bf16 a[48:51], a[172:175], v[204:207], a[48:51]
    v_exp_f32 v37, v37
    v_mfma_f32_16x16x32_bf16 a[52:55], a[172:175], v[208:211], a[52:55]
    v_exp_f32 v38, v38
    v_mfma_f32_16x16x32_bf16 a[56:59], a[172:175], v[212:215], a[56:59]
    v_exp_f32 v39, v39
    v_mfma_f32_16x16x32_bf16 a[60:63], a[172:175], v[216:219], a[60:63]
    ds_read_b128 a[156:159], v5 offset:6144
    s_waitcnt lgkmcnt(2)
    v_mfma_f32_16x16x32_bf16 v[12:15], a[144:147], v[44:47], v[220:223]
    s_cmp_eq_u32 s25, 1
    s_cselect_b32 s16, 524288, s16
    v_mfma_f32_16x16x32_bf16 v[16:19], a[144:147], v[48:51], v[224:227]
    buffer_load_dwordx4 v1, s[4:7], s16 offen lds
    v_mfma_f32_16x16x32_bf16 v[20:23], a[144:147], v[52:55], v[228:231]
    v_exp_f32 v40, v40
    v_mfma_f32_16x16x32_bf16 v[24:27], a[144:147], v[56:59], v[232:235]
    ds_read_b128 a[160:163], v5 offset:8192
    v_cvt_pk_bf16_f32 v194, v32, v33
    v_mfma_f32_16x16x32_bf16 v[12:15], a[148:151], v[60:63], v[12:15]
    buffer_load_dword v181, v180, s[72:75], s71 offen
    v_mfma_f32_16x16x32_bf16 v[16:19], a[148:151], v[64:67], v[16:19]
    s_add_u32 s71, s71, 16384
    v_exp_f32 v41, v41
    v_mfma_f32_16x16x32_bf16 v[20:23], a[148:151], v[68:71], v[20:23]
    v_exp_f32 v42, v42
    v_mfma_f32_16x16x32_bf16 v[24:27], a[148:151], v[72:75], v[24:27]
    ds_read_b128 a[164:167], v5 offset:10240
    s_waitcnt lgkmcnt(2)
    v_mfma_f32_16x16x32_bf16 v[12:15], a[152:155], v[76:79], v[12:15]
    v_exp_f32 v43, v43
    v_mfma_f32_16x16x32_bf16 v[16:19], a[152:155], v[80:83], v[16:19]
    buffer_load_dwordx4 v1, s[8:11], s16 offen offset:1024 lds
    v_mfma_f32_16x16x32_bf16 v[20:23], a[152:155], v[84:87], v[20:23]
    s_add_u32 s19, m0, 8192
    v_cvt_pk_bf16_f32 v198, v36, v37
    v_cvt_pk_bf16_f32 v199, v38, v39
    v_mfma_f32_16x16x32_bf16 v[24:27], a[152:155], v[88:91], v[24:27]
    ds_read_b128 a[168:171], v5 offset:12288
    v_cvt_pk_bf16_f32 v195, v34, v35
    v_mfma_f32_16x16x32_bf16 v[12:15], a[156:159], v[92:95], v[12:15]
    s_sub_u32 s21, s19, s99
    v_cvt_pk_bf16_f32 v202, v40, v41
    v_cvt_pk_bf16_f32 v203, v42, v43
    v_mfma_f32_16x16x32_bf16 v[16:19], a[156:159], v[96:99], v[16:19]
    s_min_u32 m0, s19, s21
    s_add_u32 s16, s16, s17
    s_add_u32 s20, s16, s18
    v_mfma_f32_16x16x32_bf16 v[20:23], a[156:159], v[100:103], v[20:23]
    s_min_u32 s16, s16, s20
    v_mfma_f32_16x16x32_bf16 v[24:27], a[156:159], v[104:107], v[24:27]
    ds_read_b128 a[172:175], v5 offset:14336
    s_waitcnt lgkmcnt(2)
    v_mfma_f32_16x16x32_bf16 v[28:31], a[160:163], v[44:47], v[220:223]
    v_exp_f32 v12, v12
    v_mfma_f32_16x16x32_bf16 v[32:35], a[160:163], v[48:51], v[224:227]
    v_exp_f32 v13, v13
    v_mfma_f32_16x16x32_bf16 v[36:39], a[160:163], v[52:55], v[228:231]
    v_exp_f32 v14, v14
    v_mfma_f32_16x16x32_bf16 v[40:43], a[160:163], v[56:59], v[232:235]
    v_exp_f32 v15, v15
    v_mfma_f32_16x16x32_bf16 v[28:31], a[164:167], v[60:63], v[28:31]
    v_exp_f32 v16, v16
    v_mfma_f32_16x16x32_bf16 v[32:35], a[164:167], v[64:67], v[32:35]
    buffer_load_dword v181, v183, s[76:79], s80 offen
    v_mfma_f32_16x16x32_bf16 v[36:39], a[164:167], v[68:71], v[36:39]
    s_add_u32 s80, s80, 131072
    v_xor_b32 v3, s23, v6
    v_xor_b32 v4, 32, v3
    v_mfma_f32_16x16x32_bf16 v[40:43], a[164:167], v[72:75], v[40:43]
    ds_read_b64_tr_b16 a[144:145], v3 offset:1024
    s_waitcnt lgkmcnt(1)
    v_mfma_f32_16x16x32_bf16 v[28:31], a[168:171], v[76:79], v[28:31]
    ds_read_b64_tr_b16 a[146:147], v3 offset:9216
    v_cvt_pk_bf16_f32 v204, v12, v13
    v_mfma_f32_16x16x32_bf16 v[32:35], a[168:171], v[80:83], v[32:35]
    v_exp_f32 v17, v17
    v_mfma_f32_16x16x32_bf16 v[36:39], a[168:171], v[84:87], v[36:39]
    v_exp_f32 v18, v18
    v_mfma_f32_16x16x32_bf16 v[40:43], a[168:171], v[88:91], v[40:43]
    ds_read_b64_tr_b16 a[148:149], v4 offset:1024
    v_cvt_pk_bf16_f32 v205, v14, v15
    v_mfma_f32_16x16x32_bf16 v[28:31], a[172:175], v[92:95], v[28:31]
    ds_read_b64_tr_b16 a[150:151], v4 offset:9216
    v_cvt_pk_bf16_f32 v208, v16, v17
    v_mfma_f32_16x16x32_bf16 v[32:35], a[172:175], v[96:99], v[32:35]
    v_exp_f32 v19, v19
    v_mfma_f32_16x16x32_bf16 v[36:39], a[172:175], v[100:103], v[36:39]
    v_exp_f32 v20, v20
    v_mfma_f32_16x16x32_bf16 v[40:43], a[172:175], v[104:107], v[40:43]
    ds_read_b64_tr_b16 a[152:153], v3 offset:3072
    v_cvt_pk_bf16_f32 v209, v18, v19
    v_mfma_f32_16x16x32_bf16 a[128:131], v[236:239], v[188:191], a[128:131]
    ds_read_b64_tr_b16 a[154:155], v3 offset:11264
    s_sub_u32 s25, s25, 1
    s_cbranch_scc0 TA_At17
    v_readfirstlane_b32 s34, v186
    s_nop 0
    s_cmp_eq_u32 s34, 0
    s_cbranch_scc1 TA_QP5
TA_QB6:
    v_mfma_f32_16x16x32_bf16 a[132:135], v[236:239], v[192:195], a[132:135]
    s_and_b32 s33, s30, 7
    s_lshl_b32 s34, s29, 3
    s_add_u32 s33, s33, s34
    v_mfma_f32_16x16x32_bf16 a[136:139], v[236:239], v[196:199], a[136:139]
    s_lshl_b32 s33, s33, 2
    s_add_u32 s33, s33, s26
    s_lshl_b32 s33, s33, 14
    v_mfma_f32_16x16x32_bf16 a[140:143], v[236:239], v[200:203], a[140:143]
    s_add_u32 s33, s33, 63963136
    ds_read_b64_tr_b16 a[156:157], v4 offset:3072
    s_waitcnt lgkmcnt(5)
    v_mfma_f32_16x16x32_bf16 v[108:111], a[144:147], v[188:191], v[108:111]
    buffer_load_dwordx4 a[192:195], v9, s[12:15], s33 offen offset:0 sc1
    v_mfma_f32_16x16x32_bf16 v[112:115], a[144:147], v[192:195], v[112:115]
    buffer_load_dwordx4 a[196:199], v9, s[12:15], s33 offen offset:1024 sc1
    v_mfma_f32_16x16x32_bf16 v[116:119], a[144:147], v[196:199], v[116:119]
    buffer_load_dwordx4 a[200:203], v9, s[12:15], s33 offen offset:2048 sc1
    v_mfma_f32_16x16x32_bf16 v[120:123], a[144:147], v[200:203], v[120:123]
    buffer_load_dwordx4 a[204:207], v9, s[12:15], s33 offen offset:3072 sc1
    s_waitcnt lgkmcnt(3)
    v_mfma_f32_16x16x32_bf16 v[124:127], a[148:151], v[188:191], v[124:127]
    s_add_u32 s33, s33, 4096
    buffer_load_dwordx4 a[208:211], v9, s[12:15], s33 offen offset:0 sc1
    ds_read_b64_tr_b16 a[158:159], v4 offset:11264
    buffer_load_dwordx4 a[212:215], v9, s[12:15], s33 offen offset:1024 sc1
    buffer_load_dwordx4 a[216:219], v9, s[12:15], s33 offen offset:2048 sc1
    buffer_load_dwordx4 a[220:223], v9, s[12:15], s33 offen offset:3072 sc1
    s_add_u32 s33, s33, 4096
    buffer_load_dwordx4 a[224:227], v9, s[12:15], s33 offen offset:0 sc1
    buffer_load_dwordx4 a[228:231], v9, s[12:15], s33 offen offset:1024 sc1
    buffer_load_dwordx4 a[232:235], v9, s[12:15], s33 offen offset:2048 sc1
    buffer_load_dwordx4 a[236:239], v9, s[12:15], s33 offen offset:3072 sc1
    buffer_load_dwordx4 v1, s[4:7], s16 offen lds
    v_mfma_f32_16x16x32_bf16 v[128:131], a[148:151], v[192:195], v[128:131]
    ds_read_b64_tr_b16 a[160:161], v3 offset:5120
    s_add_u32 s19, m0, 8192
    v_mfma_f32_16x16x32_bf16 v[132:135], a[148:151], v[196:199], v[132:135]
    ds_read_b64_tr_b16 a[162:163], v3 offset:13312
    s_sub_u32 s21, s19, s99
    v_mfma_f32_16x16x32_bf16 v[136:139], a[148:151], v[200:203], v[136:139]
    ds_read_b64_tr_b16 a[164:165], v4 offset:5120
    s_mov_b32 s23, s22
    s_waitcnt lgkmcnt(5)
    v_mfma_f32_16x16x32_bf16 v[140:143], a[152:155], v[188:191], v[140:143]
    ds_read_b64_tr_b16 a[166:167], v4 offset:13312
    v_mfma_f32_16x16x32_bf16 v[144:147], a[152:155], v[192:195], v[144:147]
    buffer_load_dwordx4 v1, s[8:11], s16 offen offset:1024 lds
    v_mfma_f32_16x16x32_bf16 v[148:151], a[152:155], v[196:199], v[148:151]
    ds_read_b64_tr_b16 a[168:169], v3 offset:7168
    s_add_u32 s16, s16, s17
    v_mfma_f32_16x16x32_bf16 v[152:155], a[152:155], v[200:203], v[152:155]
    ds_read_b64_tr_b16 a[170:171], v3 offset:15360
    s_add_u32 s20, s16, s18
    s_waitcnt lgkmcnt(6)
    v_mfma_f32_16x16x32_bf16 v[156:159], a[156:159], v[188:191], v[156:159]
    ds_read_b64_tr_b16 a[172:173], v4 offset:7168
    s_min_u32 m0, s19, s21
    v_mfma_f32_16x16x32_bf16 v[160:163], a[156:159], v[192:195], v[160:163]
    ds_read_b64_tr_b16 a[174:175], v4 offset:15360
    s_min_u32 s16, s16, s20
    v_mfma_f32_16x16x32_bf16 v[164:167], a[156:159], v[196:199], v[164:167]
    s_add_u32 s19, m0, 8192
    v_exp_f32 v28, v28
    v_mfma_f32_16x16x32_bf16 v[168:171], a[156:159], v[200:203], v[168:171]
    s_sub_u32 s21, s19, s99
    v_exp_f32 v29, v29
    s_waitcnt lgkmcnt(6)
    v_mfma_f32_16x16x32_bf16 a[0:3], a[160:163], v[188:191], a[0:3]
    v_exp_f32 v30, v30
    v_mfma_f32_16x16x32_bf16 a[4:7], a[160:163], v[192:195], a[4:7]
    s_barrier
    v_cvt_pk_bf16_f32 v206, v28, v29
    v_mfma_f32_16x16x32_bf16 a[8:11], a[160:163], v[196:199], a[8:11]
    buffer_load_dwordx4 v1, s[4:7], s16 offen lds
    v_mfma_f32_16x16x32_bf16 a[12:15], a[160:163], v[200:203], a[12:15]
    buffer_load_dwordx4 v1, s[8:11], s16 offen offset:1024 lds
    s_waitcnt lgkmcnt(4)
    v_mfma_f32_16x16x32_bf16 a[16:19], a[164:167], v[188:191], a[16:19]
    s_add_u32 s16, s16, s17
    v_exp_f32 v31, v31
    v_mfma_f32_16x16x32_bf16 a[20:23], a[164:167], v[192:195], a[20:23]
    s_add_u32 s20, s16, s18
    v_cvt_pk_bf16_f32 v207, v30, v31
    s_min_u32 m0, s19, s21
    v_mfma_f32_16x16x32_bf16 a[24:27], a[164:167], v[196:199], a[24:27]
    s_min_u32 s16, s16, s20
    v_exp_f32 v32, v32
    v_mfma_f32_16x16x32_bf16 a[28:31], a[164:167], v[200:203], a[28:31]
    v_exp_f32 v33, v33
    s_waitcnt lgkmcnt(2)
    v_mfma_f32_16x16x32_bf16 a[32:35], a[168:171], v[188:191], a[32:35]
    v_exp_f32 v34, v34
    v_mfma_f32_16x16x32_bf16 a[36:39], a[168:171], v[192:195], a[36:39]
    v_exp_f32 v35, v35
    v_mfma_f32_16x16x32_bf16 a[40:43], a[168:171], v[196:199], a[40:43]
    v_cvt_pk_bf16_f32 v210, v32, v33
    v_cvt_pk_bf16_f32 v211, v34, v35
    v_mfma_f32_16x16x32_bf16 a[44:47], a[168:171], v[200:203], a[44:47]
    v_exp_f32 v21, v21
    s_waitcnt lgkmcnt(0)
    v_mfma_f32_16x16x32_bf16 a[48:51], a[172:175], v[188:191], a[48:51]
    v_exp_f32 v22, v22
    v_mfma_f32_16x16x32_bf16 a[52:55], a[172:175], v[192:195], a[52:55]
    v_exp_f32 v23, v23
    v_mfma_f32_16x16x32_bf16 a[56:59], a[172:175], v[196:199], a[56:59]
    v_exp_f32 v36, v36
    v_mfma_f32_16x16x32_bf16 a[60:63], a[172:175], v[200:203], a[60:63]
    v_exp_f32 v37, v37
    v_mfma_f32_16x16x32_bf16 a[128:131], v[236:239], v[204:207], a[128:131]
    v_exp_f32 v38, v38
    v_mfma_f32_16x16x32_bf16 a[132:135], v[236:239], v[208:211], a[132:135]
    buffer_load_dwordx4 v1, s[4:7], s16 offen lds
    v_exp_f32 v39, v39
    v_cvt_pk_bf16_f32 v212, v20, v21
    v_cvt_pk_bf16_f32 v213, v22, v23
    v_cvt_pk_bf16_f32 v214, v36, v37
    v_cvt_pk_bf16_f32 v215, v38, v39
    v_exp_f32 v24, v24
    s_nop 0
    v_mfma_f32_16x16x32_bf16 a[136:139], v[236:239], v[212:215], a[136:139]
    v_exp_f32 v25, v25
    v_exp_f32 v26, v26
    v_exp_f32 v27, v27
    v_exp_f32 v40, v40
    v_exp_f32 v41, v41
    v_exp_f32 v42, v42
    v_exp_f32 v43, v43
    v_cvt_pk_bf16_f32 v216, v24, v25
    v_cvt_pk_bf16_f32 v217, v26, v27
    v_cvt_pk_bf16_f32 v218, v40, v41
    v_cvt_pk_bf16_f32 v219, v42, v43
    v_xor_b32 v3, s23, v6
    v_accvgpr_read_b32 v240, a128
    v_mfma_f32_16x16x32_bf16 a[140:143], v[236:239], v[216:219], a[140:143]
    ds_read_b64_tr_b16 a[144:145], v3 offset:1024
    v_accvgpr_read_b32 v241, a132
    v_accvgpr_read_b32 v242, a136
    v_xor_b32 v4, 32, v3
    v_add_f32 v245, v240, v241
    ds_read_b64_tr_b16 a[146:147], v3 offset:9216
    ds_read_b64_tr_b16 a[148:149], v4 offset:1024
    s_nop 0
    v_accvgpr_read_b32 v243, a140
    v_add_f32 v244, v242, v243
    v_add_f32 v244, v244, v245
    v_cmp_ngt_f32 vcc, 1233125376, v244
    ds_read_b64_tr_b16 a[150:151], v4 offset:9216
    ds_read_b64_tr_b16 a[152:153], v3 offset:3072
    ds_read_b64_tr_b16 a[154:155], v3 offset:11264
    s_nop 3
    s_cbranch_vccnz TA_At1slow9
TA_At1norm10:
    s_waitcnt lgkmcnt(4)
    v_mfma_f32_16x16x32_bf16 v[108:111], a[144:147], v[204:207], v[108:111]
    ds_read_b64_tr_b16 a[156:157], v4 offset:3072
    s_mov_b32 s22, 49152
    v_mfma_f32_16x16x32_bf16 v[112:115], a[144:147], v[208:211], v[112:115]
    ds_read_b64_tr_b16 a[158:159], v4 offset:11264
    v_xor_b32 v5, s22, v8
    v_mfma_f32_16x16x32_bf16 v[116:119], a[144:147], v[212:215], v[116:119]
    ds_read_b64_tr_b16 a[160:161], v3 offset:5120
    s_mov_b32 s23, s22
    v_mfma_f32_16x16x32_bf16 v[120:123], a[144:147], v[216:219], v[120:123]
    ds_read_b64_tr_b16 a[162:163], v3 offset:13312
    s_add_u32 s22, s22, 16384
    s_waitcnt lgkmcnt(6)
    v_mfma_f32_16x16x32_bf16 v[124:127], a[148:151], v[204:207], v[124:127]
    ds_read_b64_tr_b16 a[164:165], v4 offset:5120
    s_sub_u32 s24, s22, s99
    v_mfma_f32_16x16x32_bf16 v[128:131], a[148:151], v[208:211], v[128:131]
    ds_read_b64_tr_b16 a[166:167], v4 offset:13312
    s_min_u32 s22, s22, s24
    v_mfma_f32_16x16x32_bf16 v[132:135], a[148:151], v[212:215], v[132:135]
    buffer_load_dwordx4 v1, s[8:11], s16 offen offset:1024 lds
    v_mfma_f32_16x16x32_bf16 v[136:139], a[148:151], v[216:219], v[136:139]
    ds_read_b64_tr_b16 a[168:169], v3 offset:7168
    s_add_u32 s19, m0, 8192
    s_waitcnt lgkmcnt(7)
    v_mfma_f32_16x16x32_bf16 v[140:143], a[152:155], v[204:207], v[140:143]
    ds_read_b64_tr_b16 a[170:171], v3 offset:15360
    s_add_u32 s16, s16, s17
    v_mfma_f32_16x16x32_bf16 v[144:147], a[152:155], v[208:211], v[144:147]
    ds_read_b64_tr_b16 a[172:173], v4 offset:7168
    s_sub_u32 s21, s19, s99
    v_mfma_f32_16x16x32_bf16 v[148:151], a[152:155], v[212:215], v[148:151]
    ds_read_b64_tr_b16 a[174:175], v4 offset:15360
    s_add_u32 s20, s16, s18
    v_mfma_f32_16x16x32_bf16 v[152:155], a[152:155], v[216:219], v[152:155]
    s_min_u32 m0, s19, s21
    s_min_u32 s16, s16, s20
    s_lshl_b32 s96, s54, 7
    s_waitcnt lgkmcnt(8)
    v_mfma_f32_16x16x32_bf16 v[156:159], a[156:159], v[204:207], v[156:159]
    s_and_b32 s98, s29, 7
    s_mul_i32 s96, s96, 1152
    s_lshl_b32 s98, s98, 2
    v_mfma_f32_16x16x32_bf16 v[160:163], a[156:159], v[208:211], v[160:163]
    s_add_u32 s96, s46, s96
    s_addc_u32 s97, s47, 0
    s_add_u32 s98, s98, s26
    v_mfma_f32_16x16x32_bf16 v[164:167], a[156:159], v[212:215], v[164:167]
    s_mov_b32 s76, s96
    v_lshrrev_b32 v183, 1, v0
    s_mov_b32 s77, s97
    v_mfma_f32_16x16x32_bf16 v[168:171], a[156:159], v[216:219], v[168:171]
    s_mov_b32 s78, 589824
    s_mov_b32 s79, 0x00020000
    s_mul_i32 s80, s98, 4096
    s_waitcnt lgkmcnt(6)
    v_mfma_f32_16x16x32_bf16 a[0:3], a[160:163], v[204:207], a[0:3]
    s_waitcnt vmcnt(27)
    s_barrier
    v_lshlrev_b32 v183, 7, v183
    v_mfma_f32_16x16x32_bf16 a[4:7], a[160:163], v[208:211], a[4:7]
    ds_read_b128 a[144:147], v5 offset:0
    v_xor_b32 v3, s23, v6
    v_mfma_f32_16x16x32_bf16 a[8:11], a[160:163], v[212:215], a[8:11]
    ds_read_b128 a[148:151], v5 offset:2048
    v_xor_b32 v4, 32, v3
    v_mfma_f32_16x16x32_bf16 a[12:15], a[160:163], v[216:219], a[12:15]
    ds_read_b128 a[152:155], v5 offset:4096
    v_mov_b32 v236, 0x3f803f80
    s_waitcnt lgkmcnt(7)
    v_mfma_f32_16x16x32_bf16 a[16:19], a[164:167], v[204:207], a[16:19]
    ds_read_b128 a[156:159], v5 offset:6144
    v_mov_b32 v237, 0x3f803f80
    v_mfma_f32_16x16x32_bf16 a[20:23], a[164:167], v[208:211], a[20:23]
    ds_read_b128 a[160:163], v5 offset:8192
    v_mov_b32 v238, 0x3f803f80
    v_mfma_f32_16x16x32_bf16 a[24:27], a[164:167], v[212:215], a[24:27]
    s_waitcnt vmcnt(22)
    s_barrier
    v_mov_b32 v239, 0x3f803f80
    v_mfma_f32_16x16x32_bf16 a[28:31], a[164:167], v[216:219], a[28:31]
    ds_read_b128 a[164:167], v5 offset:10240
    v_accvgpr_read_b32 v240, a128
    s_waitcnt lgkmcnt(8)
    v_mfma_f32_16x16x32_bf16 a[32:35], a[168:171], v[204:207], a[32:35]
    s_add_u32 s19, m0, 8192
    v_accvgpr_read_b32 v242, a132
    v_accvgpr_read_b32 v244, a136
    v_mfma_f32_16x16x32_bf16 a[36:39], a[168:171], v[208:211], a[36:39]
    s_sub_u32 s21, s19, s99
    v_rcp_f32 v240, v240
    v_mfma_f32_16x16x32_bf16 a[40:43], a[168:171], v[212:215], a[40:43]
    s_mul_i32 s32, s29, 2359296
    v_accvgpr_read_b32 v246, a140
    v_mul_f32 v108, v108, v240
    v_mfma_f32_16x16x32_bf16 a[44:47], a[168:171], v[216:219], a[44:47]
    ds_read_b128 a[168:171], v5 offset:12288
    v_mul_f32 v109, v109, v240
    s_waitcnt lgkmcnt(7)
    v_mfma_f32_16x16x32_bf16 a[48:51], a[172:175], v[204:207], a[48:51]
    s_mul_i32 s34, s30, 147456
    v_mul_f32 v110, v110, v240
    v_mul_f32 v111, v111, v240
    v_mfma_f32_16x16x32_bf16 a[52:55], a[172:175], v[208:211], a[52:55]
    s_add_u32 s32, s32, s34
    v_cvt_pk_bf16_f32 v108, v108, v109
    v_cvt_pk_bf16_f32 v109, v110, v111
    v_mfma_f32_16x16x32_bf16 a[56:59], a[172:175], v[212:215], a[56:59]
    s_add_u32 s32, s32, 4194304
    v_rcp_f32 v242, v242
    v_mfma_f32_16x16x32_bf16 a[60:63], a[172:175], v[216:219], a[60:63]
    ds_read_b128 a[172:175], v5 offset:14336
    v_xor_b32 v5, s22, v8
    s_waitcnt vmcnt(17) lgkmcnt(7)
    v_mfma_f32_16x16x32_bf16 v[12:15], a[144:147], a[192:195], 0
    s_mul_i32 s34, s26, 12288
    v_mul_f32 v124, v124, v240
    v_mul_f32 v125, v125, v240
    s_waitcnt vmcnt(16)
    v_mfma_f32_16x16x32_bf16 v[16:19], a[144:147], a[196:199], 0
    s_mov_b32 s23, s22
    v_mul_f32 v126, v126, v240
    v_mul_f32 v127, v127, v240
    s_waitcnt vmcnt(15)
    v_mfma_f32_16x16x32_bf16 v[20:23], a[144:147], a[200:203], 0
    s_add_u32 s32, s32, s34
    v_add_u32 v182, s70, v9
    v_cvt_pk_bf16_f32 v110, v124, v125
    s_waitcnt vmcnt(14)
    v_mfma_f32_16x16x32_bf16 v[24:27], a[144:147], a[204:207], 0
    ds_read_b128 a[144:147], v5 offset:0
    v_cvt_pk_bf16_f32 v111, v126, v127
    s_waitcnt vmcnt(13) lgkmcnt(7)
    v_mfma_f32_16x16x32_bf16 v[12:15], a[148:151], a[208:211], v[12:15]
    ds_write_b128 v182, v[108:111] offset:0
    s_waitcnt vmcnt(12)
    v_mfma_f32_16x16x32_bf16 v[16:19], a[148:151], a[212:215], v[16:19]
    s_add_u32 s22, s22, 16384
    v_mul_f32 v112, v112, v242
    v_mul_f32 v113, v113, v242
    s_waitcnt vmcnt(11)
    v_mfma_f32_16x16x32_bf16 v[20:23], a[148:151], a[216:219], v[20:23]
    s_sub_u32 s24, s22, s99
    v_mul_f32 v114, v114, v242
    v_mul_f32 v115, v115, v242
    s_waitcnt vmcnt(10)
    v_mfma_f32_16x16x32_bf16 v[24:27], a[148:151], a[220:223], v[24:27]
    ds_read_b128 a[148:151], v5 offset:2048
    v_cvt_pk_bf16_f32 v112, v112, v113
    s_waitcnt vmcnt(9) lgkmcnt(8)
    v_mfma_f32_16x16x32_bf16 v[12:15], a[152:155], a[224:227], v[12:15]
    s_lshl_b32 s34, s28, 15
    v_rcp_f32 v244, v244
    s_waitcnt vmcnt(8)
    v_mfma_f32_16x16x32_bf16 v[16:19], a[152:155], a[228:231], v[16:19]
    s_min_u32 s22, s22, s24
    v_cvt_pk_bf16_f32 v113, v114, v115
    v_mul_f32 v128, v128, v242
    s_waitcnt vmcnt(7)
    v_mfma_f32_16x16x32_bf16 v[20:23], a[152:155], a[232:235], v[20:23]
    s_add_u32 s34, s34, 98304
    v_mul_f32 v129, v129, v242
    v_mul_f32 v130, v130, v242
    s_waitcnt vmcnt(6)
    v_mfma_f32_16x16x32_bf16 v[24:27], a[152:155], a[236:239], v[24:27]
    ds_read_b128 a[152:155], v5 offset:4096
    v_mul_f32 v131, v131, v242
    s_waitcnt lgkmcnt(8)
    v_mfma_f32_16x16x32_bf16 v[12:15], a[156:159], a[240:243], v[12:15]
    s_add_u32 s32, s32, 98304
    v_cvt_pk_bf16_f32 v114, v128, v129
    v_cvt_pk_bf16_f32 v115, v130, v131
    v_mfma_f32_16x16x32_bf16 v[16:19], a[156:159], a[244:247], v[16:19]
    ds_write_b128 v182, v[112:115] offset:1024
    v_mfma_f32_16x16x32_bf16 v[20:23], a[156:159], a[248:251], v[20:23]
    s_add_u32 s95, s32, 10240
    s_nop 0
    v_max3_f32 v172, v12, v13, v14
    v_max_f32 v172, v172, v15
    v_mfma_f32_16x16x32_bf16 v[24:27], a[156:159], a[252:255], v[24:27]
    ds_read_b128 a[156:159], v5 offset:6144
    v_mov_b32 v176, v172
    s_waitcnt lgkmcnt(9)
    v_mfma_f32_16x16x32_bf16 v[28:31], a[160:163], a[192:195], 0
    v_permlane32_swap_b32 v176, v172
    v_mfma_f32_16x16x32_bf16 v[32:35], a[160:163], a[196:199], 0
    v_max_f32 v172, v172, v176
    v_max3_f32 v173, v16, v17, v18
    v_mfma_f32_16x16x32_bf16 v[36:39], a[160:163], a[200:203], 0
    v_mov_b32 v176, v172
    v_max_f32 v173, v173, v19
    v_mfma_f32_16x16x32_bf16 v[40:43], a[160:163], a[204:207], 0
    ds_read_b128 a[160:163], v5 offset:8192
    v_mov_b32 v177, v173
    s_waitcnt lgkmcnt(9)
    v_mfma_f32_16x16x32_bf16 v[28:31], a[164:167], a[208:211], v[28:31]
    v_permlane16_swap_b32 v176, v172
    v_mfma_f32_16x16x32_bf16 v[32:35], a[164:167], a[212:215], v[32:35]
    v_max_f32 v172, v172, v176
    v_max3_f32 v174, v20, v21, v22
    v_mfma_f32_16x16x32_bf16 v[36:39], a[164:167], a[216:219], v[36:39]
    v_permlane32_swap_b32 v177, v173
    v_mfma_f32_16x16x32_bf16 v[40:43], a[164:167], a[220:223], v[40:43]
    ds_read_b128 a[164:167], v5 offset:10240
    v_max_f32 v173, v173, v177
    s_waitcnt lgkmcnt(9)
    v_mfma_f32_16x16x32_bf16 v[28:31], a[168:171], a[224:227], v[28:31]
    v_sub_f32 v12, v12, v172
    v_sub_f32 v13, v13, v172
    v_mfma_f32_16x16x32_bf16 v[32:35], a[168:171], a[228:231], v[32:35]
    v_sub_f32 v14, v14, v172
    v_sub_f32 v15, v15, v172
    v_mfma_f32_16x16x32_bf16 v[36:39], a[168:171], a[232:235], v[36:39]
    v_sub_f32 v220, 0, v172
    v_sub_f32 v221, 0, v172
    v_mfma_f32_16x16x32_bf16 v[40:43], a[168:171], a[236:239], v[40:43]
    ds_read_b128 a[168:171], v5 offset:12288
    v_sub_f32 v222, 0, v172
    s_waitcnt lgkmcnt(9)
    v_mfma_f32_16x16x32_bf16 v[28:31], a[172:175], a[240:243], v[28:31]
    v_sub_f32 v223, 0, v172
    v_mov_b32 v177, v173
    v_mfma_f32_16x16x32_bf16 v[32:35], a[172:175], a[244:247], v[32:35]
    v_max_f32 v174, v174, v23
    v_mov_b32 v178, v174
    v_mfma_f32_16x16x32_bf16 v[36:39], a[172:175], a[248:251], v[36:39]
    v_exp_f32 v12, v12
    v_mfma_f32_16x16x32_bf16 v[40:43], a[172:175], a[252:255], v[40:43]
    ds_read_b128 a[172:175], v5 offset:14336
    v_exp_f32 v13, v13
    v_exp_f32 v14, v14
    v_exp_f32 v15, v15
    v_permlane16_swap_b32 v177, v173
    v_max_f32 v173, v173, v177
    v_permlane32_swap_b32 v178, v174
    v_cvt_pk_bf16_f32 v188, v12, v13
    v_cvt_pk_bf16_f32 v189, v14, v15
    s_waitcnt lgkmcnt(9)
    v_mfma_f32_16x16x32_bf16 v[12:15], a[144:147], a[192:195], v[220:223]
    buffer_load_dwordx4 v1, s[4:7], s16 offen lds
    v_max_f32 v174, v174, v178
    v_max3_f32 v175, v24, v25, v26
    v_sub_f32 v16, v16, v173
    v_sub_f32 v17, v17, v173
    v_sub_f32 v18, v18, v173
    v_sub_f32 v19, v19, v173
    v_sub_f32 v224, 0, v173
    v_sub_f32 v225, 0, v173
    v_sub_f32 v226, 0, v173
    v_sub_f32 v227, 0, v173
    v_mov_b32 v178, v174
    v_max_f32 v175, v175, v27
    v_exp_f32 v16, v16
    v_exp_f32 v17, v17
    v_exp_f32 v18, v18
    v_exp_f32 v19, v19
    v_permlane16_swap_b32 v178, v174
    v_mov_b32 v179, v175
    v_max_f32 v174, v174, v178
    s_nop 0
    v_permlane32_swap_b32 v179, v175
    v_cvt_pk_bf16_f32 v192, v16, v17
    v_cvt_pk_bf16_f32 v193, v18, v19
    v_mfma_f32_16x16x32_bf16 v[16:19], a[144:147], a[196:199], v[224:227]
    v_max_f32 v175, v175, v179
    v_sub_f32 v20, v20, v174
    v_sub_f32 v21, v21, v174
    v_sub_f32 v22, v22, v174
    v_sub_f32 v23, v23, v174
    v_sub_f32 v228, 0, v174
    v_sub_f32 v229, 0, v174
    v_sub_f32 v230, 0, v174
    v_sub_f32 v231, 0, v174
    v_mov_b32 v179, v175
    v_exp_f32 v20, v20
    v_exp_f32 v21, v21
    v_exp_f32 v22, v22
    v_exp_f32 v23, v23
    v_permlane16_swap_b32 v179, v175
    v_max_f32 v175, v175, v179
    v_cvt_pk_bf16_f32 v196, v20, v21
    v_cvt_pk_bf16_f32 v197, v22, v23
    v_mfma_f32_16x16x32_bf16 v[20:23], a[144:147], a[200:203], v[228:231]
    v_sub_f32 v24, v24, v175
    v_sub_f32 v25, v25, v175
    v_sub_f32 v26, v26, v175
    v_sub_f32 v27, v27, v175
    v_sub_f32 v232, 0, v175
    v_sub_f32 v233, 0, v175
    v_sub_f32 v234, 0, v175
    v_sub_f32 v235, 0, v175
    v_exp_f32 v24, v24
    v_exp_f32 v25, v25
    v_exp_f32 v26, v26
    v_exp_f32 v27, v27
    v_cvt_pk_bf16_f32 v200, v24, v25
    v_cvt_pk_bf16_f32 v201, v26, v27
    v_mfma_f32_16x16x32_bf16 v[24:27], a[144:147], a[204:207], v[232:235]
    buffer_load_dword v181, v183, s[76:79], s80 offen
    s_waitcnt lgkmcnt(7)
    v_mfma_f32_16x16x32_bf16 v[12:15], a[148:151], a[208:211], v[12:15]
    ds_read_b64_tr_b16 a[144:145], v3 offset:1024
    v_sub_f32 v28, v28, v172
    v_mfma_f32_16x16x32_bf16 v[16:19], a[148:151], a[212:215], v[16:19]
    ds_read_b64_tr_b16 a[146:147], v3 offset:9216
    v_sub_f32 v29, v29, v172
    v_mfma_f32_16x16x32_bf16 v[20:23], a[148:151], a[216:219], v[20:23]
    s_add_u32 s80, s80, 131072
    v_sub_f32 v30, v30, v172
    v_sub_f32 v31, v31, v172
    v_mfma_f32_16x16x32_bf16 v[24:27], a[148:151], a[220:223], v[24:27]
    ds_read_b64_tr_b16 a[148:149], v4 offset:1024
    v_sub_f32 v32, v32, v173
    s_waitcnt lgkmcnt(9)
    v_mfma_f32_16x16x32_bf16 v[12:15], a[152:155], a[224:227], v[12:15]
    buffer_load_dwordx4 v1, s[8:11], s16 offen offset:1024 lds
    v_mfma_f32_16x16x32_bf16 v[16:19], a[152:155], a[228:231], v[16:19]
    ds_read_b64_tr_b16 a[150:151], v4 offset:9216
    v_sub_f32 v33, v33, v173
    v_mfma_f32_16x16x32_bf16 v[20:23], a[152:155], a[232:235], v[20:23]
    s_add_u32 s16, s16, s17
    v_exp_f32 v28, v28
    v_mfma_f32_16x16x32_bf16 v[24:27], a[152:155], a[236:239], v[24:27]
    ds_read_b64_tr_b16 a[152:153], v3 offset:3072
    v_sub_f32 v34, v34, v173
    s_waitcnt lgkmcnt(9)
    v_mfma_f32_16x16x32_bf16 v[12:15], a[156:159], a[240:243], v[12:15]
    ds_read_b64_tr_b16 a[154:155], v3 offset:11264
    v_sub_f32 v35, v35, v173
    v_mfma_f32_16x16x32_bf16 v[16:19], a[156:159], a[244:247], v[16:19]
    s_add_u32 s20, s16, s18
    v_exp_f32 v29, v29
    v_mfma_f32_16x16x32_bf16 v[20:23], a[156:159], a[248:251], v[20:23]
    s_min_u32 m0, s19, s21
    v_exp_f32 v30, v30
    v_mfma_f32_16x16x32_bf16 v[24:27], a[156:159], a[252:255], v[24:27]
    ds_read_b64_tr_b16 a[156:157], v4 offset:3072
    v_exp_f32 v31, v31
    v_cvt_pk_bf16_f32 v190, v28, v29
    v_cvt_pk_bf16_f32 v191, v30, v31
    s_waitcnt lgkmcnt(10)
    v_mfma_f32_16x16x32_bf16 v[28:31], a[160:163], a[192:195], v[220:223]
    ds_read_b64_tr_b16 a[158:159], v4 offset:11264
    v_exp_f32 v32, v32
    v_exp_f32 v33, v33
    v_exp_f32 v34, v34
    v_exp_f32 v35, v35
    v_cvt_pk_bf16_f32 v194, v32, v33
    v_cvt_pk_bf16_f32 v195, v34, v35
    v_mfma_f32_16x16x32_bf16 v[32:35], a[160:163], a[196:199], v[224:227]
    s_min_u32 s16, s16, s20
    v_sub_f32 v36, v36, v174
    v_sub_f32 v37, v37, v174
    v_sub_f32 v38, v38, v174
    v_sub_f32 v39, v39, v174
    v_exp_f32 v36, v36
    v_exp_f32 v37, v37
    v_exp_f32 v38, v38
    v_exp_f32 v39, v39
    v_cvt_pk_bf16_f32 v198, v36, v37
    v_cvt_pk_bf16_f32 v199, v38, v39
    v_mfma_f32_16x16x32_bf16 v[36:39], a[160:163], a[200:203], v[228:231]
    s_add_u32 s19, m0, 8192
    v_sub_f32 v40, v40, v175
    v_sub_f32 v41, v41, v175
    v_sub_f32 v42, v42, v175
    v_sub_f32 v43, v43, v175
    v_exp_f32 v40, v40
    v_exp_f32 v41, v41
    v_exp_f32 v42, v42
    v_exp_f32 v43, v43
    s_nop 0
    v_cvt_pk_bf16_f32 v203, v42, v43
    v_cvt_pk_bf16_f32 v202, v40, v41
    v_mfma_f32_16x16x32_bf16 v[40:43], a[160:163], a[204:207], v[232:235]
    ds_read_b64_tr_b16 a[160:161], v3 offset:5120
    v_mul_f32 v116, v116, v244
    s_waitcnt lgkmcnt(11)
    v_mfma_f32_16x16x32_bf16 v[28:31], a[164:167], a[208:211], v[28:31]
    ds_read_b64_tr_b16 a[162:163], v3 offset:13312
    v_mul_f32 v117, v117, v244
    v_mfma_f32_16x16x32_bf16 v[32:35], a[164:167], a[212:215], v[32:35]
    s_sub_u32 s21, s19, s99
    v_mul_f32 v118, v118, v244
    v_mul_f32 v119, v119, v244
    v_mfma_f32_16x16x32_bf16 v[36:39], a[164:167], a[216:219], v[36:39]
    v_cvt_pk_bf16_f32 v116, v116, v117
    v_cvt_pk_bf16_f32 v117, v118, v119
    v_mfma_f32_16x16x32_bf16 v[40:43], a[164:167], a[220:223], v[40:43]
    ds_read_b64_tr_b16 a[164:165], v4 offset:5120
    v_mul_f32 v132, v132, v244
    s_waitcnt lgkmcnt(12)
    v_mfma_f32_16x16x32_bf16 v[28:31], a[168:171], a[224:227], v[28:31]
    ds_read_b64_tr_b16 a[166:167], v4 offset:13312
    v_mul_f32 v133, v133, v244
    v_mfma_f32_16x16x32_bf16 v[32:35], a[168:171], a[228:231], v[32:35]
    v_rcp_f32 v246, v246
    v_mfma_f32_16x16x32_bf16 v[36:39], a[168:171], a[232:235], v[36:39]
    v_mul_f32 v134, v134, v244
    v_mul_f32 v135, v135, v244
    v_mfma_f32_16x16x32_bf16 v[40:43], a[168:171], a[236:239], v[40:43]
    ds_read_b64_tr_b16 a[168:169], v3 offset:7168
    v_cvt_pk_bf16_f32 v118, v132, v133
    s_waitcnt lgkmcnt(13)
    v_mfma_f32_16x16x32_bf16 v[28:31], a[172:175], a[240:243], v[28:31]
    ds_read_b64_tr_b16 a[170:171], v3 offset:15360
    v_cvt_pk_bf16_f32 v119, v134, v135
    v_mfma_f32_16x16x32_bf16 v[32:35], a[172:175], a[244:247], v[32:35]
    ds_write_b128 v182, v[116:119] offset:2048
    v_mfma_f32_16x16x32_bf16 v[36:39], a[172:175], a[248:251], v[36:39]
    v_mul_f32 v120, v120, v246
    v_mul_f32 v121, v121, v246
    v_mfma_f32_16x16x32_bf16 v[40:43], a[172:175], a[252:255], v[40:43]
    ds_read_b64_tr_b16 a[172:173], v4 offset:7168
    v_mul_f32 v122, v122, v246
    v_mfma_f32_16x16x32_bf16 a[128:131], v[236:239], v[188:191], 0
    ds_read_b64_tr_b16 a[174:175], v4 offset:15360
    v_mul_f32 v123, v123, v246
    v_mfma_f32_16x16x32_bf16 a[132:135], v[236:239], v[192:195], 0
    buffer_load_dwordx4 v1, s[4:7], s16 offen lds
    v_mfma_f32_16x16x32_bf16 a[136:139], v[236:239], v[196:199], 0
    v_cvt_pk_bf16_f32 v120, v120, v121
    v_cvt_pk_bf16_f32 v121, v122, v123
    v_mfma_f32_16x16x32_bf16 a[140:143], v[236:239], v[200:203], 0
    v_mul_f32 v136, v136, v246
    v_mul_f32 v137, v137, v246
    s_waitcnt lgkmcnt(15)
    v_mfma_f32_16x16x32_bf16 v[108:111], a[144:147], v[188:191], 0
    v_mul_f32 v138, v138, v246
    v_mul_f32 v139, v139, v246
    v_mfma_f32_16x16x32_bf16 v[112:115], a[144:147], v[192:195], 0
    v_cvt_pk_bf16_f32 v122, v136, v137
    v_cvt_pk_bf16_f32 v123, v138, v139
    v_mfma_f32_16x16x32_bf16 v[116:119], a[144:147], v[196:199], 0
    ds_write_b128 v182, v[120:123] offset:3072
    s_nop 1
    v_mfma_f32_16x16x32_bf16 v[120:123], a[144:147], v[200:203], 0
    v_mul_f32 v140, v140, v240
    v_mul_f32 v141, v141, v240
    s_waitcnt lgkmcnt(14)
    v_mfma_f32_16x16x32_bf16 v[124:127], a[148:151], v[188:191], 0
    v_mul_f32 v142, v142, v240
    v_mul_f32 v143, v143, v240
    v_mfma_f32_16x16x32_bf16 v[128:131], a[148:151], v[192:195], 0
    buffer_load_dwordx4 v1, s[8:11], s16 offen offset:1024 lds
    v_mfma_f32_16x16x32_bf16 v[132:135], a[148:151], v[196:199], 0
    s_add_u32 s16, s16, s17
    v_cvt_pk_bf16_f32 v140, v140, v141
    v_cvt_pk_bf16_f32 v141, v142, v143
    v_mfma_f32_16x16x32_bf16 v[136:139], a[148:151], v[200:203], 0
    s_add_u32 s20, s16, s18
    v_mul_f32 v156, v156, v240
    v_mul_f32 v157, v157, v240
    v_mul_f32 v158, v158, v240
    v_mul_f32 v159, v159, v240
    v_cvt_pk_bf16_f32 v142, v156, v157
    v_cvt_pk_bf16_f32 v143, v158, v159
    v_mul_f32 v144, v144, v242
    v_mul_f32 v145, v145, v242
    v_mul_f32 v146, v146, v242
    v_mul_f32 v147, v147, v242
    v_cvt_pk_bf16_f32 v144, v144, v145
    v_cvt_pk_bf16_f32 v145, v146, v147
    v_mul_f32 v160, v160, v242
    v_mul_f32 v161, v161, v242
    v_mul_f32 v162, v162, v242
    v_mul_f32 v163, v163, v242
    v_cvt_pk_bf16_f32 v146, v160, v161
    v_cvt_pk_bf16_f32 v147, v162, v163
    v_mul_f32 v148, v148, v244
    v_mul_f32 v149, v149, v244
    v_mul_f32 v150, v150, v244
    v_mul_f32 v151, v151, v244
    v_cvt_pk_bf16_f32 v148, v148, v149
    v_cvt_pk_bf16_f32 v149, v150, v151
    v_mul_f32 v164, v164, v244
    v_mul_f32 v165, v165, v244
    v_mul_f32 v166, v166, v244
    v_mul_f32 v167, v167, v244
    v_cvt_pk_bf16_f32 v150, v164, v165
    v_cvt_pk_bf16_f32 v151, v166, v167
    v_mul_f32 v152, v152, v246
    v_mul_f32 v153, v153, v246
    v_mul_f32 v154, v154, v246
    v_mul_f32 v155, v155, v246
    v_cvt_pk_bf16_f32 v152, v152, v153
    v_cvt_pk_bf16_f32 v153, v154, v155
    v_mul_f32 v168, v168, v246
    v_mul_f32 v169, v169, v246
    v_mul_f32 v170, v170, v246
    v_mul_f32 v171, v171, v246
    v_cvt_pk_bf16_f32 v154, v168, v169
    v_cvt_pk_bf16_f32 v155, v170, v171
    v_accvgpr_read_b32 v76, a0
    v_accvgpr_read_b32 v77, a1
    v_accvgpr_read_b32 v78, a2
    v_accvgpr_read_b32 v79, a3
    v_mul_f32 v76, v76, v240
    v_mul_f32 v77, v77, v240
    v_mul_f32 v78, v78, v240
    v_mul_f32 v79, v79, v240
    v_accvgpr_read_b32 v80, a16
    v_accvgpr_read_b32 v81, a17
    v_accvgpr_read_b32 v82, a18
    v_accvgpr_read_b32 v83, a19
    v_cvt_pk_bf16_f32 v92, v76, v77
    v_cvt_pk_bf16_f32 v93, v78, v79
    v_mul_f32 v80, v80, v240
    v_mul_f32 v81, v81, v240
    v_mul_f32 v82, v82, v240
    v_mul_f32 v83, v83, v240
    v_cvt_pk_bf16_f32 v94, v80, v81
    v_cvt_pk_bf16_f32 v95, v82, v83
    v_accvgpr_read_b32 v84, a4
    v_accvgpr_read_b32 v85, a5
    v_accvgpr_read_b32 v86, a6
    v_accvgpr_read_b32 v87, a7
    v_accvgpr_read_b32 v88, a20
    v_accvgpr_read_b32 v89, a21
    v_accvgpr_read_b32 v90, a22
    v_accvgpr_read_b32 v91, a23
    v_accvgpr_read_b32 v76, a8
    v_accvgpr_read_b32 v77, a9
    v_accvgpr_read_b32 v78, a10
    v_accvgpr_read_b32 v79, a11
    v_mul_f32 v84, v84, v242
    v_mul_f32 v85, v85, v242
    v_mul_f32 v86, v86, v242
    v_mul_f32 v87, v87, v242
    v_mul_f32 v88, v88, v242
    v_mul_f32 v89, v89, v242
    v_mul_f32 v90, v90, v242
    v_mul_f32 v91, v91, v242
    v_mul_f32 v76, v76, v244
    v_mul_f32 v77, v77, v244
    v_mul_f32 v78, v78, v244
    v_mul_f32 v79, v79, v244
    v_accvgpr_read_b32 v80, a24
    v_accvgpr_read_b32 v81, a25
    v_accvgpr_read_b32 v82, a26
    v_accvgpr_read_b32 v83, a27
    v_cvt_pk_bf16_f32 v96, v84, v85
    v_cvt_pk_bf16_f32 v97, v86, v87
    v_cvt_pk_bf16_f32 v98, v88, v89
    v_cvt_pk_bf16_f32 v99, v90, v91
    v_mul_f32 v80, v80, v244
    v_mul_f32 v81, v81, v244
    v_mul_f32 v82, v82, v244
    v_mul_f32 v83, v83, v244
    v_accvgpr_read_b32 v84, a12
    v_accvgpr_read_b32 v85, a13
    v_accvgpr_read_b32 v86, a14
    v_accvgpr_read_b32 v87, a15
    v_accvgpr_read_b32 v88, a28
    v_accvgpr_read_b32 v89, a29
    v_accvgpr_read_b32 v90, a30
    v_accvgpr_read_b32 v91, a31
    v_mul_f32 v84, v84, v246
    v_mul_f32 v85, v85, v246
    v_mul_f32 v86, v86, v246
    v_mul_f32 v87, v87, v246
    v_mul_f32 v88, v88, v246
    v_mul_f32 v89, v89, v246
    v_mul_f32 v90, v90, v246
    v_mul_f32 v91, v91, v246
    v_exp_f32 v12, v12
    v_exp_f32 v13, v13
    v_exp_f32 v14, v14
    v_exp_f32 v15, v15
    v_exp_f32 v16, v16
    v_exp_f32 v17, v17
    v_exp_f32 v18, v18
    v_exp_f32 v19, v19
    v_exp_f32 v20, v20
    v_exp_f32 v21, v21
    v_exp_f32 v22, v22
    v_exp_f32 v23, v23
    v_exp_f32 v24, v24
    v_exp_f32 v25, v25
    v_exp_f32 v26, v26
    v_exp_f32 v27, v27
    v_xor_b32 v5, s22, v8
    v_exp_f32 v28, v28
    v_exp_f32 v29, v29
    v_exp_f32 v30, v30
    v_exp_f32 v31, v31
    v_add_u32 v11, s34, v9
    v_exp_f32 v32, v32
    v_exp_f32 v33, v33
    v_exp_f32 v34, v34
    v_exp_f32 v35, v35
    v_exp_f32 v36, v36
    v_exp_f32 v37, v37
    v_exp_f32 v38, v38
    v_exp_f32 v39, v39
    v_mov_b32 v248, -1
    v_mov_b32 v249, -1
    v_mov_b32 v250, -1
    v_mov_b32 v251, -1
    v_cvt_pk_bf16_f32 v204, v12, v13
    v_cvt_pk_bf16_f32 v205, v14, v15
    v_cvt_pk_bf16_f32 v208, v16, v17
    v_cvt_pk_bf16_f32 v209, v18, v19
    v_cvt_pk_bf16_f32 v212, v20, v21
    v_cvt_pk_bf16_f32 v213, v22, v23
    v_cvt_pk_bf16_f32 v216, v24, v25
    v_cvt_pk_bf16_f32 v217, v26, v27
    s_min_u32 m0, s19, s21
    ds_write_b128 v182, v[140:143] offset:4096
    s_nop 0
    s_waitcnt lgkmcnt(13)
    v_mfma_f32_16x16x32_bf16 v[140:143], a[152:155], v[188:191], 0
    ds_write_b128 v182, v[144:147] offset:5120
    s_nop 1
    v_mfma_f32_16x16x32_bf16 v[144:147], a[152:155], v[192:195], 0
    ds_write_b128 v182, v[148:151] offset:6144
    s_nop 1
    v_mfma_f32_16x16x32_bf16 v[148:151], a[152:155], v[196:199], 0
    ds_write_b128 v182, v[152:155] offset:7168
    s_nop 1
    v_mfma_f32_16x16x32_bf16 v[152:155], a[152:155], v[200:203], 0
    ds_write_b128 v182, v[92:95] offset:8192
    s_waitcnt lgkmcnt(15)
    v_mfma_f32_16x16x32_bf16 v[156:159], a[156:159], v[188:191], 0
    ds_write_b128 v182, v[96:99] offset:9216
    v_mfma_f32_16x16x32_bf16 v[160:163], a[156:159], v[192:195], 0
    s_min_u32 s16, s16, s20
    v_cvt_pk_bf16_f32 v92, v76, v77
    v_cvt_pk_bf16_f32 v93, v78, v79
    v_mfma_f32_16x16x32_bf16 v[164:167], a[156:159], v[196:199], 0
    v_cvt_pk_bf16_f32 v94, v80, v81
    v_cvt_pk_bf16_f32 v95, v82, v83
    v_mfma_f32_16x16x32_bf16 v[168:171], a[156:159], v[200:203], 0
    ds_write_b128 v182, v[92:95] offset:10240
    s_waitcnt lgkmcnt(15)
    v_mfma_f32_16x16x32_bf16 v[44:47], a[160:163], v[188:191], 0
    v_accvgpr_read_b32 v76, a32
    v_accvgpr_read_b32 v77, a33
    v_mfma_f32_16x16x32_bf16 v[48:51], a[160:163], v[192:195], 0
    s_waitcnt vmcnt(9)
    s_barrier
    v_accvgpr_read_b32 v78, a34
    v_mfma_f32_16x16x32_bf16 v[52:55], a[160:163], v[196:199], 0
    ds_read_b128 a[144:147], v5 offset:0
    v_accvgpr_read_b32 v79, a35
    v_mfma_f32_16x16x32_bf16 v[56:59], a[160:163], v[200:203], 0
    ds_read_b128 a[148:151], v5 offset:2048
    v_mul_f32 v76, v76, v240
    s_waitcnt lgkmcnt(15)
    v_mfma_f32_16x16x32_bf16 v[60:63], a[164:167], v[188:191], 0
    ds_read_b128 a[152:155], v5 offset:4096
    v_mul_f32 v77, v77, v240
    v_mfma_f32_16x16x32_bf16 v[64:67], a[164:167], v[192:195], 0
    ds_read_b128 a[156:159], v5 offset:6144
    v_mul_f32 v78, v78, v240
    v_mfma_f32_16x16x32_bf16 v[68:71], a[164:167], v[196:199], 0
    v_mul_f32 v79, v79, v240
    v_accvgpr_read_b32 v80, a48
    v_mfma_f32_16x16x32_bf16 v[72:75], a[164:167], v[200:203], 0
    v_accvgpr_read_b32 v81, a49
    v_accvgpr_read_b32 v82, a50
    v_accvgpr_read_b32 v83, a51
    v_cvt_pk_bf16_f32 v96, v84, v85
    v_cvt_pk_bf16_f32 v97, v86, v87
    v_cvt_pk_bf16_f32 v98, v88, v89
    v_cvt_pk_bf16_f32 v99, v90, v91
    v_cvt_pk_bf16_f32 v92, v76, v77
    v_cvt_pk_bf16_f32 v93, v78, v79
    v_mul_f32 v80, v80, v240
    v_mul_f32 v81, v81, v240
    v_mul_f32 v82, v82, v240
    v_mul_f32 v83, v83, v240
    v_cvt_pk_bf16_f32 v94, v80, v81
    v_cvt_pk_bf16_f32 v95, v82, v83
    v_accvgpr_read_b32 v76, a40
    v_accvgpr_read_b32 v77, a41
    v_accvgpr_read_b32 v78, a42
    v_accvgpr_read_b32 v79, a43
    v_mul_f32 v76, v76, v244
    v_mul_f32 v77, v77, v244
    v_mul_f32 v78, v78, v244
    v_mul_f32 v79, v79, v244
    v_accvgpr_read_b32 v80, a56
    v_accvgpr_read_b32 v81, a57
    v_accvgpr_read_b32 v82, a58
    v_accvgpr_read_b32 v83, a59
    v_accvgpr_read_b32 v84, a36
    v_accvgpr_read_b32 v85, a37
    v_accvgpr_read_b32 v86, a38
    v_accvgpr_read_b32 v87, a39
    v_mul_f32 v80, v80, v244
    v_mul_f32 v81, v81, v244
    v_mul_f32 v82, v82, v244
    v_mul_f32 v83, v83, v244
    v_mul_f32 v84, v84, v242
    v_mul_f32 v85, v85, v242
    v_mul_f32 v86, v86, v242
    v_mul_f32 v87, v87, v242
    v_accvgpr_read_b32 v88, a52
    v_accvgpr_read_b32 v89, a53
    v_accvgpr_read_b32 v90, a54
    v_accvgpr_read_b32 v91, a55
    v_mul_f32 v88, v88, v242
    v_mul_f32 v89, v89, v242
    v_mul_f32 v90, v90, v242
    v_mul_f32 v91, v91, v242
    v_cvt_pk_bf16_f32 v206, v28, v29
    v_cvt_pk_bf16_f32 v207, v30, v31
    ds_write_b128 v182, v[96:99] offset:11264
    ds_write_b128 v182, v[92:95] offset:12288
    s_nop 1
    v_cvt_pk_bf16_f32 v92, v76, v77
    v_cvt_pk_bf16_f32 v93, v78, v79
    s_waitcnt lgkmcnt(15)
    v_mfma_f32_16x16x32_bf16 v[76:79], a[168:171], v[188:191], 0
    v_cvt_pk_bf16_f32 v94, v80, v81
    v_cvt_pk_bf16_f32 v95, v82, v83
    v_mfma_f32_16x16x32_bf16 v[80:83], a[168:171], v[192:195], 0
    v_cvt_pk_bf16_f32 v96, v84, v85
    v_cvt_pk_bf16_f32 v97, v86, v87
    v_cvt_pk_bf16_f32 v98, v88, v89
    v_cvt_pk_bf16_f32 v99, v90, v91
    v_accvgpr_read_b32 v84, a44
    v_accvgpr_read_b32 v85, a45
    v_accvgpr_read_b32 v86, a46
    v_accvgpr_read_b32 v87, a47
    v_mul_f32 v84, v84, v246
    v_mul_f32 v85, v85, v246
    v_mul_f32 v86, v86, v246
    v_mul_f32 v87, v87, v246
    v_accvgpr_read_b32 v88, a60
    v_accvgpr_read_b32 v89, a61
    v_accvgpr_read_b32 v90, a62
    v_accvgpr_read_b32 v91, a63
    v_mul_f32 v88, v88, v246
    v_mul_f32 v89, v89, v246
    v_mul_f32 v90, v90, v246
    v_mul_f32 v91, v91, v246
    ds_write_b128 v182, v[96:99] offset:13312
    s_nop 1
    v_cvt_pk_bf16_f32 v96, v84, v85
    v_cvt_pk_bf16_f32 v97, v86, v87
    v_mfma_f32_16x16x32_bf16 v[84:87], a[168:171], v[196:199], 0
    ds_write_b128 v182, v[92:95] offset:14336
    v_cvt_pk_bf16_f32 v98, v88, v89
    v_cvt_pk_bf16_f32 v99, v90, v91
    v_mfma_f32_16x16x32_bf16 v[88:91], a[168:171], v[200:203], 0
    ds_write_b128 v182, v[96:99] offset:15360
    s_waitcnt lgkmcnt(15)
    v_mfma_f32_16x16x32_bf16 v[92:95], a[172:175], v[188:191], 0
    v_mfma_f32_16x16x32_bf16 v[96:99], a[172:175], v[192:195], 0
    v_mfma_f32_16x16x32_bf16 v[100:103], a[172:175], v[196:199], 0
    s_waitcnt lgkmcnt(0)
    s_barrier
    v_mfma_f32_16x16x32_bf16 v[104:107], a[172:175], v[200:203], 0
    ds_read_b128 a[0:3], v11 offset:0
    ds_read_b128 a[4:7], v11 offset:1024
    ds_read_b128 a[8:11], v11 offset:2048
    ds_read_b128 a[12:15], v11 offset:3072
    ds_read_b128 a[16:19], v11 offset:4096
    ds_read_b128 a[20:23], v11 offset:5120
    ds_read_b128 a[24:27], v11 offset:6144
    ds_read_b128 a[28:31], v11 offset:7168
    ds_read_b128 a[32:35], v11 offset:8192
    ds_read_b128 a[36:39], v11 offset:9216
    ds_read_b128 a[40:43], v11 offset:10240
    ds_read_b128 a[44:47], v11 offset:11264
    ds_read_b128 a[48:51], v11 offset:12288
    ds_read_b128 a[52:55], v11 offset:13312
    ds_read_b128 a[56:59], v11 offset:14336
    ds_read_b128 a[60:63], v11 offset:15360
    ds_read_b128 a[64:67], v11 offset:16384
    ds_read_b128 a[68:71], v11 offset:17408
    ds_read_b128 a[72:75], v11 offset:18432
    ds_read_b128 a[76:79], v11 offset:19456
    ds_read_b128 a[80:83], v11 offset:20480
    ds_read_b128 a[84:87], v11 offset:21504
    ds_read_b128 a[88:91], v11 offset:22528
    ds_read_b128 a[92:95], v11 offset:23552
    ds_read_b128 a[96:99], v11 offset:24576
    ds_read_b128 a[100:103], v11 offset:25600
    ds_read_b128 a[104:107], v11 offset:26624
    ds_read_b128 a[108:111], v11 offset:27648
    ds_read_b128 a[112:115], v11 offset:28672
    ds_read_b128 a[116:119], v11 offset:29696
    ds_read_b128 a[120:123], v11 offset:30720
    ds_read_b128 a[124:127], v11 offset:31744
    s_mov_b32 s25, 6
    s_branch TA_At2e15
TA_SW24:
    s_lshl_b32 s59, s54, 7
    s_lshl_b32 s60, s26, 4
    s_add_u32 s59, s59, s60
    s_mul_i32 s59, s59, 1152
    s_add_u32 s4, s46, s59
    s_addc_u32 s5, s47, 0
    s_sub_u32 s6, 4718592, s59
    s_sub_u32 s8, s4, 960
    s_subb_u32 s9, s5, 0
    s_add_u32 s10, s6, 960
    s_mov_b32 s16, 0
    s_mov_b32 s17, 73728
    s_mov_b32 s18, 4294377600
    v_lshrrev_b32 v2, 2, v0
    v_mul_u32_u24 v2, 1152, v2
    v_and_or_b32 v1, v7, 48, v2
    s_branch TA_SW24r
.p2align 3
TA_At214:
    v_mfma_f32_16x16x32_bf16 v[108:111], a[144:147], v[188:191], v[108:111]
    ds_read_b64_tr_b16 a[158:159], v4 offset:11264
    s_mov_b32 s23, s22
    v_mfma_f32_16x16x32_bf16 v[112:115], a[144:147], v[192:195], v[112:115]
    s_add_u32 s22, s22, 16384
    v_exp_f32 v23, v23
    v_mfma_f32_16x16x32_bf16 v[116:119], a[144:147], v[196:199], v[116:119]
    s_sub_u32 s24, s22, s99
    v_exp_f32 v24, v24
    v_mfma_f32_16x16x32_bf16 v[120:123], a[144:147], v[200:203], v[120:123]
    ds_read_b64_tr_b16 a[160:161], v3 offset:5120
    v_cvt_pk_bf16_f32 v213, v22, v23
    v_mfma_f32_16x16x32_bf16 v[124:127], a[148:151], v[188:191], v[124:127]
    ds_read_b64_tr_b16 a[162:163], v3 offset:13312
    s_min_u32 s22, s22, s24
    v_mfma_f32_16x16x32_bf16 v[128:131], a[148:151], v[192:195], v[128:131]
    v_exp_f32 v25, v25
    v_mfma_f32_16x16x32_bf16 v[132:135], a[148:151], v[196:199], v[132:135]
    buffer_load_dwordx4 v1, s[8:11], s16 offen offset:1024 lds
    v_mfma_f32_16x16x32_bf16 v[136:139], a[148:151], v[200:203], v[136:139]
    ds_read_b64_tr_b16 a[164:165], v4 offset:5120
    s_waitcnt lgkmcnt(3)
    v_mfma_f32_16x16x32_bf16 v[140:143], a[152:155], v[188:191], v[140:143]
    ds_read_b64_tr_b16 a[166:167], v4 offset:13312
    v_cvt_pk_bf16_f32 v216, v24, v25
    v_mfma_f32_16x16x32_bf16 v[144:147], a[152:155], v[192:195], v[144:147]
    s_add_u32 s19, m0, 8192
    v_exp_f32 v26, v26
    v_mfma_f32_16x16x32_bf16 v[148:151], a[152:155], v[196:199], v[148:151]
    s_sub_u32 s21, s19, s99
    v_exp_f32 v27, v27
    v_mfma_f32_16x16x32_bf16 v[152:155], a[152:155], v[200:203], v[152:155]
    ds_read_b64_tr_b16 a[168:169], v3 offset:7168
    v_cvt_pk_bf16_f32 v217, v26, v27
    v_mfma_f32_16x16x32_bf16 v[156:159], a[156:159], v[188:191], v[156:159]
    ds_read_b64_tr_b16 a[170:171], v3 offset:15360
    v_xor_b32 v5, s22, v8
    v_mfma_f32_16x16x32_bf16 v[160:163], a[156:159], v[192:195], v[160:163]
    s_min_u32 m0, s19, s21
    v_exp_f32 v28, v28
    v_mfma_f32_16x16x32_bf16 v[164:167], a[156:159], v[196:199], v[164:167]
    s_add_u32 s16, s16, s17
    v_exp_f32 v29, v29
    v_mfma_f32_16x16x32_bf16 v[168:171], a[156:159], v[200:203], v[168:171]
    ds_read_b64_tr_b16 a[172:173], v4 offset:7168
    s_waitcnt lgkmcnt(3)
    v_mfma_f32_16x16x32_bf16 v[44:47], a[160:163], v[188:191], v[44:47]
    ds_read_b64_tr_b16 a[174:175], v4 offset:15360
    v_cvt_pk_bf16_f32 v206, v28, v29
    v_mfma_f32_16x16x32_bf16 v[48:51], a[160:163], v[192:195], v[48:51]
    s_add_u32 s20, s16, s18
    v_exp_f32 v30, v30
    v_mfma_f32_16x16x32_bf16 v[52:55], a[160:163], v[196:199], v[52:55]
    s_waitcnt vmcnt(11)
    s_barrier
    s_min_u32 s16, s16, s20
    v_mfma_f32_16x16x32_bf16 v[56:59], a[160:163], v[200:203], v[56:59]
    ds_read_b128 a[144:147], v5 offset:0
    v_mfma_f32_16x16x32_bf16 v[60:63], a[164:167], v[188:191], v[60:63]
    v_exp_f32 v31, v31
    v_mfma_f32_16x16x32_bf16 v[64:67], a[164:167], v[192:195], v[64:67]
    v_exp_f32 v32, v32
    v_mfma_f32_16x16x32_bf16 v[68:71], a[164:167], v[196:199], v[68:71]
    v_exp_f32 v33, v33
    v_mfma_f32_16x16x32_bf16 v[72:75], a[164:167], v[200:203], v[72:75]
    ds_read_b128 a[148:151], v5 offset:2048
    s_waitcnt lgkmcnt(2)
    v_mfma_f32_16x16x32_bf16 v[76:79], a[168:171], v[188:191], v[76:79]
    v_exp_f32 v34, v34
    v_mfma_f32_16x16x32_bf16 v[80:83], a[168:171], v[192:195], v[80:83]
    v_exp_f32 v35, v35
    v_mfma_f32_16x16x32_bf16 v[84:87], a[168:171], v[196:199], v[84:87]
    v_exp_f32 v36, v36
    v_mfma_f32_16x16x32_bf16 v[88:91], a[168:171], v[200:203], v[88:91]
    ds_read_b128 a[152:155], v5 offset:4096
    v_cvt_pk_bf16_f32 v207, v30, v31
    v_mfma_f32_16x16x32_bf16 v[92:95], a[172:175], v[188:191], v[92:95]
    v_exp_f32 v37, v37
    v_mfma_f32_16x16x32_bf16 v[96:99], a[172:175], v[192:195], v[96:99]
    v_exp_f32 v38, v38
    v_mfma_f32_16x16x32_bf16 v[100:103], a[172:175], v[196:199], v[100:103]
    v_exp_f32 v39, v39
    v_mfma_f32_16x16x32_bf16 v[104:107], a[172:175], v[200:203], v[104:107]
    ds_read_b128 a[156:159], v5 offset:6144
    s_waitcnt lgkmcnt(2)
TA_At2e15:
    v_mfma_f32_16x16x32_bf16 v[12:15], a[144:147], a[192:195], v[220:223]
    buffer_load_dwordx4 v1, s[4:7], s16 offen lds
    v_mfma_f32_16x16x32_bf16 v[16:19], a[144:147], a[196:199], v[224:227]
    v_exp_f32 v40, v40
    v_mfma_f32_16x16x32_bf16 v[20:23], a[144:147], a[200:203], v[228:231]
    buffer_store_dwordx4 v[248:251], v9, s[12:15], s32 offen offset:0 sc1
    v_mfma_f32_16x16x32_bf16 v[24:27], a[144:147], a[204:207], v[232:235]
    ds_read_b128 a[160:163], v5 offset:8192
    v_cvt_pk_bf16_f32 v210, v32, v33
    v_mfma_f32_16x16x32_bf16 v[12:15], a[148:151], a[208:211], v[12:15]
    v_exp_f32 v41, v41
    v_mfma_f32_16x16x32_bf16 v[16:19], a[148:151], a[212:215], v[16:19]
    v_exp_f32 v42, v42
    v_mfma_f32_16x16x32_bf16 v[20:23], a[148:151], a[216:219], v[20:23]
    v_exp_f32 v43, v43
    v_mfma_f32_16x16x32_bf16 v[24:27], a[148:151], a[220:223], v[24:27]
    ds_read_b128 a[164:167], v5 offset:10240
    s_waitcnt lgkmcnt(2)
    v_mfma_f32_16x16x32_bf16 v[12:15], a[152:155], a[224:227], v[12:15]
    buffer_load_dwordx4 v1, s[8:11], s16 offen offset:1024 lds
    v_mfma_f32_16x16x32_bf16 v[16:19], a[152:155], a[228:231], v[16:19]
    s_add_u32 s19, m0, 8192
    v_cvt_pk_bf16_f32 v214, v36, v37
    v_cvt_pk_bf16_f32 v215, v38, v39
    v_mfma_f32_16x16x32_bf16 v[20:23], a[152:155], a[232:235], v[20:23]
    s_sub_u32 s21, s19, s99
    v_cvt_pk_bf16_f32 v218, v40, v41
    v_cvt_pk_bf16_f32 v219, v42, v43
    v_mfma_f32_16x16x32_bf16 v[24:27], a[152:155], a[236:239], v[24:27]
    ds_read_b128 a[168:171], v5 offset:12288
    v_cvt_pk_bf16_f32 v211, v34, v35
    v_mfma_f32_16x16x32_bf16 v[12:15], a[156:159], a[240:243], v[12:15]
    s_min_u32 m0, s19, s21
    s_add_u32 s16, s16, s17
    s_add_u32 s20, s16, s18
    v_mfma_f32_16x16x32_bf16 v[16:19], a[156:159], a[244:247], v[16:19]
    s_min_u32 s16, s16, s20
    v_mfma_f32_16x16x32_bf16 v[20:23], a[156:159], a[248:251], v[20:23]
    v_mfma_f32_16x16x32_bf16 v[24:27], a[156:159], a[252:255], v[24:27]
    ds_read_b128 a[172:175], v5 offset:14336
    s_waitcnt lgkmcnt(2)
    v_mfma_f32_16x16x32_bf16 v[28:31], a[160:163], a[192:195], v[220:223]
    v_exp_f32 v12, v12
    v_mfma_f32_16x16x32_bf16 v[32:35], a[160:163], a[196:199], v[224:227]
    v_exp_f32 v13, v13
    v_mfma_f32_16x16x32_bf16 v[36:39], a[160:163], a[200:203], v[228:231]
    buffer_store_dwordx4 v[248:251], v9, s[12:15], s32 offen offset:1024 sc1
    v_mfma_f32_16x16x32_bf16 v[40:43], a[160:163], a[204:207], v[232:235]
    s_nop 0
    s_add_u32 s32, s32, 2048
    s_min_u32 s32, s32, s95
    v_xor_b32 v3, s23, v6
    v_mfma_f32_16x16x32_bf16 v[28:31], a[164:167], a[208:211], v[28:31]
    v_xor_b32 v4, 32, v3
    v_cvt_pk_bf16_f32 v188, v12, v13
    v_mfma_f32_16x16x32_bf16 v[32:35], a[164:167], a[212:215], v[32:35]
    v_exp_f32 v14, v14
    v_mfma_f32_16x16x32_bf16 v[36:39], a[164:167], a[216:219], v[36:39]
    v_exp_f32 v15, v15
    v_mfma_f32_16x16x32_bf16 v[40:43], a[164:167], a[220:223], v[40:43]
    ds_read_b64_tr_b16 a[144:145], v3 offset:1024
    s_waitcnt lgkmcnt(1)
    v_mfma_f32_16x16x32_bf16 v[28:31], a[168:171], a[224:227], v[28:31]
    ds_read_b64_tr_b16 a[146:147], v3 offset:9216
    v_cvt_pk_bf16_f32 v189, v14, v15
    v_mfma_f32_16x16x32_bf16 v[32:35], a[168:171], a[228:231], v[32:35]
    v_exp_f32 v16, v16
    v_mfma_f32_16x16x32_bf16 v[36:39], a[168:171], a[232:235], v[36:39]
    v_exp_f32 v17, v17
    v_mfma_f32_16x16x32_bf16 v[40:43], a[168:171], a[236:239], v[40:43]
    ds_read_b64_tr_b16 a[148:149], v4 offset:1024
    v_cvt_pk_bf16_f32 v192, v16, v17
    v_mfma_f32_16x16x32_bf16 v[28:31], a[172:175], a[240:243], v[28:31]
    ds_read_b64_tr_b16 a[150:151], v4 offset:9216
    v_mfma_f32_16x16x32_bf16 v[32:35], a[172:175], a[244:247], v[32:35]
    v_exp_f32 v18, v18
    v_mfma_f32_16x16x32_bf16 v[36:39], a[172:175], a[248:251], v[36:39]
    v_exp_f32 v19, v19
    v_mfma_f32_16x16x32_bf16 v[40:43], a[172:175], a[252:255], v[40:43]
    ds_read_b64_tr_b16 a[152:153], v3 offset:3072
    v_cvt_pk_bf16_f32 v193, v18, v19
    v_mfma_f32_16x16x32_bf16 a[128:131], v[236:239], v[204:207], a[128:131]
    ds_read_b64_tr_b16 a[154:155], v3 offset:11264
    v_mfma_f32_16x16x32_bf16 a[132:135], v[236:239], v[208:211], a[132:135]
    v_exp_f32 v20, v20
    v_mfma_f32_16x16x32_bf16 a[136:139], v[236:239], v[212:215], a[136:139]
    buffer_load_dwordx4 v1, s[4:7], s16 offen lds
    v_mfma_f32_16x16x32_bf16 a[140:143], v[236:239], v[216:219], a[140:143]
    ds_read_b64_tr_b16 a[156:157], v4 offset:3072
    s_waitcnt lgkmcnt(3)
    v_mfma_f32_16x16x32_bf16 v[108:111], a[144:147], v[204:207], v[108:111]
    ds_read_b64_tr_b16 a[158:159], v4 offset:11264
    v_mfma_f32_16x16x32_bf16 v[112:115], a[144:147], v[208:211], v[112:115]
    v_exp_f32 v21, v21
    v_mfma_f32_16x16x32_bf16 v[116:119], a[144:147], v[212:215], v[116:119]
    v_exp_f32 v22, v22
    v_mfma_f32_16x16x32_bf16 v[120:123], a[144:147], v[216:219], v[120:123]
    ds_read_b64_tr_b16 a[160:161], v3 offset:5120
    v_cvt_pk_bf16_f32 v196, v20, v21
    v_mfma_f32_16x16x32_bf16 v[124:127], a[148:151], v[204:207], v[124:127]
    ds_read_b64_tr_b16 a[162:163], v3 offset:13312
    v_mfma_f32_16x16x32_bf16 v[128:131], a[148:151], v[208:211], v[128:131]
    v_exp_f32 v23, v23
    v_mfma_f32_16x16x32_bf16 v[132:135], a[148:151], v[212:215], v[132:135]
    buffer_load_dwordx4 v1, s[8:11], s16 offen offset:1024 lds
    v_mfma_f32_16x16x32_bf16 v[136:139], a[148:151], v[216:219], v[136:139]
    ds_read_b64_tr_b16 a[164:165], v4 offset:5120
    s_waitcnt lgkmcnt(3)
    v_mfma_f32_16x16x32_bf16 v[140:143], a[152:155], v[204:207], v[140:143]
    ds_read_b64_tr_b16 a[166:167], v4 offset:13312
    v_cvt_pk_bf16_f32 v197, v22, v23
    v_mfma_f32_16x16x32_bf16 v[144:147], a[152:155], v[208:211], v[144:147]
    s_mov_b32 s23, s22
    v_exp_f32 v24, v24
    v_mfma_f32_16x16x32_bf16 v[148:151], a[152:155], v[212:215], v[148:151]
    s_add_u32 s22, s22, 16384
    s_sub_u32 s24, s22, s99
    s_min_u32 s22, s22, s24
    v_exp_f32 v25, v25
    v_mfma_f32_16x16x32_bf16 v[152:155], a[152:155], v[216:219], v[152:155]
    ds_read_b64_tr_b16 a[168:169], v3 offset:7168
    v_cvt_pk_bf16_f32 v200, v24, v25
    v_mfma_f32_16x16x32_bf16 v[156:159], a[156:159], v[204:207], v[156:159]
    ds_read_b64_tr_b16 a[170:171], v3 offset:15360
    v_xor_b32 v5, s22, v8
    v_mfma_f32_16x16x32_bf16 v[160:163], a[156:159], v[208:211], v[160:163]
    s_add_u32 s19, m0, 8192
    v_exp_f32 v26, v26
    v_mfma_f32_16x16x32_bf16 v[164:167], a[156:159], v[212:215], v[164:167]
    s_sub_u32 s21, s19, s99
    v_exp_f32 v27, v27
    v_mfma_f32_16x16x32_bf16 v[168:171], a[156:159], v[216:219], v[168:171]
    ds_read_b64_tr_b16 a[172:173], v4 offset:7168
    s_waitcnt lgkmcnt(3)
    v_mfma_f32_16x16x32_bf16 v[44:47], a[160:163], v[204:207], v[44:47]
    ds_read_b64_tr_b16 a[174:175], v4 offset:15360
    v_cvt_pk_bf16_f32 v201, v26, v27
    v_mfma_f32_16x16x32_bf16 v[48:51], a[160:163], v[208:211], v[48:51]
    s_min_u32 m0, s19, s21
    v_exp_f32 v28, v28
    v_mfma_f32_16x16x32_bf16 v[52:55], a[160:163], v[212:215], v[52:55]
    s_waitcnt vmcnt(11)
    s_barrier
    s_add_u32 s16, s16, s17
    v_mfma_f32_16x16x32_bf16 v[56:59], a[160:163], v[216:219], v[56:59]
    ds_read_b128 a[144:147], v5 offset:0
    s_add_u32 s20, s16, s18
    v_mfma_f32_16x16x32_bf16 v[60:63], a[164:167], v[204:207], v[60:63]
    s_min_u32 s16, s16, s20
    v_exp_f32 v29, v29
    v_mfma_f32_16x16x32_bf16 v[64:67], a[164:167], v[208:211], v[64:67]
    v_exp_f32 v30, v30
    v_mfma_f32_16x16x32_bf16 v[68:71], a[164:167], v[212:215], v[68:71]
    v_exp_f32 v31, v31
    v_mfma_f32_16x16x32_bf16 v[72:75], a[164:167], v[216:219], v[72:75]
    ds_read_b128 a[148:151], v5 offset:2048
    s_waitcnt lgkmcnt(2)
    v_mfma_f32_16x16x32_bf16 v[76:79], a[168:171], v[204:207], v[76:79]
    v_exp_f32 v32, v32
    v_mfma_f32_16x16x32_bf16 v[80:83], a[168:171], v[208:211], v[80:83]
    v_exp_f32 v33, v33
    v_mfma_f32_16x16x32_bf16 v[84:87], a[168:171], v[212:215], v[84:87]
    v_exp_f32 v34, v34
    v_mfma_f32_16x16x32_bf16 v[88:91], a[168:171], v[216:219], v[88:91]
    ds_read_b128 a[152:155], v5 offset:4096
    v_cvt_pk_bf16_f32 v190, v28, v29
    v_mfma_f32_16x16x32_bf16 v[92:95], a[172:175], v[204:207], v[92:95]
    v_exp_f32 v35, v35
    v_mfma_f32_16x16x32_bf16 v[96:99], a[172:175], v[208:211], v[96:99]
    v_exp_f32 v36, v36
    v_mfma_f32_16x16x32_bf16 v[100:103], a[172:175], v[212:215], v[100:103]
    v_exp_f32 v37, v37
    v_mfma_f32_16x16x32_bf16 v[104:107], a[172:175], v[216:219], v[104:107]
    ds_read_b128 a[156:159], v5 offset:6144
    s_waitcnt lgkmcnt(2)
    v_mfma_f32_16x16x32_bf16 v[12:15], a[144:147], a[192:195], v[220:223]
    s_cmp_eq_u32 s25, 1
    s_cbranch_scc1 TA_SW24
TA_SW24r:
    v_mfma_f32_16x16x32_bf16 v[16:19], a[144:147], a[196:199], v[224:227]
    buffer_load_dwordx4 v1, s[4:7], s16 offen lds
    v_mfma_f32_16x16x32_bf16 v[20:23], a[144:147], a[200:203], v[228:231]
    v_exp_f32 v38, v38
    v_mfma_f32_16x16x32_bf16 v[24:27], a[144:147], a[204:207], v[232:235]
    ds_read_b128 a[160:163], v5 offset:8192
    v_cvt_pk_bf16_f32 v191, v30, v31
    v_mfma_f32_16x16x32_bf16 v[12:15], a[148:151], a[208:211], v[12:15]
    buffer_load_dword v181, v183, s[76:79], s80 offen
    v_mfma_f32_16x16x32_bf16 v[16:19], a[148:151], a[212:215], v[16:19]
    s_add_u32 s80, s80, 131072
    v_exp_f32 v39, v39
    v_mfma_f32_16x16x32_bf16 v[20:23], a[148:151], a[216:219], v[20:23]
    v_exp_f32 v40, v40
    v_mfma_f32_16x16x32_bf16 v[24:27], a[148:151], a[220:223], v[24:27]
    ds_read_b128 a[164:167], v5 offset:10240
    s_waitcnt lgkmcnt(2)
    v_mfma_f32_16x16x32_bf16 v[12:15], a[152:155], a[224:227], v[12:15]
    v_exp_f32 v41, v41
    v_mfma_f32_16x16x32_bf16 v[16:19], a[152:155], a[228:231], v[16:19]
    buffer_load_dwordx4 v1, s[8:11], s16 offen offset:1024 lds
    v_mfma_f32_16x16x32_bf16 v[20:23], a[152:155], a[232:235], v[20:23]
    s_add_u32 s19, m0, 8192
    v_exp_f32 v42, v42
    v_mfma_f32_16x16x32_bf16 v[24:27], a[152:155], a[236:239], v[24:27]
    ds_read_b128 a[168:171], v5 offset:12288
    v_cvt_pk_bf16_f32 v194, v32, v33
    v_mfma_f32_16x16x32_bf16 v[12:15], a[156:159], a[240:243], v[12:15]
    s_sub_u32 s21, s19, s99
    v_exp_f32 v43, v43
    v_mfma_f32_16x16x32_bf16 v[16:19], a[156:159], a[244:247], v[16:19]
    s_min_u32 m0, s19, s21
    v_cvt_pk_bf16_f32 v195, v34, v35
    v_cvt_pk_bf16_f32 v198, v36, v37
    v_cvt_pk_bf16_f32 v203, v42, v43
    v_mfma_f32_16x16x32_bf16 v[20:23], a[156:159], a[248:251], v[20:23]
    s_add_u32 s16, s16, s17
    v_cvt_pk_bf16_f32 v199, v38, v39
    v_cvt_pk_bf16_f32 v202, v40, v41
    v_mfma_f32_16x16x32_bf16 v[24:27], a[156:159], a[252:255], v[24:27]
    ds_read_b128 a[172:175], v5 offset:14336
    s_waitcnt lgkmcnt(2)
    v_mfma_f32_16x16x32_bf16 v[28:31], a[160:163], a[192:195], v[220:223]
    s_add_u32 s20, s16, s18
    v_xor_b32 v3, s23, v6
    v_xor_b32 v4, 32, v3
    v_mfma_f32_16x16x32_bf16 v[32:35], a[160:163], a[196:199], v[224:227]
    s_min_u32 s16, s16, s20
    v_exp_f32 v12, v12
    v_mfma_f32_16x16x32_bf16 v[36:39], a[160:163], a[200:203], v[228:231]
    v_exp_f32 v13, v13
    v_mfma_f32_16x16x32_bf16 v[40:43], a[160:163], a[204:207], v[232:235]
    v_exp_f32 v14, v14
    v_mfma_f32_16x16x32_bf16 v[28:31], a[164:167], a[208:211], v[28:31]
    v_exp_f32 v15, v15
    v_mfma_f32_16x16x32_bf16 v[32:35], a[164:167], a[212:215], v[32:35]
    v_exp_f32 v16, v16
    v_mfma_f32_16x16x32_bf16 v[36:39], a[164:167], a[216:219], v[36:39]
    v_exp_f32 v17, v17
    v_mfma_f32_16x16x32_bf16 v[40:43], a[164:167], a[220:223], v[40:43]
    ds_read_b64_tr_b16 a[144:145], v3 offset:1024
    s_waitcnt lgkmcnt(1)
    v_mfma_f32_16x16x32_bf16 v[28:31], a[168:171], a[224:227], v[28:31]
    ds_read_b64_tr_b16 a[146:147], v3 offset:9216
    v_cvt_pk_bf16_f32 v204, v12, v13
    v_mfma_f32_16x16x32_bf16 v[32:35], a[168:171], a[228:231], v[32:35]
    v_exp_f32 v18, v18
    v_mfma_f32_16x16x32_bf16 v[36:39], a[168:171], a[232:235], v[36:39]
    v_exp_f32 v19, v19
    v_mfma_f32_16x16x32_bf16 v[40:43], a[168:171], a[236:239], v[40:43]
    ds_read_b64_tr_b16 a[148:149], v4 offset:1024
    v_cvt_pk_bf16_f32 v205, v14, v15
    v_mfma_f32_16x16x32_bf16 v[28:31], a[172:175], a[240:243], v[28:31]
    ds_read_b64_tr_b16 a[150:151], v4 offset:9216
    v_cvt_pk_bf16_f32 v208, v16, v17
    v_mfma_f32_16x16x32_bf16 v[32:35], a[172:175], a[244:247], v[32:35]
    v_exp_f32 v20, v20
    v_mfma_f32_16x16x32_bf16 v[36:39], a[172:175], a[248:251], v[36:39]
    v_exp_f32 v21, v21
    v_mfma_f32_16x16x32_bf16 v[40:43], a[172:175], a[252:255], v[40:43]
    ds_read_b64_tr_b16 a[152:153], v3 offset:3072
    v_cvt_pk_bf16_f32 v209, v18, v19
    v_mfma_f32_16x16x32_bf16 a[128:131], v[236:239], v[188:191], a[128:131]
    ds_read_b64_tr_b16 a[154:155], v3 offset:11264
    v_cvt_pk_bf16_f32 v212, v20, v21
    v_mfma_f32_16x16x32_bf16 a[132:135], v[236:239], v[192:195], a[132:135]
    v_exp_f32 v22, v22
    v_mfma_f32_16x16x32_bf16 a[136:139], v[236:239], v[196:199], a[136:139]
    buffer_load_dwordx4 v1, s[4:7], s16 offen lds
    v_mfma_f32_16x16x32_bf16 a[140:143], v[236:239], v[200:203], a[140:143]
    ds_read_b64_tr_b16 a[156:157], v4 offset:3072
    s_waitcnt lgkmcnt(3)
    s_sub_u32 s25, s25, 1
    s_cbranch_scc0 TA_At214
    v_mfma_f32_16x16x32_bf16 v[108:111], a[144:147], v[188:191], v[108:111]
    ds_read_b64_tr_b16 a[158:159], v4 offset:11264
    s_add_u32 s19, m0, 8192
    v_mfma_f32_16x16x32_bf16 v[112:115], a[144:147], v[192:195], v[112:115]
    ds_read_b64_tr_b16 a[160:161], v3 offset:5120
    s_sub_u32 s21, s19, s99
    v_mfma_f32_16x16x32_bf16 v[116:119], a[144:147], v[196:199], v[116:119]
    ds_read_b64_tr_b16 a[162:163], v3 offset:13312
    s_mov_b32 s23, s22
    v_mfma_f32_16x16x32_bf16 v[120:123], a[144:147], v[200:203], v[120:123]
    ds_read_b64_tr_b16 a[164:165], v4 offset:5120
    v_mfma_f32_16x16x32_bf16 v[124:127], a[148:151], v[188:191], v[124:127]
    ds_read_b64_tr_b16 a[166:167], v4 offset:13312
    v_mfma_f32_16x16x32_bf16 v[128:131], a[148:151], v[192:195], v[128:131]
    buffer_load_dwordx4 v1, s[8:11], s16 offen offset:1024 lds
    v_mfma_f32_16x16x32_bf16 v[132:135], a[148:151], v[196:199], v[132:135]
    ds_read_b64_tr_b16 a[168:169], v3 offset:7168
    s_add_u32 s16, s16, s17
    v_mfma_f32_16x16x32_bf16 v[136:139], a[148:151], v[200:203], v[136:139]
    ds_read_b64_tr_b16 a[170:171], v3 offset:15360
    s_add_u32 s20, s16, s18
    s_waitcnt lgkmcnt(8)
    v_mfma_f32_16x16x32_bf16 v[140:143], a[152:155], v[188:191], v[140:143]
    ds_read_b64_tr_b16 a[172:173], v4 offset:7168
    s_min_u32 m0, s19, s21
    v_mfma_f32_16x16x32_bf16 v[144:147], a[152:155], v[192:195], v[144:147]
    ds_read_b64_tr_b16 a[174:175], v4 offset:15360
    s_min_u32 s16, s16, s20
    v_mfma_f32_16x16x32_bf16 v[148:151], a[152:155], v[196:199], v[148:151]
    s_add_u32 s19, m0, 8192
    v_exp_f32 v28, v28
    v_mfma_f32_16x16x32_bf16 v[152:155], a[152:155], v[200:203], v[152:155]
    s_sub_u32 s21, s19, s99
    v_exp_f32 v29, v29
    s_waitcnt lgkmcnt(8)
    v_mfma_f32_16x16x32_bf16 v[156:159], a[156:159], v[188:191], v[156:159]
    v_exp_f32 v30, v30
    v_mfma_f32_16x16x32_bf16 v[160:163], a[156:159], v[192:195], v[160:163]
    v_exp_f32 v31, v31
    v_mfma_f32_16x16x32_bf16 v[164:167], a[156:159], v[196:199], v[164:167]
    v_cvt_pk_bf16_f32 v206, v28, v29
    v_cvt_pk_bf16_f32 v207, v30, v31
    v_mfma_f32_16x16x32_bf16 v[168:171], a[156:159], v[200:203], v[168:171]
    v_exp_f32 v32, v32
    s_waitcnt lgkmcnt(6)
    v_mfma_f32_16x16x32_bf16 v[44:47], a[160:163], v[188:191], v[44:47]
    v_exp_f32 v33, v33
    v_mfma_f32_16x16x32_bf16 v[48:51], a[160:163], v[192:195], v[48:51]
    s_barrier
    v_cvt_pk_bf16_f32 v210, v32, v33
    v_mfma_f32_16x16x32_bf16 v[52:55], a[160:163], v[196:199], v[52:55]
    buffer_load_dwordx4 v1, s[4:7], s16 offen lds
    v_mfma_f32_16x16x32_bf16 v[56:59], a[160:163], v[200:203], v[56:59]
    buffer_load_dwordx4 v1, s[8:11], s16 offen offset:1024 lds
    s_waitcnt lgkmcnt(4)
    v_mfma_f32_16x16x32_bf16 v[60:63], a[164:167], v[188:191], v[60:63]
    s_add_u32 s16, s16, s17
    v_exp_f32 v34, v34
    v_mfma_f32_16x16x32_bf16 v[64:67], a[164:167], v[192:195], v[64:67]
    s_add_u32 s20, s16, s18
    v_exp_f32 v35, v35
    v_mfma_f32_16x16x32_bf16 v[68:71], a[164:167], v[196:199], v[68:71]
    s_min_u32 m0, s19, s21
    v_cvt_pk_bf16_f32 v211, v34, v35
    s_min_u32 s16, s16, s20
    v_mfma_f32_16x16x32_bf16 v[72:75], a[164:167], v[200:203], v[72:75]
    v_exp_f32 v23, v23
    s_waitcnt lgkmcnt(2)
    v_mfma_f32_16x16x32_bf16 v[76:79], a[168:171], v[188:191], v[76:79]
    v_exp_f32 v36, v36
    v_mfma_f32_16x16x32_bf16 v[80:83], a[168:171], v[192:195], v[80:83]
    v_exp_f32 v37, v37
    v_mfma_f32_16x16x32_bf16 v[84:87], a[168:171], v[196:199], v[84:87]
    v_exp_f32 v38, v38
    v_mfma_f32_16x16x32_bf16 v[88:91], a[168:171], v[200:203], v[88:91]
    v_exp_f32 v39, v39
    s_waitcnt lgkmcnt(0)
    v_mfma_f32_16x16x32_bf16 v[92:95], a[172:175], v[188:191], v[92:95]
    v_cvt_pk_bf16_f32 v213, v22, v23
    v_cvt_pk_bf16_f32 v214, v36, v37
    v_mfma_f32_16x16x32_bf16 v[96:99], a[172:175], v[192:195], v[96:99]
    v_cvt_pk_bf16_f32 v215, v38, v39
    v_xor_b32 v3, s23, v6
    v_mfma_f32_16x16x32_bf16 v[100:103], a[172:175], v[196:199], v[100:103]
    ds_read_b64_tr_b16 a[144:145], v3 offset:1024
    v_xor_b32 v4, 32, v3
    v_mfma_f32_16x16x32_bf16 v[104:107], a[172:175], v[200:203], v[104:107]
    ds_read_b64_tr_b16 a[146:147], v3 offset:9216
    v_mfma_f32_16x16x32_bf16 a[128:131], v[236:239], v[204:207], a[128:131]
    ds_read_b64_tr_b16 a[148:149], v4 offset:1024
    v_mfma_f32_16x16x32_bf16 a[132:135], v[236:239], v[208:211], a[132:135]
    buffer_load_dwordx4 v1, s[4:7], s16 offen lds
    v_mfma_f32_16x16x32_bf16 a[136:139], v[236:239], v[212:215], a[136:139]
    ds_read_b64_tr_b16 a[150:151], v4 offset:9216
    v_exp_f32 v24, v24
    v_exp_f32 v25, v25
    v_exp_f32 v26, v26
    v_exp_f32 v27, v27
    v_exp_f32 v40, v40
    v_exp_f32 v41, v41
    v_exp_f32 v42, v42
    v_exp_f32 v43, v43
    v_cvt_pk_bf16_f32 v216, v24, v25
    v_cvt_pk_bf16_f32 v217, v26, v27
    v_cvt_pk_bf16_f32 v218, v40, v41
    v_cvt_pk_bf16_f32 v219, v42, v43
    v_accvgpr_read_b32 v240, a128
    v_accvgpr_read_b32 v241, a132
    v_mfma_f32_16x16x32_bf16 a[140:143], v[236:239], v[216:219], a[140:143]
    ds_read_b64_tr_b16 a[152:153], v3 offset:3072
    v_accvgpr_read_b32 v242, a136
    v_add_f32 v245, v240, v241
    ds_read_b64_tr_b16 a[154:155], v3 offset:11264
    s_nop 3
    v_accvgpr_read_b32 v243, a140
    v_add_f32 v244, v242, v243
    v_add_f32 v244, v244, v245
    v_cmp_ngt_f32 vcc, 1233125376, v244
    s_nop 3
    s_cbranch_vccnz TA_At2slow16
TA_At2norm17:
    s_waitcnt lgkmcnt(4)
    v_mfma_f32_16x16x32_bf16 v[108:111], a[144:147], v[204:207], v[108:111]
    ds_read_b64_tr_b16 a[156:157], v4 offset:3072
    s_lshl_b32 s22, s27, 10
    v_mfma_f32_16x16x32_bf16 v[112:115], a[144:147], v[208:211], v[112:115]
    ds_read_b64_tr_b16 a[158:159], v4 offset:11264
    s_add_u32 s22, s22, 8192
    v_mfma_f32_16x16x32_bf16 v[116:119], a[144:147], v[212:215], v[116:119]
    ds_read_b64_tr_b16 a[160:161], v3 offset:5120
    s_add_u32 s22, s22, 8192
    v_mfma_f32_16x16x32_bf16 v[120:123], a[144:147], v[216:219], v[120:123]
    ds_read_b64_tr_b16 a[162:163], v3 offset:13312
    s_sub_u32 s24, s22, s99
    s_waitcnt lgkmcnt(6)
    v_mfma_f32_16x16x32_bf16 v[124:127], a[148:151], v[204:207], v[124:127]
    ds_read_b64_tr_b16 a[164:165], v4 offset:5120
    s_min_u32 s22, s22, s24
    v_mfma_f32_16x16x32_bf16 v[128:131], a[148:151], v[208:211], v[128:131]
    ds_read_b64_tr_b16 a[166:167], v4 offset:13312
    s_add_u32 s19, m0, 8192
    v_mfma_f32_16x16x32_bf16 v[132:135], a[148:151], v[212:215], v[132:135]
    buffer_load_dwordx4 v1, s[8:11], s16 offen offset:1024 lds
    v_mfma_f32_16x16x32_bf16 v[136:139], a[148:151], v[216:219], v[136:139]
    ds_read_b64_tr_b16 a[168:169], v3 offset:7168
    s_add_u32 s16, s16, s17
    s_waitcnt lgkmcnt(7)
    v_mfma_f32_16x16x32_bf16 v[140:143], a[152:155], v[204:207], v[140:143]
    ds_read_b64_tr_b16 a[170:171], v3 offset:15360
    v_xor_b32 v3, s22, v6
    v_mfma_f32_16x16x32_bf16 v[144:147], a[152:155], v[208:211], v[144:147]
    ds_read_b64_tr_b16 a[172:173], v4 offset:7168
    s_add_u32 s22, s22, 8192
    v_mfma_f32_16x16x32_bf16 v[148:151], a[152:155], v[212:215], v[148:151]
    ds_read_b64_tr_b16 a[174:175], v4 offset:15360
    v_xor_b32 v4, 32, v3
    v_mfma_f32_16x16x32_bf16 v[152:155], a[152:155], v[216:219], v[152:155]
    s_sub_u32 s24, s22, s99
    s_min_u32 s22, s22, s24
    s_sub_u32 s21, s19, s99
    s_waitcnt lgkmcnt(8)
    v_mfma_f32_16x16x32_bf16 v[156:159], a[156:159], v[204:207], v[156:159]
    s_add_u32 s20, s16, s18
    s_min_u32 m0, s19, s21
    s_min_u32 s16, s16, s20
    v_mfma_f32_16x16x32_bf16 v[160:163], a[156:159], v[208:211], v[160:163]
    s_add_u32 s19, m0, 8192
    v_mov_b32 v187, -1
    s_sub_u32 s21, s19, s99
    v_mfma_f32_16x16x32_bf16 v[164:167], a[156:159], v[212:215], v[164:167]
    s_mul_i32 s32, s29, 2359296
    v_accvgpr_read_b32 v240, a128
    v_accvgpr_read_b32 v242, a132
    v_mfma_f32_16x16x32_bf16 v[168:171], a[156:159], v[216:219], v[168:171]
    s_mul_i32 s34, s57, 147456
    v_rcp_f32 v240, v240
    s_waitcnt lgkmcnt(6)
    v_mfma_f32_16x16x32_bf16 v[44:47], a[160:163], v[204:207], v[44:47]
    s_waitcnt vmcnt(15)
    s_barrier
    v_accvgpr_read_b32 v244, a136
    v_mfma_f32_16x16x32_bf16 v[48:51], a[160:163], v[208:211], v[48:51]
    ds_read_b64_tr_b16 a[176:177], v3 offset:0
    v_accvgpr_read_b32 v246, a140
    v_mfma_f32_16x16x32_bf16 v[52:55], a[160:163], v[212:215], v[52:55]
    ds_read_b64_tr_b16 a[178:179], v3 offset:2048
    v_mul_f32 v108, v108, v240
    v_mfma_f32_16x16x32_bf16 v[56:59], a[160:163], v[216:219], v[56:59]
    ds_read_b64_tr_b16 a[180:181], v4 offset:0
    v_mul_f32 v109, v109, v240
    s_waitcnt lgkmcnt(7)
    v_mfma_f32_16x16x32_bf16 v[60:63], a[164:167], v[204:207], v[60:63]
    ds_read_b64_tr_b16 a[182:183], v4 offset:2048
    v_mul_f32 v110, v110, v240
    v_mfma_f32_16x16x32_bf16 v[64:67], a[164:167], v[208:211], v[64:67]
    ds_read_b64_tr_b16 a[184:185], v3 offset:4096
    v_mul_f32 v111, v111, v240
    v_mfma_f32_16x16x32_bf16 v[68:71], a[164:167], v[212:215], v[68:71]
    ds_read_b64_tr_b16 a[186:187], v3 offset:6144
    v_xor_b32 v3, s22, v6
    v_mfma_f32_16x16x32_bf16 v[72:75], a[164:167], v[216:219], v[72:75]
    ds_read_b64_tr_b16 a[188:189], v4 offset:4096
    s_add_u32 s22, s22, 8192
    s_waitcnt lgkmcnt(9)
    v_mfma_f32_16x16x32_bf16 v[76:79], a[168:171], v[204:207], v[76:79]
    ds_read_b64_tr_b16 a[190:191], v4 offset:6144
    v_xor_b32 v4, 32, v3
    v_mfma_f32_16x16x32_bf16 v[80:83], a[168:171], v[208:211], v[80:83]
    s_sub_u32 s24, s22, s99
    s_min_u32 s22, s22, s24
    v_cvt_pk_bf16_f32 v108, v108, v109
    v_mfma_f32_16x16x32_bf16 v[84:87], a[168:171], v[212:215], v[84:87]
    s_add_u32 s32, s32, s34
    v_rcp_f32 v242, v242
    v_mfma_f32_16x16x32_bf16 v[88:91], a[168:171], v[216:219], v[88:91]
    s_add_u32 s32, s32, 4194304
    v_rcp_f32 v244, v244
    s_waitcnt lgkmcnt(8)
    v_mfma_f32_16x16x32_bf16 v[92:95], a[172:175], v[204:207], v[92:95]
    s_lshl_b32 s34, s27, 13
    v_rcp_f32 v246, v246
    v_mfma_f32_16x16x32_bf16 v[96:99], a[172:175], v[208:211], v[96:99]
    s_add_u32 s32, s32, s34
    v_mul_f32 v112, v112, v242
    v_mul_f32 v113, v113, v242
    v_mfma_f32_16x16x32_bf16 v[100:103], a[172:175], v[212:215], v[100:103]
    s_lshl_b32 s34, s28, 12
    v_cvt_pk_bf16_f32 v109, v110, v111
    v_mul_f32 v124, v124, v240
    v_mfma_f32_16x16x32_bf16 v[104:107], a[172:175], v[216:219], v[104:107]
    s_add_u32 s32, s32, s34
    v_mul_f32 v125, v125, v240
    v_mul_f32 v126, v126, v240
    s_waitcnt lgkmcnt(6)
    v_mfma_f32_16x16x32_bf16 v[12:15], a[176:179], a[0:3], 0
    s_lshl_b32 s34, s28, 15
    v_mul_f32 v127, v127, v240
    v_mul_f32 v114, v114, v242
    v_mfma_f32_16x16x32_bf16 v[16:19], a[176:179], a[4:7], 0
    s_add_u32 s34, s34, 98304
    v_mul_f32 v115, v115, v242
    v_cvt_pk_bf16_f32 v112, v112, v113
    v_mfma_f32_16x16x32_bf16 v[20:23], a[176:179], a[8:11], 0
    s_mov_b32 s33, 0xf0000000
    v_mul_f32 v116, v116, v244
    v_mul_f32 v117, v117, v244
    v_mfma_f32_16x16x32_bf16 v[24:27], a[176:179], a[12:15], 0
    ds_read_b64_tr_b16 a[176:177], v3 offset:0
    v_cvt_pk_bf16_f32 v110, v124, v125
    s_waitcnt lgkmcnt(5)
    v_mfma_f32_16x16x32_bf16 v[28:31], a[180:183], a[0:3], 0
    ds_read_b64_tr_b16 a[178:179], v3 offset:2048
    v_cvt_pk_bf16_f32 v111, v126, v127
    v_mfma_f32_16x16x32_bf16 v[32:35], a[180:183], a[4:7], 0
    ds_write_b128 v182, v[108:111] offset:0
    v_mfma_f32_16x16x32_bf16 v[36:39], a[180:183], a[8:11], 0
    s_mov_b32 s33, s32
    v_cvt_pk_bf16_f32 v113, v114, v115
    v_mul_f32 v128, v128, v242
    v_mfma_f32_16x16x32_bf16 v[40:43], a[180:183], a[12:15], 0
    ds_read_b64_tr_b16 a[180:181], v4 offset:0
    v_mul_f32 v129, v129, v242
    s_waitcnt lgkmcnt(6)
    v_mfma_f32_16x16x32_bf16 v[12:15], a[184:187], a[16:19], v[12:15]
    ds_read_b64_tr_b16 a[182:183], v4 offset:2048
    v_mul_f32 v130, v130, v242
    v_mfma_f32_16x16x32_bf16 v[16:19], a[184:187], a[20:23], v[16:19]
    s_add_u32 s32, s32, 16384
    v_mul_f32 v131, v131, v242
    v_mul_f32 v118, v118, v244
    v_mfma_f32_16x16x32_bf16 v[20:23], a[184:187], a[24:27], v[20:23]
    v_mul_f32 v119, v119, v244
    v_cvt_pk_bf16_f32 v116, v116, v117
    v_mfma_f32_16x16x32_bf16 v[24:27], a[184:187], a[28:31], v[24:27]
    ds_read_b64_tr_b16 a[184:185], v3 offset:4096
    v_mul_f32 v120, v120, v246
    s_waitcnt lgkmcnt(6)
    v_mfma_f32_16x16x32_bf16 v[28:31], a[188:191], a[16:19], v[28:31]
    ds_read_b64_tr_b16 a[186:187], v3 offset:6144
    v_xor_b32 v3, s22, v6
    v_mfma_f32_16x16x32_bf16 v[32:35], a[188:191], a[20:23], v[32:35]
    buffer_load_dwordx4 v1, s[4:7], s16 offen lds
    v_mfma_f32_16x16x32_bf16 v[36:39], a[188:191], a[24:27], v[36:39]
    s_add_u32 s22, s22, 8192
    s_sub_u32 s24, s22, s99
    s_min_u32 s22, s22, s24
    v_mfma_f32_16x16x32_bf16 v[40:43], a[188:191], a[28:31], v[40:43]
    ds_read_b64_tr_b16 a[188:189], v4 offset:4096
    v_mul_f32 v121, v121, v246
    s_waitcnt lgkmcnt(6)
    v_mfma_f32_16x16x32_bf16 v[12:15], a[176:179], a[32:35], v[12:15]
    ds_read_b64_tr_b16 a[190:191], v4 offset:6144
    v_xor_b32 v4, 32, v3
    v_mfma_f32_16x16x32_bf16 v[16:19], a[176:179], a[36:39], v[16:19]
    s_waitcnt vmcnt(10)
    s_barrier
    v_cvt_pk_bf16_f32 v114, v128, v129
    v_mfma_f32_16x16x32_bf16 v[20:23], a[176:179], a[40:43], v[20:23]
    buffer_load_dwordx4 v1, s[8:11], s16 offen offset:1024 lds
    v_mfma_f32_16x16x32_bf16 v[24:27], a[176:179], a[44:47], v[24:27]
    ds_read_b64_tr_b16 a[176:177], v3 offset:0
    s_add_u32 s16, s16, s17
    s_waitcnt lgkmcnt(5)
    v_mfma_f32_16x16x32_bf16 v[28:31], a[180:183], a[32:35], v[28:31]
    ds_read_b64_tr_b16 a[178:179], v3 offset:2048
    s_add_u32 s20, s16, s18
    v_mfma_f32_16x16x32_bf16 v[32:35], a[180:183], a[36:39], v[32:35]
    s_mov_b64 exec, s[38:39]
    buffer_store_dword v187, v184, s[12:15], s35 offen sc1
    s_mov_b64 exec, -1
    v_mfma_f32_16x16x32_bf16 v[36:39], a[180:183], a[40:43], v[36:39]
    s_min_u32 m0, s19, s21
    s_min_u32 s16, s16, s20
    s_add_u32 s19, m0, 8192
    v_mfma_f32_16x16x32_bf16 v[40:43], a[180:183], a[44:47], v[40:43]
    ds_read_b64_tr_b16 a[180:181], v4 offset:0
    s_sub_u32 s21, s19, s99
    s_waitcnt lgkmcnt(5)
    v_mfma_f32_16x16x32_bf16 v[12:15], a[184:187], a[48:51], v[12:15]
    ds_read_b64_tr_b16 a[182:183], v4 offset:2048
    v_cvt_pk_bf16_f32 v115, v130, v131
    v_mfma_f32_16x16x32_bf16 v[16:19], a[184:187], a[52:55], v[16:19]
    ds_write_b128 v182, v[112:115] offset:1024
    v_mfma_f32_16x16x32_bf16 v[20:23], a[184:187], a[56:59], v[20:23]
    buffer_load_dwordx4 v1, s[4:7], s16 offen lds
    v_mfma_f32_16x16x32_bf16 v[24:27], a[184:187], a[60:63], v[24:27]
    ds_read_b64_tr_b16 a[184:185], v3 offset:4096
    v_cvt_pk_bf16_f32 v117, v118, v119
    s_waitcnt lgkmcnt(6)
    v_mfma_f32_16x16x32_bf16 v[28:31], a[188:191], a[48:51], v[28:31]
    ds_read_b64_tr_b16 a[186:187], v3 offset:6144
    v_xor_b32 v3, s22, v6
    v_mfma_f32_16x16x32_bf16 v[32:35], a[188:191], a[52:55], v[32:35]
    buffer_load_dwordx4 v1, s[8:11], s16 offen offset:1024 lds
    v_mfma_f32_16x16x32_bf16 v[36:39], a[188:191], a[56:59], v[36:39]
    s_add_u32 s16, s16, s17
    s_add_u32 s20, s16, s18
    s_min_u32 m0, s19, s21
    v_mfma_f32_16x16x32_bf16 v[40:43], a[188:191], a[60:63], v[40:43]
    ds_read_b64_tr_b16 a[188:189], v4 offset:4096
    s_min_u32 s16, s16, s20
    s_waitcnt lgkmcnt(6)
    v_mfma_f32_16x16x32_bf16 v[12:15], a[176:179], a[64:67], v[12:15]
    ds_read_b64_tr_b16 a[190:191], v4 offset:6144
    v_xor_b32 v4, 32, v3
    v_mfma_f32_16x16x32_bf16 v[16:19], a[176:179], a[68:71], v[16:19]
    s_add_u32 s22, s22, 8192
    v_mul_f32 v132, v132, v244
    v_mul_f32 v133, v133, v244
    v_mfma_f32_16x16x32_bf16 v[20:23], a[176:179], a[72:75], v[20:23]
    s_sub_u32 s24, s22, s99
    v_mul_f32 v134, v134, v244
    v_mul_f32 v135, v135, v244
    v_mfma_f32_16x16x32_bf16 v[24:27], a[176:179], a[76:79], v[24:27]
    ds_read_b64_tr_b16 a[176:177], v3 offset:0
    v_mul_f32 v122, v122, v246
    s_waitcnt lgkmcnt(6)
    v_mfma_f32_16x16x32_bf16 v[28:31], a[180:183], a[64:67], v[28:31]
    ds_read_b64_tr_b16 a[178:179], v3 offset:2048
    v_mul_f32 v123, v123, v246
    v_mfma_f32_16x16x32_bf16 v[32:35], a[180:183], a[68:71], v[32:35]
    buffer_load_dwordx4 v1, s[4:7], s16 offen lds
    v_mfma_f32_16x16x32_bf16 v[36:39], a[180:183], a[72:75], v[36:39]
    s_min_u32 s22, s22, s24
    v_cvt_pk_bf16_f32 v120, v120, v121
    v_mul_f32 v140, v140, v240
    v_mfma_f32_16x16x32_bf16 v[40:43], a[180:183], a[76:79], v[40:43]
    ds_read_b64_tr_b16 a[180:181], v4 offset:0
    v_mul_f32 v141, v141, v240
    s_waitcnt lgkmcnt(5)
    v_mfma_f32_16x16x32_bf16 v[12:15], a[184:187], a[80:83], v[12:15]
    ds_read_b64_tr_b16 a[182:183], v4 offset:2048
    v_cvt_pk_bf16_f32 v118, v132, v133
    v_mfma_f32_16x16x32_bf16 v[16:19], a[184:187], a[84:87], v[16:19]
    buffer_load_dwordx4 v1, s[8:11], s16 offen offset:1024 lds
    v_mfma_f32_16x16x32_bf16 v[20:23], a[184:187], a[88:91], v[20:23]
    s_add_u32 s19, m0, 8192
    v_cvt_pk_bf16_f32 v119, v134, v135
    v_cvt_pk_bf16_f32 v121, v122, v123
    v_mfma_f32_16x16x32_bf16 v[24:27], a[184:187], a[92:95], v[24:27]
    ds_write_b128 v182, v[116:119] offset:2048
    s_waitcnt lgkmcnt(5)
    v_mfma_f32_16x16x32_bf16 v[28:31], a[188:191], a[80:83], v[28:31]
    ds_read_b64_tr_b16 a[184:185], v3 offset:4096
    v_mul_f32 v136, v136, v246
    v_mfma_f32_16x16x32_bf16 v[32:35], a[188:191], a[84:87], v[32:35]
    ds_read_b64_tr_b16 a[186:187], v3 offset:6144
    v_mul_f32 v137, v137, v246
    v_mfma_f32_16x16x32_bf16 v[36:39], a[188:191], a[88:91], v[36:39]
    s_add_u32 s16, s16, s17
    v_mul_f32 v138, v138, v246
    v_mul_f32 v139, v139, v246
    v_mfma_f32_16x16x32_bf16 v[40:43], a[188:191], a[92:95], v[40:43]
    ds_read_b64_tr_b16 a[188:189], v4 offset:4096
    v_mul_f32 v142, v142, v240
    s_waitcnt lgkmcnt(6)
    v_mfma_f32_16x16x32_bf16 v[12:15], a[176:179], a[96:99], v[12:15]
    v_mul_f32 v143, v143, v240
    v_cvt_pk_bf16_f32 v140, v140, v141
    v_mfma_f32_16x16x32_bf16 v[16:19], a[176:179], a[100:103], v[16:19]
    v_mul_f32 v144, v144, v242
    v_mul_f32 v145, v145, v242
    v_mfma_f32_16x16x32_bf16 v[20:23], a[176:179], a[104:107], v[20:23]
    v_cvt_pk_bf16_f32 v122, v136, v137
    v_cvt_pk_bf16_f32 v123, v138, v139
    v_mfma_f32_16x16x32_bf16 v[24:27], a[176:179], a[108:111], v[24:27]
    ds_write_b128 v182, v[120:123] offset:3072
    s_waitcnt lgkmcnt(5)
    v_mfma_f32_16x16x32_bf16 v[28:31], a[180:183], a[96:99], v[28:31]
    ds_read_b64_tr_b16 a[190:191], v4 offset:6144
    v_cvt_pk_bf16_f32 v141, v142, v143
    v_mfma_f32_16x16x32_bf16 v[32:35], a[180:183], a[100:103], v[32:35]
    v_mul_f32 v156, v156, v240
    v_mul_f32 v157, v157, v240
    v_mfma_f32_16x16x32_bf16 v[36:39], a[180:183], a[104:107], v[36:39]
    v_mul_f32 v158, v158, v240
    v_mul_f32 v159, v159, v240
    v_mfma_f32_16x16x32_bf16 v[40:43], a[180:183], a[108:111], v[40:43]
    s_waitcnt vmcnt(10)
    s_barrier
    v_mul_f32 v146, v146, v242
    s_waitcnt lgkmcnt(3)
    v_mfma_f32_16x16x32_bf16 v[12:15], a[184:187], a[112:115], v[12:15]
    v_mul_f32 v147, v147, v242
    v_cvt_pk_bf16_f32 v144, v144, v145
    v_mfma_f32_16x16x32_bf16 v[16:19], a[184:187], a[116:119], v[16:19]
    v_mul_f32 v148, v148, v244
    v_mul_f32 v149, v149, v244
    v_mfma_f32_16x16x32_bf16 v[20:23], a[184:187], a[120:123], v[20:23]
    v_cvt_pk_bf16_f32 v142, v156, v157
    v_cvt_pk_bf16_f32 v143, v158, v159
    v_mfma_f32_16x16x32_bf16 v[24:27], a[184:187], a[124:127], v[24:27]
    ds_write_b128 v182, v[140:143] offset:4096
    v_cvt_pk_bf16_f32 v145, v146, v147
    v_mul_f32 v160, v160, v242
    v_mul_f32 v161, v161, v242
    v_mul_f32 v162, v162, v242
    v_mul_f32 v163, v163, v242
    v_mul_f32 v150, v150, v244
    v_mul_f32 v151, v151, v244
    v_cvt_pk_bf16_f32 v148, v148, v149
    v_mul_f32 v152, v152, v246
    v_mul_f32 v153, v153, v246
    v_cvt_pk_bf16_f32 v146, v160, v161
    v_cvt_pk_bf16_f32 v147, v162, v163
    v_cvt_pk_bf16_f32 v149, v150, v151
    v_mul_f32 v164, v164, v244
    v_mul_f32 v165, v165, v244
    v_mul_f32 v166, v166, v244
    v_mul_f32 v167, v167, v244
    v_mul_f32 v154, v154, v246
    v_mul_f32 v155, v155, v246
    v_cvt_pk_bf16_f32 v152, v152, v153
    v_mul_f32 v44, v44, v240
    v_mul_f32 v45, v45, v240
    v_cvt_pk_bf16_f32 v150, v164, v165
    v_cvt_pk_bf16_f32 v151, v166, v167
    v_cvt_pk_bf16_f32 v153, v154, v155
    v_mul_f32 v168, v168, v246
    v_mul_f32 v169, v169, v246
    v_mul_f32 v170, v170, v246
    v_mul_f32 v171, v171, v246
    v_mul_f32 v46, v46, v240
    v_mul_f32 v47, v47, v240
    v_cvt_pk_bf16_f32 v44, v44, v45
    v_mul_f32 v48, v48, v242
    v_mul_f32 v49, v49, v242
    v_cvt_pk_bf16_f32 v154, v168, v169
    v_cvt_pk_bf16_f32 v155, v170, v171
    v_cvt_pk_bf16_f32 v45, v46, v47
    v_mul_f32 v60, v60, v240
    v_mul_f32 v61, v61, v240
    v_mul_f32 v62, v62, v240
    v_mul_f32 v63, v63, v240
    v_mul_f32 v50, v50, v242
    v_mul_f32 v51, v51, v242
    v_cvt_pk_bf16_f32 v48, v48, v49
    v_mul_f32 v52, v52, v244
    v_mul_f32 v53, v53, v244
    v_cvt_pk_bf16_f32 v46, v60, v61
    v_cvt_pk_bf16_f32 v47, v62, v63
    v_cvt_pk_bf16_f32 v49, v50, v51
    v_mul_f32 v64, v64, v242
    v_mul_f32 v65, v65, v242
    v_mul_f32 v66, v66, v242
    v_mul_f32 v67, v67, v242
    v_mul_f32 v54, v54, v244
    v_mul_f32 v55, v55, v244
    v_cvt_pk_bf16_f32 v52, v52, v53
    v_mul_f32 v56, v56, v246
    v_mul_f32 v57, v57, v246
    v_cvt_pk_bf16_f32 v50, v64, v65
    v_cvt_pk_bf16_f32 v51, v66, v67
    v_cvt_pk_bf16_f32 v53, v54, v55
    v_mul_f32 v68, v68, v244
    v_mul_f32 v69, v69, v244
    v_mul_f32 v70, v70, v244
    v_mul_f32 v71, v71, v244
    v_mul_f32 v58, v58, v246
    v_mul_f32 v59, v59, v246
    v_cvt_pk_bf16_f32 v56, v56, v57
    v_mul_f32 v76, v76, v240
    v_mul_f32 v77, v77, v240
    v_cvt_pk_bf16_f32 v54, v68, v69
    v_cvt_pk_bf16_f32 v55, v70, v71
    v_cvt_pk_bf16_f32 v57, v58, v59
    v_mul_f32 v72, v72, v246
    v_mul_f32 v73, v73, v246
    v_mul_f32 v74, v74, v246
    v_mul_f32 v75, v75, v246
    v_mul_f32 v78, v78, v240
    v_mul_f32 v79, v79, v240
    v_cvt_pk_bf16_f32 v76, v76, v77
    v_mul_f32 v80, v80, v242
    v_mul_f32 v81, v81, v242
    v_cvt_pk_bf16_f32 v58, v72, v73
    v_cvt_pk_bf16_f32 v59, v74, v75
    v_cvt_pk_bf16_f32 v77, v78, v79
    v_mul_f32 v92, v92, v240
    v_mul_f32 v93, v93, v240
    v_mul_f32 v94, v94, v240
    v_mul_f32 v95, v95, v240
    v_mul_f32 v82, v82, v242
    v_mul_f32 v83, v83, v242
    v_cvt_pk_bf16_f32 v80, v80, v81
    v_mul_f32 v84, v84, v244
    v_mul_f32 v85, v85, v244
    v_cvt_pk_bf16_f32 v78, v92, v93
    v_cvt_pk_bf16_f32 v79, v94, v95
    v_cvt_pk_bf16_f32 v81, v82, v83
    v_mul_f32 v96, v96, v242
    v_mul_f32 v97, v97, v242
    v_mul_f32 v98, v98, v242
    v_mul_f32 v99, v99, v242
    v_mul_f32 v86, v86, v244
    v_mul_f32 v87, v87, v244
    v_cvt_pk_bf16_f32 v84, v84, v85
    v_mul_f32 v88, v88, v246
    v_mul_f32 v89, v89, v246
    v_cvt_pk_bf16_f32 v82, v96, v97
    v_cvt_pk_bf16_f32 v83, v98, v99
    v_cvt_pk_bf16_f32 v85, v86, v87
    v_mul_f32 v100, v100, v244
    v_mul_f32 v101, v101, v244
    v_mul_f32 v102, v102, v244
    v_mul_f32 v103, v103, v244
    v_mul_f32 v90, v90, v246
    v_mul_f32 v91, v91, v246
    v_cvt_pk_bf16_f32 v88, v88, v89
    v_cvt_pk_bf16_f32 v86, v100, v101
    v_cvt_pk_bf16_f32 v87, v102, v103
    v_cvt_pk_bf16_f32 v89, v90, v91
    v_mul_f32 v104, v104, v246
    v_mul_f32 v105, v105, v246
    v_mul_f32 v106, v106, v246
    v_mul_f32 v107, v107, v246
    v_cvt_pk_bf16_f32 v90, v104, v105
    v_cvt_pk_bf16_f32 v91, v106, v107
    v_xor_b32 v3, s22, v6
    v_add_u32 v11, s34, v9
    v_xor_b32 v4, 32, v3
    s_sub_u32 s21, s19, s99
    ds_write_b128 v182, v[144:147] offset:5120
    ds_write_b128 v182, v[148:151] offset:6144
    ds_write_b128 v182, v[152:155] offset:7168
    ds_write_b128 v182, v[44:47] offset:8192
    ds_write_b128 v182, v[48:51] offset:9216
    ds_write_b128 v182, v[52:55] offset:10240
    ds_write_b128 v182, v[56:59] offset:11264
    ds_write_b128 v182, v[76:79] offset:12288
    ds_write_b128 v182, v[80:83] offset:13312
    ds_write_b128 v182, v[84:87] offset:14336
    ds_write_b128 v182, v[88:91] offset:15360
    ds_read_b64_tr_b16 a[176:177], v3 offset:0
    ds_read_b64_tr_b16 a[178:179], v3 offset:2048
    ds_read_b64_tr_b16 a[180:181], v4 offset:0
    ds_read_b64_tr_b16 a[182:183], v4 offset:2048
    s_add_u32 s20, s16, s18
    s_waitcnt lgkmcnt(4)
    s_barrier
    ds_read_b128 v[44:47], v11 offset:0
    ds_read_b128 v[48:51], v11 offset:1024
    ds_read_b128 v[52:55], v11 offset:2048
    ds_read_b128 v[56:59], v11 offset:3072
    s_min_u32 m0, s19, s21
    s_min_u32 s16, s16, s20
    buffer_load_dwordx4 v1, s[4:7], s16 offen lds
    v_mfma_f32_16x16x32_bf16 v[28:31], a[188:191], a[112:115], v[28:31]
    ds_read_b128 v[60:63], v11 offset:4096
    s_add_u32 s22, s22, 8192
    v_mfma_f32_16x16x32_bf16 v[32:35], a[188:191], a[116:119], v[32:35]
    ds_read_b64_tr_b16 a[184:185], v3 offset:4096
    s_sub_u32 s24, s22, s99
    v_mfma_f32_16x16x32_bf16 v[36:39], a[188:191], a[120:123], v[36:39]
    ds_read_b64_tr_b16 a[186:187], v3 offset:6144
    s_min_u32 s22, s22, s24
    v_mfma_f32_16x16x32_bf16 v[40:43], a[188:191], a[124:127], v[40:43]
    ds_read_b128 v[64:67], v11 offset:5120
    ds_read_b128 v[68:71], v11 offset:6144
    buffer_load_dwordx4 v1, s[8:11], s16 offen offset:1024 lds
    ds_read_b128 v[72:75], v11 offset:7168
    ds_read_b64_tr_b16 a[188:189], v4 offset:4096
    s_waitcnt lgkmcnt(10)
    v_mfma_f32_16x16x32_bf16 v[12:15], a[176:179], v[44:47], v[12:15]
    ds_read_b64_tr_b16 a[190:191], v4 offset:6144
    v_xor_b32 v3, s22, v6
    s_waitcnt lgkmcnt(10)
    v_mfma_f32_16x16x32_bf16 v[16:19], a[176:179], v[48:51], v[16:19]
    ds_read_b128 v[76:79], v11 offset:8192
    v_xor_b32 v4, 32, v3
    s_waitcnt lgkmcnt(10)
    v_mfma_f32_16x16x32_bf16 v[20:23], a[176:179], v[52:55], v[20:23]
    ds_read_b128 v[80:83], v11 offset:9216
    s_add_u32 s19, m0, 8192
    s_waitcnt lgkmcnt(10)
    v_mfma_f32_16x16x32_bf16 v[24:27], a[176:179], v[56:59], v[24:27]
    ds_read_b64_tr_b16 a[176:177], v3 offset:0
    s_add_u32 s16, s16, s17
    v_mfma_f32_16x16x32_bf16 v[28:31], a[180:183], v[44:47], v[28:31]
    ds_read_b64_tr_b16 a[178:179], v3 offset:2048
    s_sub_u32 s21, s19, s99
    v_mfma_f32_16x16x32_bf16 v[32:35], a[180:183], v[48:51], v[32:35]
    ds_read_b128 v[84:87], v11 offset:10240
    s_add_u32 s20, s16, s18
    v_mfma_f32_16x16x32_bf16 v[36:39], a[180:183], v[52:55], v[36:39]
    ds_read_b128 v[88:91], v11 offset:11264
    s_min_u32 m0, s19, s21
    v_mfma_f32_16x16x32_bf16 v[40:43], a[180:183], v[56:59], v[40:43]
    ds_read_b64_tr_b16 a[180:181], v4 offset:0
    s_min_u32 s16, s16, s20
    s_waitcnt lgkmcnt(12)
    v_mfma_f32_16x16x32_bf16 v[12:15], a[184:187], v[60:63], v[12:15]
    ds_read_b64_tr_b16 a[182:183], v4 offset:2048
    s_add_u32 s19, m0, 8192
    s_waitcnt lgkmcnt(12)
    v_mfma_f32_16x16x32_bf16 v[16:19], a[184:187], v[64:67], v[16:19]
    buffer_load_dwordx4 v1, s[4:7], s16 offen lds
    s_waitcnt lgkmcnt(11)
    v_mfma_f32_16x16x32_bf16 v[20:23], a[184:187], v[68:71], v[20:23]
    ds_read_b128 v[92:95], v11 offset:12288
    s_sub_u32 s21, s19, s99
    s_waitcnt lgkmcnt(11)
    v_mfma_f32_16x16x32_bf16 v[24:27], a[184:187], v[72:75], v[24:27]
    ds_read_b64_tr_b16 a[184:185], v3 offset:4096
    s_add_u32 s22, s22, 8192
    s_waitcnt lgkmcnt(10)
    v_mfma_f32_16x16x32_bf16 v[28:31], a[188:191], v[60:63], v[28:31]
    ds_read_b64_tr_b16 a[186:187], v3 offset:6144
    s_sub_u32 s24, s22, s99
    v_mfma_f32_16x16x32_bf16 v[32:35], a[188:191], v[64:67], v[32:35]
    ds_read_b128 v[96:99], v11 offset:13312
    s_min_u32 s22, s22, s24
    v_mfma_f32_16x16x32_bf16 v[36:39], a[188:191], v[68:71], v[36:39]
    buffer_load_dwordx4 v1, s[8:11], s16 offen offset:1024 lds
    v_mfma_f32_16x16x32_bf16 v[40:43], a[188:191], v[72:75], v[40:43]
    ds_read_b128 v[100:103], v11 offset:14336
    s_add_u32 s16, s16, s17
    s_waitcnt lgkmcnt(9)
    v_mfma_f32_16x16x32_bf16 v[12:15], a[176:179], v[76:79], v[12:15]
    ds_read_b128 v[104:107], v11 offset:15360
    s_add_u32 s20, s16, s18
    v_mfma_f32_16x16x32_bf16 v[16:19], a[176:179], v[80:83], v[16:19]
    ds_read_b64_tr_b16 a[188:189], v4 offset:4096
    s_min_u32 m0, s19, s21
    s_waitcnt lgkmcnt(10)
    v_mfma_f32_16x16x32_bf16 v[20:23], a[176:179], v[84:87], v[20:23]
    ds_read_b64_tr_b16 a[190:191], v4 offset:6144
    s_min_u32 s16, s16, s20
    s_waitcnt lgkmcnt(10)
    v_mfma_f32_16x16x32_bf16 v[24:27], a[176:179], v[88:91], v[24:27]
    s_waitcnt vmcnt(10)
    s_barrier
    v_xor_b32 v3, s22, v6
    s_waitcnt lgkmcnt(8)
    v_mfma_f32_16x16x32_bf16 v[28:31], a[180:183], v[76:79], v[28:31]
    buffer_load_dwordx4 v1, s[4:7], s16 offen lds
    v_mfma_f32_16x16x32_bf16 v[32:35], a[180:183], v[80:83], v[32:35]
    s_add_u32 s22, s22, 8192
    v_xor_b32 v4, 32, v3
    s_sub_u32 s24, s22, s99
    v_mfma_f32_16x16x32_bf16 v[36:39], a[180:183], v[84:87], v[36:39]
    s_add_u32 s19, m0, 8192
    ds_read_b128 v[108:111], v11 offset:16384
    v_mfma_f32_16x16x32_bf16 v[40:43], a[180:183], v[88:91], v[40:43]
    ds_read_b128 v[112:115], v11 offset:17408
    s_min_u32 s22, s22, s24
    s_waitcnt lgkmcnt(7)
    v_mfma_f32_16x16x32_bf16 v[12:15], a[184:187], v[92:95], v[12:15]
    buffer_load_dwordx4 v1, s[8:11], s16 offen offset:1024 lds
    s_waitcnt lgkmcnt(6)
    v_mfma_f32_16x16x32_bf16 v[16:19], a[184:187], v[96:99], v[16:19]
    s_add_u32 s16, s16, s17
    ds_read_b128 v[116:119], v11 offset:18432
    s_waitcnt lgkmcnt(6)
    v_mfma_f32_16x16x32_bf16 v[20:23], a[184:187], v[100:103], v[20:23]
    ds_read_b128 v[120:123], v11 offset:19456
    s_sub_u32 s21, s19, s99
    s_waitcnt lgkmcnt(6)
    v_mfma_f32_16x16x32_bf16 v[24:27], a[184:187], v[104:107], v[24:27]
    ds_read_b128 v[124:127], v11 offset:20480
    s_add_u32 s20, s16, s18
    s_waitcnt lgkmcnt(5)
    v_mfma_f32_16x16x32_bf16 v[28:31], a[188:191], v[92:95], v[28:31]
    ds_read_b128 v[128:131], v11 offset:21504
    v_add_u32 v187, 1, v187
    v_mfma_f32_16x16x32_bf16 v[32:35], a[188:191], v[96:99], v[32:35]
    ds_read_b128 v[132:135], v11 offset:22528
    s_min_u32 m0, s19, s21
    v_mfma_f32_16x16x32_bf16 v[36:39], a[188:191], v[100:103], v[36:39]
    ds_read_b128 v[136:139], v11 offset:23552
    s_min_u32 s16, s16, s20
    v_mfma_f32_16x16x32_bf16 v[40:43], a[188:191], v[104:107], v[40:43]
    ds_read_b128 v[140:143], v11 offset:24576
    ds_read_b128 v[144:147], v11 offset:25600
    ds_read_b128 v[148:151], v11 offset:26624
    ds_read_b128 v[152:155], v11 offset:27648
    ds_read_b128 v[156:159], v11 offset:28672
    ds_read_b128 v[160:163], v11 offset:29696
    ds_read_b128 v[164:167], v11 offset:30720
    ds_read_b128 v[168:171], v11 offset:31744
    ds_read_b64_tr_b16 a[176:177], v3 offset:0
    ds_read_b64_tr_b16 a[178:179], v3 offset:2048
    ds_read_b64_tr_b16 a[180:181], v4 offset:0
    ds_read_b64_tr_b16 a[182:183], v4 offset:2048
    ds_read_b64_tr_b16 a[184:185], v3 offset:4096
    ds_read_b64_tr_b16 a[186:187], v3 offset:6144
    ds_read_b64_tr_b16 a[188:189], v4 offset:4096
    v_xor_b32 v3, s22, v6
    s_waitcnt lgkmcnt(7)
    s_waitcnt lgkmcnt(3)
    s_mov_b32 s25, 8
    s_branch TA_G2se22
TA_SW25:
    s_mov_b32 s6, 0
    s_mov_b32 s10, 0
    s_branch TA_SW25r
.p2align 3
TA_G2s21:
    v_mfma_f32_16x16x32_bf16 v[32:35], a[180:183], v[112:115], v[32:35]
    buffer_load_dwordx4 v1, s[8:11], s16 offen offset:1024 lds
    v_mfma_f32_16x16x32_bf16 v[36:39], a[180:183], v[116:119], v[36:39]
    s_add_u32 s19, m0, 8192
    s_sub_u32 s21, s19, s99
    s_min_u32 m0, s19, s21
    v_mfma_f32_16x16x32_bf16 v[40:43], a[180:183], v[120:123], v[40:43]
    ds_read_b64_tr_b16 a[180:181], v4 offset:0
    s_waitcnt lgkmcnt(3)
    v_mfma_f32_16x16x32_bf16 v[12:15], a[184:187], v[124:127], v[12:15]
    ds_read_b64_tr_b16 a[182:183], v4 offset:2048
    s_add_u32 s22, s22, 8192
    v_mfma_f32_16x16x32_bf16 v[16:19], a[184:187], v[128:131], v[16:19]
    s_sub_u32 s24, s22, s99
    s_min_u32 s22, s22, s24
    s_add_u32 s16, s16, s17
    v_mfma_f32_16x16x32_bf16 v[20:23], a[184:187], v[132:135], v[20:23]
    s_add_u32 s20, s16, s18
    s_min_u32 s16, s16, s20
    v_mfma_f32_16x16x32_bf16 v[24:27], a[184:187], v[136:139], v[24:27]
    ds_read_b64_tr_b16 a[184:185], v3 offset:4096
    v_mfma_f32_16x16x32_bf16 v[28:31], a[188:191], v[124:127], v[28:31]
    ds_read_b64_tr_b16 a[186:187], v3 offset:6144
    v_xor_b32 v3, s22, v6
    v_mfma_f32_16x16x32_bf16 v[32:35], a[188:191], v[128:131], v[32:35]
    v_mfma_f32_16x16x32_bf16 v[36:39], a[188:191], v[132:135], v[36:39]
    v_mfma_f32_16x16x32_bf16 v[40:43], a[188:191], v[136:139], v[40:43]
    ds_read_b64_tr_b16 a[188:189], v4 offset:4096
    s_waitcnt lgkmcnt(3)
    v_mfma_f32_16x16x32_bf16 v[12:15], a[176:179], v[140:143], v[12:15]
    ds_read_b64_tr_b16 a[190:191], v4 offset:6144
    v_xor_b32 v4, 32, v3
    v_mfma_f32_16x16x32_bf16 v[16:19], a[176:179], v[144:147], v[16:19]
    buffer_load_dwordx4 v1, s[4:7], s16 offen lds
    v_mfma_f32_16x16x32_bf16 v[20:23], a[176:179], v[148:151], v[20:23]
    s_waitcnt vmcnt(11)
    s_barrier
    v_mfma_f32_16x16x32_bf16 v[24:27], a[176:179], v[152:155], v[24:27]
    ds_read_b64_tr_b16 a[176:177], v3 offset:0
    v_mfma_f32_16x16x32_bf16 v[28:31], a[180:183], v[140:143], v[28:31]
    ds_read_b64_tr_b16 a[178:179], v3 offset:2048
    v_mfma_f32_16x16x32_bf16 v[32:35], a[180:183], v[144:147], v[32:35]
    buffer_load_dwordx4 v1, s[8:11], s16 offen offset:1024 lds
    v_mfma_f32_16x16x32_bf16 v[36:39], a[180:183], v[148:151], v[36:39]
    s_add_u32 s19, m0, 8192
    s_sub_u32 s21, s19, s99
    s_min_u32 m0, s19, s21
    v_mfma_f32_16x16x32_bf16 v[40:43], a[180:183], v[152:155], v[40:43]
    ds_read_b64_tr_b16 a[180:181], v4 offset:0
    s_waitcnt lgkmcnt(3)
    v_mfma_f32_16x16x32_bf16 v[12:15], a[184:187], v[156:159], v[12:15]
    ds_read_b64_tr_b16 a[182:183], v4 offset:2048
    s_add_u32 s22, s22, 8192
    v_mfma_f32_16x16x32_bf16 v[16:19], a[184:187], v[160:163], v[16:19]
    s_sub_u32 s24, s22, s99
    s_min_u32 s22, s22, s24
    s_add_u32 s16, s16, s17
    v_mfma_f32_16x16x32_bf16 v[20:23], a[184:187], v[164:167], v[20:23]
    s_add_u32 s20, s16, s18
    s_min_u32 s16, s16, s20
    v_mfma_f32_16x16x32_bf16 v[24:27], a[184:187], v[168:171], v[24:27]
    ds_read_b64_tr_b16 a[184:185], v3 offset:4096
    v_mfma_f32_16x16x32_bf16 v[28:31], a[188:191], v[156:159], v[28:31]
    ds_read_b64_tr_b16 a[186:187], v3 offset:6144
    v_cvt_pk_bf16_f32 v220, v12, v13
    v_xor_b32 v3, s22, v6
    v_mfma_f32_16x16x32_bf16 v[32:35], a[188:191], v[160:163], v[32:35]
    v_cvt_pk_bf16_f32 v221, v14, v15
    v_cvt_pk_bf16_f32 v224, v16, v17
    v_mfma_f32_16x16x32_bf16 v[36:39], a[188:191], v[164:167], v[36:39]
    s_waitcnt lgkmcnt(2)
    v_cvt_pk_bf16_f32 v225, v18, v19
    v_cvt_pk_bf16_f32 v228, v20, v21
    v_mfma_f32_16x16x32_bf16 v[40:43], a[188:191], v[168:171], v[40:43]
    ds_read_b64_tr_b16 a[188:189], v4 offset:4096
    v_cvt_pk_bf16_f32 v229, v22, v23
    v_mfma_f32_16x16x32_bf16 v[12:15], a[176:179], a[0:3], 0
    ds_read_b64_tr_b16 a[190:191], v4 offset:6144
    v_cvt_pk_bf16_f32 v232, v24, v25
    v_mfma_f32_16x16x32_bf16 v[16:19], a[176:179], a[4:7], 0
    s_add_u32 s22, s22, 8192
    v_cvt_pk_bf16_f32 v233, v26, v27
    v_cvt_pk_bf16_f32 v222, v28, v29
    v_mfma_f32_16x16x32_bf16 v[20:23], a[176:179], a[8:11], 0
    s_sub_u32 s24, s22, s99
    v_cvt_pk_bf16_f32 v223, v30, v31
    v_cvt_pk_bf16_f32 v226, v32, v33
    v_mfma_f32_16x16x32_bf16 v[24:27], a[176:179], a[12:15], 0
    ds_read_b64_tr_b16 a[176:177], v3 offset:0
    v_cvt_pk_bf16_f32 v227, v34, v35
    v_mfma_f32_16x16x32_bf16 v[28:31], a[180:183], a[0:3], 0
    ds_read_b64_tr_b16 a[178:179], v3 offset:2048
    v_cvt_pk_bf16_f32 v230, v36, v37
    v_mfma_f32_16x16x32_bf16 v[32:35], a[180:183], a[4:7], 0
    s_min_u32 s22, s22, s24
    v_cvt_pk_bf16_f32 v231, v38, v39
    v_cvt_pk_bf16_f32 v234, v40, v41
    v_mfma_f32_16x16x32_bf16 v[36:39], a[180:183], a[8:11], 0
    v_cvt_pk_bf16_f32 v235, v42, v43
    v_xor_b32 v4, 32, v3
    v_mfma_f32_16x16x32_bf16 v[40:43], a[180:183], a[12:15], 0
    ds_read_b64_tr_b16 a[180:181], v4 offset:0
    s_waitcnt lgkmcnt(3)
    v_mfma_f32_16x16x32_bf16 v[12:15], a[184:187], a[16:19], v[12:15]
    ds_read_b64_tr_b16 a[182:183], v4 offset:2048
    v_mfma_f32_16x16x32_bf16 v[16:19], a[184:187], a[20:23], v[16:19]
    buffer_store_dwordx4 v[220:223], v9, s[12:15], s33 offen offset:0 sc1
    v_mfma_f32_16x16x32_bf16 v[20:23], a[184:187], a[24:27], v[20:23]
    s_cmp_eq_u32 s25, 0
    s_cbranch_scc1 TA_SW25
TA_SW25r:
    v_mfma_f32_16x16x32_bf16 v[24:27], a[184:187], a[28:31], v[24:27]
    ds_read_b64_tr_b16 a[184:185], v3 offset:4096
    v_mfma_f32_16x16x32_bf16 v[28:31], a[188:191], a[16:19], v[28:31]
    ds_read_b64_tr_b16 a[186:187], v3 offset:6144
    v_xor_b32 v3, s22, v6
    v_mfma_f32_16x16x32_bf16 v[32:35], a[188:191], a[20:23], v[32:35]
    buffer_load_dwordx4 v1, s[4:7], s16 offen lds
    v_mfma_f32_16x16x32_bf16 v[36:39], a[188:191], a[24:27], v[36:39]
    v_mfma_f32_16x16x32_bf16 v[40:43], a[188:191], a[28:31], v[40:43]
    ds_read_b64_tr_b16 a[188:189], v4 offset:4096
    s_waitcnt lgkmcnt(3)
    v_mfma_f32_16x16x32_bf16 v[12:15], a[176:179], a[32:35], v[12:15]
    ds_read_b64_tr_b16 a[190:191], v4 offset:6144
    v_xor_b32 v4, 32, v3
    v_mfma_f32_16x16x32_bf16 v[16:19], a[176:179], a[36:39], v[16:19]
    s_add_u32 s22, s22, 8192
    s_sub_u32 s24, s22, s99
    s_min_u32 s22, s22, s24
    v_mfma_f32_16x16x32_bf16 v[20:23], a[176:179], a[40:43], v[20:23]
    s_waitcnt vmcnt(10)
    s_barrier
    buffer_load_dwordx4 v1, s[8:11], s16 offen offset:1024 lds
    v_mfma_f32_16x16x32_bf16 v[24:27], a[176:179], a[44:47], v[24:27]
    ds_read_b64_tr_b16 a[176:177], v3 offset:0
    s_add_u32 s19, m0, 8192
    v_mfma_f32_16x16x32_bf16 v[28:31], a[180:183], a[32:35], v[28:31]
    ds_read_b64_tr_b16 a[178:179], v3 offset:2048
    s_sub_u32 s21, s19, s99
    v_mfma_f32_16x16x32_bf16 v[32:35], a[180:183], a[36:39], v[32:35]
    s_min_u32 m0, s19, s21
    s_add_u32 s16, s16, s17
    s_add_u32 s20, s16, s18
    s_min_u32 s16, s16, s20
    v_mfma_f32_16x16x32_bf16 v[36:39], a[180:183], a[40:43], v[36:39]
    s_mov_b64 exec, s[38:39]
    buffer_store_dword v187, v184, s[12:15], s35 offen sc1
    s_mov_b64 exec, -1
    v_mfma_f32_16x16x32_bf16 v[40:43], a[180:183], a[44:47], v[40:43]
    ds_read_b64_tr_b16 a[180:181], v4 offset:0
    s_waitcnt lgkmcnt(3)
    v_mfma_f32_16x16x32_bf16 v[12:15], a[184:187], a[48:51], v[12:15]
    ds_read_b64_tr_b16 a[182:183], v4 offset:2048
    v_add_u32 v187, 1, v187
    v_mfma_f32_16x16x32_bf16 v[16:19], a[184:187], a[52:55], v[16:19]
    buffer_store_dwordx4 v[224:227], v9, s[12:15], s33 offen offset:1024 sc1
    v_mfma_f32_16x16x32_bf16 v[20:23], a[184:187], a[56:59], v[20:23]
    buffer_load_dwordx4 v1, s[4:7], s16 offen lds
    v_mfma_f32_16x16x32_bf16 v[24:27], a[184:187], a[60:63], v[24:27]
    ds_read_b64_tr_b16 a[184:185], v3 offset:4096
    v_mfma_f32_16x16x32_bf16 v[28:31], a[188:191], a[48:51], v[28:31]
    ds_read_b64_tr_b16 a[186:187], v3 offset:6144
    v_xor_b32 v3, s22, v6
    v_mfma_f32_16x16x32_bf16 v[32:35], a[188:191], a[52:55], v[32:35]
    buffer_load_dwordx4 v1, s[8:11], s16 offen offset:1024 lds
    v_mfma_f32_16x16x32_bf16 v[36:39], a[188:191], a[56:59], v[36:39]
    s_add_u32 s19, m0, 8192
    s_sub_u32 s21, s19, s99
    s_min_u32 m0, s19, s21
    v_mfma_f32_16x16x32_bf16 v[40:43], a[188:191], a[60:63], v[40:43]
    ds_read_b64_tr_b16 a[188:189], v4 offset:4096
    s_waitcnt lgkmcnt(3)
    v_mfma_f32_16x16x32_bf16 v[12:15], a[176:179], a[64:67], v[12:15]
    ds_read_b64_tr_b16 a[190:191], v4 offset:6144
    v_xor_b32 v4, 32, v3
    v_mfma_f32_16x16x32_bf16 v[16:19], a[176:179], a[68:71], v[16:19]
    s_add_u32 s22, s22, 8192
    s_sub_u32 s24, s22, s99
    s_min_u32 s22, s22, s24
    v_mfma_f32_16x16x32_bf16 v[20:23], a[176:179], a[72:75], v[20:23]
    s_add_u32 s16, s16, s17
    s_add_u32 s20, s16, s18
    s_min_u32 s16, s16, s20
    v_mfma_f32_16x16x32_bf16 v[24:27], a[176:179], a[76:79], v[24:27]
    ds_read_b64_tr_b16 a[176:177], v3 offset:0
    v_mfma_f32_16x16x32_bf16 v[28:31], a[180:183], a[64:67], v[28:31]
    ds_read_b64_tr_b16 a[178:179], v3 offset:2048
    v_mfma_f32_16x16x32_bf16 v[32:35], a[180:183], a[68:71], v[32:35]
    v_mfma_f32_16x16x32_bf16 v[36:39], a[180:183], a[72:75], v[36:39]
    buffer_load_dwordx4 v1, s[4:7], s16 offen lds
    v_mfma_f32_16x16x32_bf16 v[40:43], a[180:183], a[76:79], v[40:43]
    ds_read_b64_tr_b16 a[180:181], v4 offset:0
    s_waitcnt lgkmcnt(3)
    v_mfma_f32_16x16x32_bf16 v[12:15], a[184:187], a[80:83], v[12:15]
    ds_read_b64_tr_b16 a[182:183], v4 offset:2048
    v_mfma_f32_16x16x32_bf16 v[16:19], a[184:187], a[84:87], v[16:19]
    buffer_store_dwordx4 v[228:231], v9, s[12:15], s33 offen offset:2048 sc1
    v_mfma_f32_16x16x32_bf16 v[20:23], a[184:187], a[88:91], v[20:23]
    buffer_load_dwordx4 v1, s[8:11], s16 offen offset:1024 lds
    v_mfma_f32_16x16x32_bf16 v[24:27], a[184:187], a[92:95], v[24:27]
    ds_read_b64_tr_b16 a[184:185], v3 offset:4096
    s_add_u32 s19, m0, 8192
    v_mfma_f32_16x16x32_bf16 v[28:31], a[188:191], a[80:83], v[28:31]
    ds_read_b64_tr_b16 a[186:187], v3 offset:6144
    v_xor_b32 v3, s22, v6
    v_mfma_f32_16x16x32_bf16 v[32:35], a[188:191], a[84:87], v[32:35]
    s_sub_u32 s21, s19, s99
    s_min_u32 m0, s19, s21
    s_add_u32 s16, s16, s17
    v_mfma_f32_16x16x32_bf16 v[36:39], a[188:191], a[88:91], v[36:39]
    s_add_u32 s20, s16, s18
    s_min_u32 s16, s16, s20
    v_mfma_f32_16x16x32_bf16 v[40:43], a[188:191], a[92:95], v[40:43]
    ds_read_b64_tr_b16 a[188:189], v4 offset:4096
    s_waitcnt lgkmcnt(3)
    v_mfma_f32_16x16x32_bf16 v[12:15], a[176:179], a[96:99], v[12:15]
    ds_read_b64_tr_b16 a[190:191], v4 offset:6144
    v_xor_b32 v4, 32, v3
    v_mfma_f32_16x16x32_bf16 v[16:19], a[176:179], a[100:103], v[16:19]
    s_add_u32 s22, s22, 8192
    s_sub_u32 s24, s22, s99
    s_min_u32 s22, s22, s24
    v_mfma_f32_16x16x32_bf16 v[20:23], a[176:179], a[104:107], v[20:23]
    s_waitcnt vmcnt(13)
    s_barrier
    v_mfma_f32_16x16x32_bf16 v[24:27], a[176:179], a[108:111], v[24:27]
    ds_read_b64_tr_b16 a[176:177], v3 offset:0
    v_mfma_f32_16x16x32_bf16 v[28:31], a[180:183], a[96:99], v[28:31]
    ds_read_b64_tr_b16 a[178:179], v3 offset:2048
    v_mfma_f32_16x16x32_bf16 v[32:35], a[180:183], a[100:103], v[32:35]
    buffer_load_dwordx4 v1, s[4:7], s16 offen lds
    v_mfma_f32_16x16x32_bf16 v[36:39], a[180:183], a[104:107], v[36:39]
    v_mfma_f32_16x16x32_bf16 v[40:43], a[180:183], a[108:111], v[40:43]
    ds_read_b64_tr_b16 a[180:181], v4 offset:0
    s_waitcnt lgkmcnt(3)
    v_mfma_f32_16x16x32_bf16 v[12:15], a[184:187], a[112:115], v[12:15]
    ds_read_b64_tr_b16 a[182:183], v4 offset:2048
    v_mfma_f32_16x16x32_bf16 v[16:19], a[184:187], a[116:119], v[16:19]
    buffer_store_dwordx4 v[232:235], v9, s[12:15], s33 offen offset:3072 sc1
    v_mfma_f32_16x16x32_bf16 v[20:23], a[184:187], a[120:123], v[20:23]
    buffer_load_dwordx4 v1, s[8:11], s16 offen offset:1024 lds
    v_mfma_f32_16x16x32_bf16 v[24:27], a[184:187], a[124:127], v[24:27]
    ds_read_b64_tr_b16 a[184:185], v3 offset:4096
    s_add_u32 s19, m0, 8192
    v_mfma_f32_16x16x32_bf16 v[28:31], a[188:191], a[112:115], v[28:31]
    ds_read_b64_tr_b16 a[186:187], v3 offset:6144
    v_xor_b32 v3, s22, v6
    v_mfma_f32_16x16x32_bf16 v[32:35], a[188:191], a[116:119], v[32:35]
    s_sub_u32 s21, s19, s99
    s_min_u32 m0, s19, s21
    s_add_u32 s16, s16, s17
    v_mfma_f32_16x16x32_bf16 v[36:39], a[188:191], a[120:123], v[36:39]
    s_add_u32 s20, s16, s18
    s_min_u32 s16, s16, s20
    s_mov_b32 s33, s32
    v_mfma_f32_16x16x32_bf16 v[40:43], a[188:191], a[124:127], v[40:43]
    ds_read_b64_tr_b16 a[188:189], v4 offset:4096
    s_waitcnt lgkmcnt(3)
    v_mfma_f32_16x16x32_bf16 v[12:15], a[176:179], v[44:47], v[12:15]
    ds_read_b64_tr_b16 a[190:191], v4 offset:6144
    v_xor_b32 v4, 32, v3
    v_mfma_f32_16x16x32_bf16 v[16:19], a[176:179], v[48:51], v[16:19]
    s_add_u32 s22, s22, 8192
    s_sub_u32 s24, s22, s99
    s_min_u32 s22, s22, s24
    v_mfma_f32_16x16x32_bf16 v[20:23], a[176:179], v[52:55], v[20:23]
    s_add_u32 s32, s32, 16384
    v_mfma_f32_16x16x32_bf16 v[24:27], a[176:179], v[56:59], v[24:27]
    ds_read_b64_tr_b16 a[176:177], v3 offset:0
    v_mfma_f32_16x16x32_bf16 v[28:31], a[180:183], v[44:47], v[28:31]
    ds_read_b64_tr_b16 a[178:179], v3 offset:2048
    v_mfma_f32_16x16x32_bf16 v[32:35], a[180:183], v[48:51], v[32:35]
    buffer_load_dwordx4 v1, s[4:7], s16 offen lds
    v_mfma_f32_16x16x32_bf16 v[36:39], a[180:183], v[52:55], v[36:39]
    v_mfma_f32_16x16x32_bf16 v[40:43], a[180:183], v[56:59], v[40:43]
    ds_read_b64_tr_b16 a[180:181], v4 offset:0
    s_waitcnt lgkmcnt(3)
    v_mfma_f32_16x16x32_bf16 v[12:15], a[184:187], v[60:63], v[12:15]
    ds_read_b64_tr_b16 a[182:183], v4 offset:2048
    v_mfma_f32_16x16x32_bf16 v[16:19], a[184:187], v[64:67], v[16:19]
    buffer_load_dwordx4 v1, s[8:11], s16 offen offset:1024 lds
    v_mfma_f32_16x16x32_bf16 v[20:23], a[184:187], v[68:71], v[20:23]
    s_add_u32 s19, m0, 8192
    s_sub_u32 s21, s19, s99
    s_min_u32 m0, s19, s21
    v_mfma_f32_16x16x32_bf16 v[24:27], a[184:187], v[72:75], v[24:27]
    ds_read_b64_tr_b16 a[184:185], v3 offset:4096
    s_add_u32 s16, s16, s17
    v_mfma_f32_16x16x32_bf16 v[28:31], a[188:191], v[60:63], v[28:31]
    ds_read_b64_tr_b16 a[186:187], v3 offset:6144
    v_xor_b32 v3, s22, v6
    v_mfma_f32_16x16x32_bf16 v[32:35], a[188:191], v[64:67], v[32:35]
    s_add_u32 s20, s16, s18
    s_min_u32 s16, s16, s20
    v_mfma_f32_16x16x32_bf16 v[36:39], a[188:191], v[68:71], v[36:39]
    v_mfma_f32_16x16x32_bf16 v[40:43], a[188:191], v[72:75], v[40:43]
    ds_read_b64_tr_b16 a[188:189], v4 offset:4096
    s_waitcnt lgkmcnt(3)
    v_mfma_f32_16x16x32_bf16 v[12:15], a[176:179], v[76:79], v[12:15]
    ds_read_b64_tr_b16 a[190:191], v4 offset:6144
    v_xor_b32 v4, 32, v3
    v_mfma_f32_16x16x32_bf16 v[16:19], a[176:179], v[80:83], v[16:19]
    s_add_u32 s22, s22, 8192
    s_sub_u32 s24, s22, s99
    s_min_u32 s22, s22, s24
    v_mfma_f32_16x16x32_bf16 v[20:23], a[176:179], v[84:87], v[20:23]
    s_waitcnt vmcnt(14)
    s_barrier
    v_mfma_f32_16x16x32_bf16 v[24:27], a[176:179], v[88:91], v[24:27]
    ds_read_b64_tr_b16 a[176:177], v3 offset:0
    v_mfma_f32_16x16x32_bf16 v[28:31], a[180:183], v[76:79], v[28:31]
    ds_read_b64_tr_b16 a[178:179], v3 offset:2048
    v_mfma_f32_16x16x32_bf16 v[32:35], a[180:183], v[80:83], v[32:35]
    buffer_load_dwordx4 v1, s[4:7], s16 offen lds
    v_mfma_f32_16x16x32_bf16 v[36:39], a[180:183], v[84:87], v[36:39]
    v_mfma_f32_16x16x32_bf16 v[40:43], a[180:183], v[88:91], v[40:43]
    ds_read_b64_tr_b16 a[180:181], v4 offset:0
    s_waitcnt lgkmcnt(3)
    v_mfma_f32_16x16x32_bf16 v[12:15], a[184:187], v[92:95], v[12:15]
    ds_read_b64_tr_b16 a[182:183], v4 offset:2048
    v_mfma_f32_16x16x32_bf16 v[16:19], a[184:187], v[96:99], v[16:19]
    buffer_load_dwordx4 v1, s[8:11], s16 offen offset:1024 lds
    v_mfma_f32_16x16x32_bf16 v[20:23], a[184:187], v[100:103], v[20:23]
    s_add_u32 s19, m0, 8192
    s_sub_u32 s21, s19, s99
    s_min_u32 m0, s19, s21
    v_mfma_f32_16x16x32_bf16 v[24:27], a[184:187], v[104:107], v[24:27]
    ds_read_b64_tr_b16 a[184:185], v3 offset:4096
    s_add_u32 s16, s16, s17
    v_mfma_f32_16x16x32_bf16 v[28:31], a[188:191], v[92:95], v[28:31]
    ds_read_b64_tr_b16 a[186:187], v3 offset:6144
    v_xor_b32 v3, s22, v6
    v_mfma_f32_16x16x32_bf16 v[32:35], a[188:191], v[96:99], v[32:35]
    s_add_u32 s20, s16, s18
    s_min_u32 s16, s16, s20
    v_mfma_f32_16x16x32_bf16 v[36:39], a[188:191], v[100:103], v[36:39]
    v_mfma_f32_16x16x32_bf16 v[40:43], a[188:191], v[104:107], v[40:43]
    ds_read_b64_tr_b16 a[188:189], v4 offset:4096
    s_waitcnt lgkmcnt(3)
TA_G2se22:
    v_mfma_f32_16x16x32_bf16 v[12:15], a[176:179], v[108:111], v[12:15]
    ds_read_b64_tr_b16 a[190:191], v4 offset:6144
    v_xor_b32 v4, 32, v3
    v_mfma_f32_16x16x32_bf16 v[16:19], a[176:179], v[112:115], v[16:19]
    v_mfma_f32_16x16x32_bf16 v[20:23], a[176:179], v[116:119], v[20:23]
    buffer_load_dwordx4 v1, s[4:7], s16 offen lds
    v_mfma_f32_16x16x32_bf16 v[24:27], a[176:179], v[120:123], v[24:27]
    ds_read_b64_tr_b16 a[176:177], v3 offset:0
    v_mfma_f32_16x16x32_bf16 v[28:31], a[180:183], v[108:111], v[28:31]
    ds_read_b64_tr_b16 a[178:179], v3 offset:2048
    s_sub_u32 s25, s25, 1
    s_cbranch_scc0 TA_G2s21
    v_mfma_f32_16x16x32_bf16 v[32:35], a[180:183], v[112:115], v[32:35]
    buffer_load_dwordx4 v1, s[8:11], s16 offen offset:1024 lds
    v_mfma_f32_16x16x32_bf16 v[36:39], a[180:183], v[116:119], v[36:39]
    s_add_u32 s19, m0, 8192
    s_add_u32 s16, s16, s17
    s_sub_u32 s21, s19, s99
    v_mfma_f32_16x16x32_bf16 v[40:43], a[180:183], v[120:123], v[40:43]
    ds_read_b64_tr_b16 a[180:181], v4 offset:0
    s_add_u32 s20, s16, s18
    s_waitcnt lgkmcnt(5)
    v_mfma_f32_16x16x32_bf16 v[12:15], a[184:187], v[124:127], v[12:15]
    ds_read_b64_tr_b16 a[182:183], v4 offset:2048
    s_min_u32 m0, s19, s21
    v_mfma_f32_16x16x32_bf16 v[16:19], a[184:187], v[128:131], v[16:19]
    s_min_u32 s16, s16, s20
    s_add_u32 s19, m0, 8192
    s_sub_u32 s21, s19, s99
    v_mfma_f32_16x16x32_bf16 v[20:23], a[184:187], v[132:135], v[20:23]
    v_mfma_f32_16x16x32_bf16 v[24:27], a[184:187], v[136:139], v[24:27]
    ds_read_b64_tr_b16 a[184:185], v3 offset:4096
    s_waitcnt lgkmcnt(5)
    v_mfma_f32_16x16x32_bf16 v[28:31], a[188:191], v[124:127], v[28:31]
    ds_read_b64_tr_b16 a[186:187], v3 offset:6144
    v_mfma_f32_16x16x32_bf16 v[32:35], a[188:191], v[128:131], v[32:35]
    v_mfma_f32_16x16x32_bf16 v[36:39], a[188:191], v[132:135], v[36:39]
    v_mfma_f32_16x16x32_bf16 v[40:43], a[188:191], v[136:139], v[40:43]
    ds_read_b64_tr_b16 a[188:189], v4 offset:4096
    s_waitcnt lgkmcnt(5)
    v_mfma_f32_16x16x32_bf16 v[12:15], a[176:179], v[140:143], v[12:15]
    ds_read_b64_tr_b16 a[190:191], v4 offset:6144
    v_mfma_f32_16x16x32_bf16 v[16:19], a[176:179], v[144:147], v[16:19]
    buffer_load_dwordx4 v1, s[4:7], s16 offen lds
    v_mfma_f32_16x16x32_bf16 v[20:23], a[176:179], v[148:151], v[20:23]
    v_mfma_f32_16x16x32_bf16 v[24:27], a[176:179], v[152:155], v[24:27]
    s_waitcnt lgkmcnt(4)
    v_mfma_f32_16x16x32_bf16 v[28:31], a[180:183], v[140:143], v[28:31]
    buffer_load_dwordx4 v1, s[8:11], s16 offen offset:1024 lds
    v_mfma_f32_16x16x32_bf16 v[32:35], a[180:183], v[144:147], v[32:35]
    s_add_u32 s16, s16, s17
    s_add_u32 s20, s16, s18
    s_min_u32 m0, s19, s21
    v_mfma_f32_16x16x32_bf16 v[36:39], a[180:183], v[148:151], v[36:39]
    s_min_u32 s16, s16, s20
    v_mfma_f32_16x16x32_bf16 v[40:43], a[180:183], v[152:155], v[40:43]
    s_waitcnt lgkmcnt(2)
    v_mfma_f32_16x16x32_bf16 v[12:15], a[184:187], v[156:159], v[12:15]
    v_mfma_f32_16x16x32_bf16 v[16:19], a[184:187], v[160:163], v[16:19]
    v_mfma_f32_16x16x32_bf16 v[20:23], a[184:187], v[164:167], v[20:23]
    s_nop 5
    v_cvt_pk_bf16_f32 v220, v12, v13
    v_mfma_f32_16x16x32_bf16 v[24:27], a[184:187], v[168:171], v[24:27]
    v_cvt_pk_bf16_f32 v221, v14, v15
    v_cvt_pk_bf16_f32 v224, v16, v17
    s_waitcnt lgkmcnt(0)
    v_mfma_f32_16x16x32_bf16 v[28:31], a[188:191], v[156:159], v[28:31]
    v_cvt_pk_bf16_f32 v225, v18, v19
    v_cvt_pk_bf16_f32 v228, v20, v21
    v_mfma_f32_16x16x32_bf16 v[32:35], a[188:191], v[160:163], v[32:35]
    v_cvt_pk_bf16_f32 v229, v22, v23
    v_cvt_pk_bf16_f32 v232, v24, v25
    v_mfma_f32_16x16x32_bf16 v[36:39], a[188:191], v[164:167], v[36:39]
    s_nop 1
    v_cvt_pk_bf16_f32 v222, v28, v29
    v_mfma_f32_16x16x32_bf16 v[40:43], a[188:191], v[168:171], v[40:43]
    v_cvt_pk_bf16_f32 v223, v30, v31
    v_cvt_pk_bf16_f32 v226, v32, v33
    v_cvt_pk_bf16_f32 v227, v34, v35
    v_cvt_pk_bf16_f32 v233, v26, v27
    buffer_store_dwordx4 v[220:223], v9, s[12:15], s33 offen offset:0 sc1
    v_cvt_pk_bf16_f32 v230, v36, v37
    v_cvt_pk_bf16_f32 v231, v38, v39
    s_nop 0
    v_cvt_pk_bf16_f32 v234, v40, v41
    v_cvt_pk_bf16_f32 v235, v42, v43
    buffer_store_dwordx4 v[224:227], v9, s[12:15], s33 offen offset:1024 sc1
    buffer_store_dwordx4 v[228:231], v9, s[12:15], s33 offen offset:2048 sc1
    buffer_store_dwordx4 v[232:235], v9, s[12:15], s33 offen offset:3072 sc1
    v_mov_b32 v187, 9
    s_waitcnt vmcnt(0)
    s_barrier
    s_mov_b64 exec, s[38:39]
    buffer_store_dword v187, v184, s[12:15], s35 offen sc1
    s_mov_b64 exec, -1
    s_endpgm
TA_RP3:
    s_mov_b32 s25, 0x40000
TA_RP3l:
    buffer_load_dword v185, off, s[64:67], s95 sc1
    s_waitcnt vmcnt(0)
    v_readfirstlane_b32 s34, v185
    s_nop 3
    s_cmp_lg_u32 s34, 0
    s_cbranch_scc1 TA_RB4
    s_sleep 2
    s_sub_u32 s25, s25, 1
    s_cbranch_scc0 TA_RP3l
    s_branch TA_RB4
TA_QP5:
    s_mov_b32 s25, 0x40000
TA_QP5l:
    buffer_load_dword v186, off, s[12:15], s81 offset:256 sc1
    s_waitcnt vmcnt(0)
    v_readfirstlane_b32 s34, v186
    s_nop 3
    s_cmp_lg_u32 s34, 0
    s_cbranch_scc1 TA_QB6
    s_sleep 2
    s_sub_u32 s25, s25, 1
    s_cbranch_scc0 TA_QP5l
    s_branch TA_QB6
TA_At1slow9:
    s_waitcnt vmcnt(0) lgkmcnt(0)
    s_nop 7
    s_mov_b32 s69, m0
    s_mov_b32 s66, 8388608
    s_mov_b32 s67, 0x00020000
    v_lshrrev_b32 v249, 2, v0
    v_lshlrev_b32 v249, 8, v249
    v_lshrrev_b32 v248, 4, v0
    v_sub_u32 v248, 0, v248
    v_xor_b32 v248, v248, v0
    v_and_b32 v248, 3, v248
    v_lshl_add_u32 v248, v248, 4, v249
    v_add_u32 v249, s70, v8
    v_add_u32 v250, s70, v6
    v_xor_b32 v251, 32, v250
    s_lshr_b32 s68, s54, 1
    s_lshl_b32 s68, s68, 19
    s_add_u32 s68, s68, 393216
    s_mov_b32 s25, 16
    v_mov_b32 v240, 0xff800000
    v_mov_b32 v241, 0xff800000
    v_mov_b32 v242, 0xff800000
    v_mov_b32 v243, 0xff800000
.p2align 3
TA_sl11:
    s_mov_b64 s[64:65], s[40:41]
    s_add_u32 m0, s70, 0
    s_add_u32 s34, s68, 0
    buffer_load_dwordx4 v248, s[64:67], s34 offen lds
    s_add_u32 m0, s70, 1024
    s_add_u32 s34, s68, 64
    buffer_load_dwordx4 v248, s[64:67], s34 offen lds
    s_add_u32 m0, s70, 2048
    s_add_u32 s34, s68, 128
    buffer_load_dwordx4 v248, s[64:67], s34 offen lds
    s_add_u32 m0, s70, 3072
    s_add_u32 s34, s68, 192
    buffer_load_dwordx4 v248, s[64:67], s34 offen lds
    s_add_u32 m0, s70, 4096
    s_add_u32 s34, s68, 4096
    buffer_load_dwordx4 v248, s[64:67], s34 offen lds
    s_add_u32 m0, s70, 5120
    s_add_u32 s34, s68, 4160
    buffer_load_dwordx4 v248, s[64:67], s34 offen lds
    s_add_u32 m0, s70, 6144
    s_add_u32 s34, s68, 4224
    buffer_load_dwordx4 v248, s[64:67], s34 offen lds
    s_add_u32 m0, s70, 7168
    s_add_u32 s34, s68, 4288
    buffer_load_dwordx4 v248, s[64:67], s34 offen lds
    s_waitcnt vmcnt(0)
    ds_read_b128 a[176:179], v249 offset:0
    ds_read_b128 a[180:183], v249 offset:1024
    ds_read_b128 a[184:187], v249 offset:2048
    ds_read_b128 a[188:191], v249 offset:3072
    s_waitcnt lgkmcnt(3)
    v_mfma_f32_16x16x32_bf16 v[12:15], a[176:179], v[44:47], 0
    v_mfma_f32_16x16x32_bf16 v[16:19], a[176:179], v[48:51], 0
    v_mfma_f32_16x16x32_bf16 v[20:23], a[176:179], v[52:55], 0
    v_mfma_f32_16x16x32_bf16 v[24:27], a[176:179], v[56:59], 0
    s_waitcnt lgkmcnt(2)
    v_mfma_f32_16x16x32_bf16 v[12:15], a[180:183], v[60:63], v[12:15]
    v_mfma_f32_16x16x32_bf16 v[16:19], a[180:183], v[64:67], v[16:19]
    v_mfma_f32_16x16x32_bf16 v[20:23], a[180:183], v[68:71], v[20:23]
    v_mfma_f32_16x16x32_bf16 v[24:27], a[180:183], v[72:75], v[24:27]
    s_waitcnt lgkmcnt(1)
    v_mfma_f32_16x16x32_bf16 v[12:15], a[184:187], v[76:79], v[12:15]
    v_mfma_f32_16x16x32_bf16 v[16:19], a[184:187], v[80:83], v[16:19]
    v_mfma_f32_16x16x32_bf16 v[20:23], a[184:187], v[84:87], v[20:23]
    v_mfma_f32_16x16x32_bf16 v[24:27], a[184:187], v[88:91], v[24:27]
    s_waitcnt lgkmcnt(0)
    v_mfma_f32_16x16x32_bf16 v[12:15], a[188:191], v[92:95], v[12:15]
    v_mfma_f32_16x16x32_bf16 v[16:19], a[188:191], v[96:99], v[16:19]
    v_mfma_f32_16x16x32_bf16 v[20:23], a[188:191], v[100:103], v[20:23]
    v_mfma_f32_16x16x32_bf16 v[24:27], a[188:191], v[104:107], v[24:27]
    ds_read_b128 a[176:179], v249 offset:4096
    ds_read_b128 a[180:183], v249 offset:5120
    ds_read_b128 a[184:187], v249 offset:6144
    ds_read_b128 a[188:191], v249 offset:7168
    s_waitcnt lgkmcnt(3)
    v_mfma_f32_16x16x32_bf16 v[28:31], a[176:179], v[44:47], 0
    v_mfma_f32_16x16x32_bf16 v[32:35], a[176:179], v[48:51], 0
    v_mfma_f32_16x16x32_bf16 v[36:39], a[176:179], v[52:55], 0
    v_mfma_f32_16x16x32_bf16 v[40:43], a[176:179], v[56:59], 0
    s_waitcnt lgkmcnt(2)
    v_mfma_f32_16x16x32_bf16 v[28:31], a[180:183], v[60:63], v[28:31]
    v_mfma_f32_16x16x32_bf16 v[32:35], a[180:183], v[64:67], v[32:35]
    v_mfma_f32_16x16x32_bf16 v[36:39], a[180:183], v[68:71], v[36:39]
    v_mfma_f32_16x16x32_bf16 v[40:43], a[180:183], v[72:75], v[40:43]
    s_waitcnt lgkmcnt(1)
    v_mfma_f32_16x16x32_bf16 v[28:31], a[184:187], v[76:79], v[28:31]
    v_mfma_f32_16x16x32_bf16 v[32:35], a[184:187], v[80:83], v[32:35]
    v_mfma_f32_16x16x32_bf16 v[36:39], a[184:187], v[84:87], v[36:39]
    v_mfma_f32_16x16x32_bf16 v[40:43], a[184:187], v[88:91], v[40:43]
    s_waitcnt lgkmcnt(0)
    v_mfma_f32_16x16x32_bf16 v[28:31], a[188:191], v[92:95], v[28:31]
    v_mfma_f32_16x16x32_bf16 v[32:35], a[188:191], v[96:99], v[32:35]
    v_mfma_f32_16x16x32_bf16 v[36:39], a[188:191], v[100:103], v[36:39]
    v_mfma_f32_16x16x32_bf16 v[40:43], a[188:191], v[104:107], v[40:43]
    v_max3_f32 v240, v240, v12, v13
    v_max3_f32 v240, v240, v14, v15
    v_max3_f32 v241, v241, v16, v17
    v_max3_f32 v241, v241, v18, v19
    v_max3_f32 v242, v242, v20, v21
    v_max3_f32 v242, v242, v22, v23
    v_max3_f32 v243, v243, v24, v25
    v_max3_f32 v243, v243, v26, v27
    v_max3_f32 v240, v240, v28, v29
    v_max3_f32 v240, v240, v30, v31
    v_max3_f32 v241, v241, v32, v33
    v_max3_f32 v241, v241, v34, v35
    v_max3_f32 v242, v242, v36, v37
    v_max3_f32 v242, v242, v38, v39
    v_max3_f32 v243, v243, v40, v41
    v_max3_f32 v243, v243, v42, v43
    s_add_u32 s68, s68, 8192
    s_sub_u32 s25, s25, 1
    s_cmp_lg_u32 s25, 0
    s_cbranch_scc1 TA_sl11
    v_mov_b32 v244, v240
    s_nop 1
    v_permlane32_swap_b32 v244, v240
    v_max_f32 v240, v240, v244
    v_mov_b32 v244, v240
    s_nop 1
    v_permlane16_swap_b32 v244, v240
    v_max_f32 v240, v240, v244
    v_sub_f32 v220, 0, v240
    v_sub_f32 v221, 0, v240
    v_sub_f32 v222, 0, v240
    v_sub_f32 v223, 0, v240
    v_mov_b32 v244, v241
    s_nop 1
    v_permlane32_swap_b32 v244, v241
    v_max_f32 v241, v241, v244
    v_mov_b32 v244, v241
    s_nop 1
    v_permlane16_swap_b32 v244, v241
    v_max_f32 v241, v241, v244
    v_sub_f32 v224, 0, v241
    v_sub_f32 v225, 0, v241
    v_sub_f32 v226, 0, v241
    v_sub_f32 v227, 0, v241
    v_mov_b32 v244, v242
    s_nop 1
    v_permlane32_swap_b32 v244, v242
    v_max_f32 v242, v242, v244
    v_mov_b32 v244, v242
    s_nop 1
    v_permlane16_swap_b32 v244, v242
    v_max_f32 v242, v242, v244
    v_sub_f32 v228, 0, v242
    v_sub_f32 v229, 0, v242
    v_sub_f32 v230, 0, v242
    v_sub_f32 v231, 0, v242
    v_mov_b32 v244, v243
    s_nop 1
    v_permlane32_swap_b32 v244, v243
    v_max_f32 v243, v243, v244
    v_mov_b32 v244, v243
    s_nop 1
    v_permlane16_swap_b32 v244, v243
    v_max_f32 v243, v243, v244
    v_sub_f32 v232, 0, v243
    v_sub_f32 v233, 0, v243
    v_sub_f32 v234, 0, v243
    v_sub_f32 v235, 0, v243
    v_mov_b32 v108, 0
    v_mov_b32 v109, 0
    v_mov_b32 v110, 0
    v_mov_b32 v111, 0
    v_mov_b32 v112, 0
    v_mov_b32 v113, 0
    v_mov_b32 v114, 0
    v_mov_b32 v115, 0
    v_mov_b32 v116, 0
    v_mov_b32 v117, 0
    v_mov_b32 v118, 0
    v_mov_b32 v119, 0
    v_mov_b32 v120, 0
    v_mov_b32 v121, 0
    v_mov_b32 v122, 0
    v_mov_b32 v123, 0
    v_mov_b32 v124, 0
    v_mov_b32 v125, 0
    v_mov_b32 v126, 0
    v_mov_b32 v127, 0
    v_mov_b32 v128, 0
    v_mov_b32 v129, 0
    v_mov_b32 v130, 0
    v_mov_b32 v131, 0
    v_mov_b32 v132, 0
    v_mov_b32 v133, 0
    v_mov_b32 v134, 0
    v_mov_b32 v135, 0
    v_mov_b32 v136, 0
    v_mov_b32 v137, 0
    v_mov_b32 v138, 0
    v_mov_b32 v139, 0
    v_mov_b32 v140, 0
    v_mov_b32 v141, 0
    v_mov_b32 v142, 0
    v_mov_b32 v143, 0
    v_mov_b32 v144, 0
    v_mov_b32 v145, 0
    v_mov_b32 v146, 0
    v_mov_b32 v147, 0
    v_mov_b32 v148, 0
    v_mov_b32 v149, 0
    v_mov_b32 v150, 0
    v_mov_b32 v151, 0
    v_mov_b32 v152, 0
    v_mov_b32 v153, 0
    v_mov_b32 v154, 0
    v_mov_b32 v155, 0
    v_mov_b32 v156, 0
    v_mov_b32 v157, 0
    v_mov_b32 v158, 0
    v_mov_b32 v159, 0
    v_mov_b32 v160, 0
    v_mov_b32 v161, 0
    v_mov_b32 v162, 0
    v_mov_b32 v163, 0
    v_mov_b32 v164, 0
    v_mov_b32 v165, 0
    v_mov_b32 v166, 0
    v_mov_b32 v167, 0
    v_mov_b32 v168, 0
    v_mov_b32 v169, 0
    v_mov_b32 v170, 0
    v_mov_b32 v171, 0
    v_accvgpr_write_b32 a0, 0
    v_accvgpr_write_b32 a1, 0
    v_accvgpr_write_b32 a2, 0
    v_accvgpr_write_b32 a3, 0
    v_accvgpr_write_b32 a4, 0
    v_accvgpr_write_b32 a5, 0
    v_accvgpr_write_b32 a6, 0
    v_accvgpr_write_b32 a7, 0
    v_accvgpr_write_b32 a8, 0
    v_accvgpr_write_b32 a9, 0
    v_accvgpr_write_b32 a10, 0
    v_accvgpr_write_b32 a11, 0
    v_accvgpr_write_b32 a12, 0
    v_accvgpr_write_b32 a13, 0
    v_accvgpr_write_b32 a14, 0
    v_accvgpr_write_b32 a15, 0
    v_accvgpr_write_b32 a16, 0
    v_accvgpr_write_b32 a17, 0
    v_accvgpr_write_b32 a18, 0
    v_accvgpr_write_b32 a19, 0
    v_accvgpr_write_b32 a20, 0
    v_accvgpr_write_b32 a21, 0
    v_accvgpr_write_b32 a22, 0
    v_accvgpr_write_b32 a23, 0
    v_accvgpr_write_b32 a24, 0
    v_accvgpr_write_b32 a25, 0
    v_accvgpr_write_b32 a26, 0
    v_accvgpr_write_b32 a27, 0
    v_accvgpr_write_b32 a28, 0
    v_accvgpr_write_b32 a29, 0
    v_accvgpr_write_b32 a30, 0
    v_accvgpr_write_b32 a31, 0
    v_accvgpr_write_b32 a32, 0
    v_accvgpr_write_b32 a33, 0
    v_accvgpr_write_b32 a34, 0
    v_accvgpr_write_b32 a35, 0
    v_accvgpr_write_b32 a36, 0
    v_accvgpr_write_b32 a37, 0
    v_accvgpr_write_b32 a38, 0
    v_accvgpr_write_b32 a39, 0
    v_accvgpr_write_b32 a40, 0
    v_accvgpr_write_b32 a41, 0
    v_accvgpr_write_b32 a42, 0
    v_accvgpr_write_b32 a43, 0
    v_accvgpr_write_b32 a44, 0
    v_accvgpr_write_b32 a45, 0
    v_accvgpr_write_b32 a46, 0
    v_accvgpr_write_b32 a47, 0
    v_accvgpr_write_b32 a48, 0
    v_accvgpr_write_b32 a49, 0
    v_accvgpr_write_b32 a50, 0
    v_accvgpr_write_b32 a51, 0
    v_accvgpr_write_b32 a52, 0
    v_accvgpr_write_b32 a53, 0
    v_accvgpr_write_b32 a54, 0
    v_accvgpr_write_b32 a55, 0
    v_accvgpr_write_b32 a56, 0
    v_accvgpr_write_b32 a57, 0
    v_accvgpr_write_b32 a58, 0
    v_accvgpr_write_b32 a59, 0
    v_accvgpr_write_b32 a60, 0
    v_accvgpr_write_b32 a61, 0
    v_accvgpr_write_b32 a62, 0
    v_accvgpr_write_b32 a63, 0
    v_accvgpr_write_b32 a128, 0
    v_accvgpr_write_b32 a129, 0
    v_accvgpr_write_b32 a130, 0
    v_accvgpr_write_b32 a131, 0
    v_accvgpr_write_b32 a132, 0
    v_accvgpr_write_b32 a133, 0
    v_accvgpr_write_b32 a134, 0
    v_accvgpr_write_b32 a135, 0
    v_accvgpr_write_b32 a136, 0
    v_accvgpr_write_b32 a137, 0
    v_accvgpr_write_b32 a138, 0
    v_accvgpr_write_b32 a139, 0
    v_accvgpr_write_b32 a140, 0
    v_accvgpr_write_b32 a141, 0
    v_accvgpr_write_b32 a142, 0
    v_accvgpr_write_b32 a143, 0
    s_lshr_b32 s68, s54, 1
    s_lshl_b32 s68, s68, 19
    s_add_u32 s68, s68, 393216
    s_mov_b32 s25, 16
.p2align 3
TA_sl12:
    s_mov_b64 s[64:65], s[40:41]
    s_add_u32 m0, s70, 0
    s_add_u32 s34, s68, 0
    buffer_load_dwordx4 v248, s[64:67], s34 offen lds
    s_add_u32 m0, s70, 1024
    s_add_u32 s34, s68, 64
    buffer_load_dwordx4 v248, s[64:67], s34 offen lds
    s_add_u32 m0, s70, 2048
    s_add_u32 s34, s68, 128
    buffer_load_dwordx4 v248, s[64:67], s34 offen lds
    s_add_u32 m0, s70, 3072
    s_add_u32 s34, s68, 192
    buffer_load_dwordx4 v248, s[64:67], s34 offen lds
    s_add_u32 m0, s70, 4096
    s_add_u32 s34, s68, 4096
    buffer_load_dwordx4 v248, s[64:67], s34 offen lds
    s_add_u32 m0, s70, 5120
    s_add_u32 s34, s68, 4160
    buffer_load_dwordx4 v248, s[64:67], s34 offen lds
    s_add_u32 m0, s70, 6144
    s_add_u32 s34, s68, 4224
    buffer_load_dwordx4 v248, s[64:67], s34 offen lds
    s_add_u32 m0, s70, 7168
    s_add_u32 s34, s68, 4288
    buffer_load_dwordx4 v248, s[64:67], s34 offen lds
    s_mov_b64 s[64:65], s[42:43]
    s_add_u32 m0, s70, 8192
    s_add_u32 s34, s68, 0
    buffer_load_dwordx4 v248, s[64:67], s34 offen lds
    s_add_u32 m0, s70, 9216
    s_add_u32 s34, s68, 64
    buffer_load_dwordx4 v248, s[64:67], s34 offen lds
    s_add_u32 m0, s70, 10240
    s_add_u32 s34, s68, 128
    buffer_load_dwordx4 v248, s[64:67], s34 offen lds
    s_add_u32 m0, s70, 11264
    s_add_u32 s34, s68, 192
    buffer_load_dwordx4 v248, s[64:67], s34 offen lds
    s_add_u32 m0, s70, 12288
    s_add_u32 s34, s68, 4096
    buffer_load_dwordx4 v248, s[64:67], s34 offen lds
    s_add_u32 m0, s70, 13312
    s_add_u32 s34, s68, 4160
    buffer_load_dwordx4 v248, s[64:67], s34 offen lds
    s_add_u32 m0, s70, 14336
    s_add_u32 s34, s68, 4224
    buffer_load_dwordx4 v248, s[64:67], s34 offen lds
    s_add_u32 m0, s70, 15360
    s_add_u32 s34, s68, 4288
    buffer_load_dwordx4 v248, s[64:67], s34 offen lds
    s_waitcnt vmcnt(0)
    ds_read_b128 a[176:179], v249 offset:0
    ds_read_b128 a[180:183], v249 offset:1024
    ds_read_b128 a[184:187], v249 offset:2048
    ds_read_b128 a[188:191], v249 offset:3072
    s_waitcnt lgkmcnt(3)
    v_mfma_f32_16x16x32_bf16 v[12:15], a[176:179], v[44:47], v[220:223]
    v_mfma_f32_16x16x32_bf16 v[16:19], a[176:179], v[48:51], v[224:227]
    v_mfma_f32_16x16x32_bf16 v[20:23], a[176:179], v[52:55], v[228:231]
    v_mfma_f32_16x16x32_bf16 v[24:27], a[176:179], v[56:59], v[232:235]
    s_waitcnt lgkmcnt(2)
    v_mfma_f32_16x16x32_bf16 v[12:15], a[180:183], v[60:63], v[12:15]
    v_mfma_f32_16x16x32_bf16 v[16:19], a[180:183], v[64:67], v[16:19]
    v_mfma_f32_16x16x32_bf16 v[20:23], a[180:183], v[68:71], v[20:23]
    v_mfma_f32_16x16x32_bf16 v[24:27], a[180:183], v[72:75], v[24:27]
    s_waitcnt lgkmcnt(1)
    v_mfma_f32_16x16x32_bf16 v[12:15], a[184:187], v[76:79], v[12:15]
    v_mfma_f32_16x16x32_bf16 v[16:19], a[184:187], v[80:83], v[16:19]
    v_mfma_f32_16x16x32_bf16 v[20:23], a[184:187], v[84:87], v[20:23]
    v_mfma_f32_16x16x32_bf16 v[24:27], a[184:187], v[88:91], v[24:27]
    s_waitcnt lgkmcnt(0)
    v_mfma_f32_16x16x32_bf16 v[12:15], a[188:191], v[92:95], v[12:15]
    v_mfma_f32_16x16x32_bf16 v[16:19], a[188:191], v[96:99], v[16:19]
    v_mfma_f32_16x16x32_bf16 v[20:23], a[188:191], v[100:103], v[20:23]
    v_mfma_f32_16x16x32_bf16 v[24:27], a[188:191], v[104:107], v[24:27]
    ds_read_b128 a[176:179], v249 offset:4096
    ds_read_b128 a[180:183], v249 offset:5120
    ds_read_b128 a[184:187], v249 offset:6144
    ds_read_b128 a[188:191], v249 offset:7168
    s_waitcnt lgkmcnt(3)
    v_mfma_f32_16x16x32_bf16 v[28:31], a[176:179], v[44:47], v[220:223]
    v_mfma_f32_16x16x32_bf16 v[32:35], a[176:179], v[48:51], v[224:227]
    v_mfma_f32_16x16x32_bf16 v[36:39], a[176:179], v[52:55], v[228:231]
    v_mfma_f32_16x16x32_bf16 v[40:43], a[176:179], v[56:59], v[232:235]
    s_waitcnt lgkmcnt(2)
    v_mfma_f32_16x16x32_bf16 v[28:31], a[180:183], v[60:63], v[28:31]
    v_mfma_f32_16x16x32_bf16 v[32:35], a[180:183], v[64:67], v[32:35]
    v_mfma_f32_16x16x32_bf16 v[36:39], a[180:183], v[68:71], v[36:39]
    v_mfma_f32_16x16x32_bf16 v[40:43], a[180:183], v[72:75], v[40:43]
    s_waitcnt lgkmcnt(1)
    v_mfma_f32_16x16x32_bf16 v[28:31], a[184:187], v[76:79], v[28:31]
    v_mfma_f32_16x16x32_bf16 v[32:35], a[184:187], v[80:83], v[32:35]
    v_mfma_f32_16x16x32_bf16 v[36:39], a[184:187], v[84:87], v[36:39]
    v_mfma_f32_16x16x32_bf16 v[40:43], a[184:187], v[88:91], v[40:43]
    s_waitcnt lgkmcnt(0)
    v_mfma_f32_16x16x32_bf16 v[28:31], a[188:191], v[92:95], v[28:31]
    v_mfma_f32_16x16x32_bf16 v[32:35], a[188:191], v[96:99], v[32:35]
    v_mfma_f32_16x16x32_bf16 v[36:39], a[188:191], v[100:103], v[36:39]
    v_mfma_f32_16x16x32_bf16 v[40:43], a[188:191], v[104:107], v[40:43]
    v_exp_f32 v12, v12
    v_exp_f32 v13, v13
    v_exp_f32 v14, v14
    v_exp_f32 v15, v15
    v_cvt_pk_bf16_f32 v204, v12, v13
    v_cvt_pk_bf16_f32 v205, v14, v15
    v_exp_f32 v16, v16
    v_exp_f32 v17, v17
    v_exp_f32 v18, v18
    v_exp_f32 v19, v19
    v_cvt_pk_bf16_f32 v208, v16, v17
    v_cvt_pk_bf16_f32 v209, v18, v19
    v_exp_f32 v20, v20
    v_exp_f32 v21, v21
    v_exp_f32 v22, v22
    v_exp_f32 v23, v23
    v_cvt_pk_bf16_f32 v212, v20, v21
    v_cvt_pk_bf16_f32 v213, v22, v23
    v_exp_f32 v24, v24
    v_exp_f32 v25, v25
    v_exp_f32 v26, v26
    v_exp_f32 v27, v27
    v_cvt_pk_bf16_f32 v216, v24, v25
    v_cvt_pk_bf16_f32 v217, v26, v27
    v_exp_f32 v28, v28
    v_exp_f32 v29, v29
    v_exp_f32 v30, v30
    v_exp_f32 v31, v31
    v_cvt_pk_bf16_f32 v206, v28, v29
    v_cvt_pk_bf16_f32 v207, v30, v31
    v_exp_f32 v32, v32
    v_exp_f32 v33, v33
    v_exp_f32 v34, v34
    v_exp_f32 v35, v35
    v_cvt_pk_bf16_f32 v210, v32, v33
    v_cvt_pk_bf16_f32 v211, v34, v35
    v_exp_f32 v36, v36
    v_exp_f32 v37, v37
    v_exp_f32 v38, v38
    v_exp_f32 v39, v39
    v_cvt_pk_bf16_f32 v214, v36, v37
    v_cvt_pk_bf16_f32 v215, v38, v39
    v_exp_f32 v40, v40
    v_exp_f32 v41, v41
    v_exp_f32 v42, v42
    v_exp_f32 v43, v43
    v_cvt_pk_bf16_f32 v218, v40, v41
    v_cvt_pk_bf16_f32 v219, v42, v43
    v_mfma_f32_16x16x32_bf16 a[128:131], v[236:239], v[204:207], a[128:131]
    v_mfma_f32_16x16x32_bf16 a[132:135], v[236:239], v[208:211], a[132:135]
    v_mfma_f32_16x16x32_bf16 a[136:139], v[236:239], v[212:215], a[136:139]
    v_mfma_f32_16x16x32_bf16 a[140:143], v[236:239], v[216:219], a[140:143]
    s_cmp_eq_u32 s25, 1
    s_cbranch_scc1 TA_slo13
    ds_read_b64_tr_b16 a[176:177], v250 offset:8192
    ds_read_b64_tr_b16 a[178:179], v250 offset:12288
    s_waitcnt lgkmcnt(0)
    v_mfma_f32_16x16x32_bf16 v[108:111], a[176:179], v[204:207], v[108:111]
    v_mfma_f32_16x16x32_bf16 v[112:115], a[176:179], v[208:211], v[112:115]
    v_mfma_f32_16x16x32_bf16 v[116:119], a[176:179], v[212:215], v[116:119]
    v_mfma_f32_16x16x32_bf16 v[120:123], a[176:179], v[216:219], v[120:123]
    ds_read_b64_tr_b16 a[180:181], v251 offset:8192
    ds_read_b64_tr_b16 a[182:183], v251 offset:12288
    s_waitcnt lgkmcnt(0)
    v_mfma_f32_16x16x32_bf16 v[124:127], a[180:183], v[204:207], v[124:127]
    v_mfma_f32_16x16x32_bf16 v[128:131], a[180:183], v[208:211], v[128:131]
    v_mfma_f32_16x16x32_bf16 v[132:135], a[180:183], v[212:215], v[132:135]
    v_mfma_f32_16x16x32_bf16 v[136:139], a[180:183], v[216:219], v[136:139]
    ds_read_b64_tr_b16 a[184:185], v250 offset:9216
    ds_read_b64_tr_b16 a[186:187], v250 offset:13312
    s_waitcnt lgkmcnt(0)
    v_mfma_f32_16x16x32_bf16 v[140:143], a[184:187], v[204:207], v[140:143]
    v_mfma_f32_16x16x32_bf16 v[144:147], a[184:187], v[208:211], v[144:147]
    v_mfma_f32_16x16x32_bf16 v[148:151], a[184:187], v[212:215], v[148:151]
    v_mfma_f32_16x16x32_bf16 v[152:155], a[184:187], v[216:219], v[152:155]
    ds_read_b64_tr_b16 a[188:189], v251 offset:9216
    ds_read_b64_tr_b16 a[190:191], v251 offset:13312
    s_waitcnt lgkmcnt(0)
    v_mfma_f32_16x16x32_bf16 v[156:159], a[188:191], v[204:207], v[156:159]
    v_mfma_f32_16x16x32_bf16 v[160:163], a[188:191], v[208:211], v[160:163]
    v_mfma_f32_16x16x32_bf16 v[164:167], a[188:191], v[212:215], v[164:167]
    v_mfma_f32_16x16x32_bf16 v[168:171], a[188:191], v[216:219], v[168:171]
    ds_read_b64_tr_b16 a[176:177], v250 offset:10240
    ds_read_b64_tr_b16 a[178:179], v250 offset:14336
    s_waitcnt lgkmcnt(0)
    v_mfma_f32_16x16x32_bf16 a[0:3], a[176:179], v[204:207], a[0:3]
    v_mfma_f32_16x16x32_bf16 a[4:7], a[176:179], v[208:211], a[4:7]
    v_mfma_f32_16x16x32_bf16 a[8:11], a[176:179], v[212:215], a[8:11]
    v_mfma_f32_16x16x32_bf16 a[12:15], a[176:179], v[216:219], a[12:15]
    ds_read_b64_tr_b16 a[180:181], v251 offset:10240
    ds_read_b64_tr_b16 a[182:183], v251 offset:14336
    s_waitcnt lgkmcnt(0)
    v_mfma_f32_16x16x32_bf16 a[16:19], a[180:183], v[204:207], a[16:19]
    v_mfma_f32_16x16x32_bf16 a[20:23], a[180:183], v[208:211], a[20:23]
    v_mfma_f32_16x16x32_bf16 a[24:27], a[180:183], v[212:215], a[24:27]
    v_mfma_f32_16x16x32_bf16 a[28:31], a[180:183], v[216:219], a[28:31]
    ds_read_b64_tr_b16 a[184:185], v250 offset:11264
    ds_read_b64_tr_b16 a[186:187], v250 offset:15360
    s_waitcnt lgkmcnt(0)
    v_mfma_f32_16x16x32_bf16 a[32:35], a[184:187], v[204:207], a[32:35]
    v_mfma_f32_16x16x32_bf16 a[36:39], a[184:187], v[208:211], a[36:39]
    v_mfma_f32_16x16x32_bf16 a[40:43], a[184:187], v[212:215], a[40:43]
    v_mfma_f32_16x16x32_bf16 a[44:47], a[184:187], v[216:219], a[44:47]
    ds_read_b64_tr_b16 a[188:189], v251 offset:11264
    ds_read_b64_tr_b16 a[190:191], v251 offset:15360
    s_waitcnt lgkmcnt(0)
    v_mfma_f32_16x16x32_bf16 a[48:51], a[188:191], v[204:207], a[48:51]
    v_mfma_f32_16x16x32_bf16 a[52:55], a[188:191], v[208:211], a[52:55]
    v_mfma_f32_16x16x32_bf16 a[56:59], a[188:191], v[212:215], a[56:59]
    v_mfma_f32_16x16x32_bf16 a[60:63], a[188:191], v[216:219], a[60:63]
    s_add_u32 s68, s68, 8192
    s_sub_u32 s25, s25, 1
    s_cmp_lg_u32 s25, 0
    s_cbranch_scc1 TA_sl12
TA_slo13:
    s_mov_b32 m0, s69
    s_nop 7
    s_nop 7
    s_branch TA_At1norm10
TA_At2slow16:
    s_waitcnt vmcnt(0) lgkmcnt(0)
    s_nop 7
    s_mov_b32 s69, m0
    s_mov_b32 s66, 8388608
    s_mov_b32 s67, 0x00020000
    v_lshrrev_b32 v249, 2, v0
    v_lshlrev_b32 v249, 8, v249
    v_lshrrev_b32 v248, 4, v0
    v_sub_u32 v248, 0, v248
    v_xor_b32 v248, v248, v0
    v_and_b32 v248, 3, v248
    v_lshl_add_u32 v248, v248, 4, v249
    v_add_u32 v249, s70, v8
    v_add_u32 v250, s70, v6
    v_xor_b32 v251, 32, v250
    s_lshr_b32 s68, s55, 1
    s_lshl_b32 s68, s68, 19
    s_add_u32 s68, s68, 393216
    s_mov_b32 s25, 16
    v_mov_b32 v240, 0xff800000
    v_mov_b32 v241, 0xff800000
    v_mov_b32 v242, 0xff800000
    v_mov_b32 v243, 0xff800000
.p2align 3
TA_sl18:
    s_mov_b64 s[64:65], s[40:41]
    s_add_u32 m0, s70, 0
    s_add_u32 s34, s68, 0
    buffer_load_dwordx4 v248, s[64:67], s34 offen lds
    s_add_u32 m0, s70, 1024
    s_add_u32 s34, s68, 64
    buffer_load_dwordx4 v248, s[64:67], s34 offen lds
    s_add_u32 m0, s70, 2048
    s_add_u32 s34, s68, 128
    buffer_load_dwordx4 v248, s[64:67], s34 offen lds
    s_add_u32 m0, s70, 3072
    s_add_u32 s34, s68, 192
    buffer_load_dwordx4 v248, s[64:67], s34 offen lds
    s_add_u32 m0, s70, 4096
    s_add_u32 s34, s68, 4096
    buffer_load_dwordx4 v248, s[64:67], s34 offen lds
    s_add_u32 m0, s70, 5120
    s_add_u32 s34, s68, 4160
    buffer_load_dwordx4 v248, s[64:67], s34 offen lds
    s_add_u32 m0, s70, 6144
    s_add_u32 s34, s68, 4224
    buffer_load_dwordx4 v248, s[64:67], s34 offen lds
    s_add_u32 m0, s70, 7168
    s_add_u32 s34, s68, 4288
    buffer_load_dwordx4 v248, s[64:67], s34 offen lds
    s_waitcnt vmcnt(0)
    ds_read_b128 a[176:179], v249 offset:0
    ds_read_b128 a[180:183], v249 offset:1024
    ds_read_b128 a[184:187], v249 offset:2048
    ds_read_b128 a[188:191], v249 offset:3072
    s_waitcnt lgkmcnt(3)
    v_mfma_f32_16x16x32_bf16 v[12:15], a[176:179], a[192:195], 0
    v_mfma_f32_16x16x32_bf16 v[16:19], a[176:179], a[196:199], 0
    v_mfma_f32_16x16x32_bf16 v[20:23], a[176:179], a[200:203], 0
    v_mfma_f32_16x16x32_bf16 v[24:27], a[176:179], a[204:207], 0
    s_waitcnt lgkmcnt(2)
    v_mfma_f32_16x16x32_bf16 v[12:15], a[180:183], a[208:211], v[12:15]
    v_mfma_f32_16x16x32_bf16 v[16:19], a[180:183], a[212:215], v[16:19]
    v_mfma_f32_16x16x32_bf16 v[20:23], a[180:183], a[216:219], v[20:23]
    v_mfma_f32_16x16x32_bf16 v[24:27], a[180:183], a[220:223], v[24:27]
    s_waitcnt lgkmcnt(1)
    v_mfma_f32_16x16x32_bf16 v[12:15], a[184:187], a[224:227], v[12:15]
    v_mfma_f32_16x16x32_bf16 v[16:19], a[184:187], a[228:231], v[16:19]
    v_mfma_f32_16x16x32_bf16 v[20:23], a[184:187], a[232:235], v[20:23]
    v_mfma_f32_16x16x32_bf16 v[24:27], a[184:187], a[236:239], v[24:27]
    s_waitcnt lgkmcnt(0)
    v_mfma_f32_16x16x32_bf16 v[12:15], a[188:191], a[240:243], v[12:15]
    v_mfma_f32_16x16x32_bf16 v[16:19], a[188:191], a[244:247], v[16:19]
    v_mfma_f32_16x16x32_bf16 v[20:23], a[188:191], a[248:251], v[20:23]
    v_mfma_f32_16x16x32_bf16 v[24:27], a[188:191], a[252:255], v[24:27]
    ds_read_b128 a[176:179], v249 offset:4096
    ds_read_b128 a[180:183], v249 offset:5120
    ds_read_b128 a[184:187], v249 offset:6144
    ds_read_b128 a[188:191], v249 offset:7168
    s_waitcnt lgkmcnt(3)
    v_mfma_f32_16x16x32_bf16 v[28:31], a[176:179], a[192:195], 0
    v_mfma_f32_16x16x32_bf16 v[32:35], a[176:179], a[196:199], 0
    v_mfma_f32_16x16x32_bf16 v[36:39], a[176:179], a[200:203], 0
    v_mfma_f32_16x16x32_bf16 v[40:43], a[176:179], a[204:207], 0
    s_waitcnt lgkmcnt(2)
    v_mfma_f32_16x16x32_bf16 v[28:31], a[180:183], a[208:211], v[28:31]
    v_mfma_f32_16x16x32_bf16 v[32:35], a[180:183], a[212:215], v[32:35]
    v_mfma_f32_16x16x32_bf16 v[36:39], a[180:183], a[216:219], v[36:39]
    v_mfma_f32_16x16x32_bf16 v[40:43], a[180:183], a[220:223], v[40:43]
    s_waitcnt lgkmcnt(1)
    v_mfma_f32_16x16x32_bf16 v[28:31], a[184:187], a[224:227], v[28:31]
    v_mfma_f32_16x16x32_bf16 v[32:35], a[184:187], a[228:231], v[32:35]
    v_mfma_f32_16x16x32_bf16 v[36:39], a[184:187], a[232:235], v[36:39]
    v_mfma_f32_16x16x32_bf16 v[40:43], a[184:187], a[236:239], v[40:43]
    s_waitcnt lgkmcnt(0)
    v_mfma_f32_16x16x32_bf16 v[28:31], a[188:191], a[240:243], v[28:31]
    v_mfma_f32_16x16x32_bf16 v[32:35], a[188:191], a[244:247], v[32:35]
    v_mfma_f32_16x16x32_bf16 v[36:39], a[188:191], a[248:251], v[36:39]
    v_mfma_f32_16x16x32_bf16 v[40:43], a[188:191], a[252:255], v[40:43]
    v_max3_f32 v240, v240, v12, v13
    v_max3_f32 v240, v240, v14, v15
    v_max3_f32 v241, v241, v16, v17
    v_max3_f32 v241, v241, v18, v19
    v_max3_f32 v242, v242, v20, v21
    v_max3_f32 v242, v242, v22, v23
    v_max3_f32 v243, v243, v24, v25
    v_max3_f32 v243, v243, v26, v27
    v_max3_f32 v240, v240, v28, v29
    v_max3_f32 v240, v240, v30, v31
    v_max3_f32 v241, v241, v32, v33
    v_max3_f32 v241, v241, v34, v35
    v_max3_f32 v242, v242, v36, v37
    v_max3_f32 v242, v242, v38, v39
    v_max3_f32 v243, v243, v40, v41
    v_max3_f32 v243, v243, v42, v43
    s_add_u32 s68, s68, 8192
    s_sub_u32 s25, s25, 1
    s_cmp_lg_u32 s25, 0
    s_cbranch_scc1 TA_sl18
    v_mov_b32 v244, v240
    s_nop 1
    v_permlane32_swap_b32 v244, v240
    v_max_f32 v240, v240, v244
    v_mov_b32 v244, v240
    s_nop 1
    v_permlane16_swap_b32 v244, v240
    v_max_f32 v240, v240, v244
    v_sub_f32 v220, 0, v240
    v_sub_f32 v221, 0, v240
    v_sub_f32 v222, 0, v240
    v_sub_f32 v223, 0, v240
    v_mov_b32 v244, v241
    s_nop 1
    v_permlane32_swap_b32 v244, v241
    v_max_f32 v241, v241, v244
    v_mov_b32 v244, v241
    s_nop 1
    v_permlane16_swap_b32 v244, v241
    v_max_f32 v241, v241, v244
    v_sub_f32 v224, 0, v241
    v_sub_f32 v225, 0, v241
    v_sub_f32 v226, 0, v241
    v_sub_f32 v227, 0, v241
    v_mov_b32 v244, v242
    s_nop 1
    v_permlane32_swap_b32 v244, v242
    v_max_f32 v242, v242, v244
    v_mov_b32 v244, v242
    s_nop 1
    v_permlane16_swap_b32 v244, v242
    v_max_f32 v242, v242, v244
    v_sub_f32 v228, 0, v242
    v_sub_f32 v229, 0, v242
    v_sub_f32 v230, 0, v242
    v_sub_f32 v231, 0, v242
    v_mov_b32 v244, v243
    s_nop 1
    v_permlane32_swap_b32 v244, v243
    v_max_f32 v243, v243, v244
    v_mov_b32 v244, v243
    s_nop 1
    v_permlane16_swap_b32 v244, v243
    v_max_f32 v243, v243, v244
    v_sub_f32 v232, 0, v243
    v_sub_f32 v233, 0, v243
    v_sub_f32 v234, 0, v243
    v_sub_f32 v235, 0, v243
    v_mov_b32 v108, 0
    v_mov_b32 v109, 0
    v_mov_b32 v110, 0
    v_mov_b32 v111, 0
    v_mov_b32 v112, 0
    v_mov_b32 v113, 0
    v_mov_b32 v114, 0
    v_mov_b32 v115, 0
    v_mov_b32 v116, 0
    v_mov_b32 v117, 0
    v_mov_b32 v118, 0
    v_mov_b32 v119, 0
    v_mov_b32 v120, 0
    v_mov_b32 v121, 0
    v_mov_b32 v122, 0
    v_mov_b32 v123, 0
    v_mov_b32 v124, 0
    v_mov_b32 v125, 0
    v_mov_b32 v126, 0
    v_mov_b32 v127, 0
    v_mov_b32 v128, 0
    v_mov_b32 v129, 0
    v_mov_b32 v130, 0
    v_mov_b32 v131, 0
    v_mov_b32 v132, 0
    v_mov_b32 v133, 0
    v_mov_b32 v134, 0
    v_mov_b32 v135, 0
    v_mov_b32 v136, 0
    v_mov_b32 v137, 0
    v_mov_b32 v138, 0
    v_mov_b32 v139, 0
    v_mov_b32 v140, 0
    v_mov_b32 v141, 0
    v_mov_b32 v142, 0
    v_mov_b32 v143, 0
    v_mov_b32 v144, 0
    v_mov_b32 v145, 0
    v_mov_b32 v146, 0
    v_mov_b32 v147, 0
    v_mov_b32 v148, 0
    v_mov_b32 v149, 0
    v_mov_b32 v150, 0
    v_mov_b32 v151, 0
    v_mov_b32 v152, 0
    v_mov_b32 v153, 0
    v_mov_b32 v154, 0
    v_mov_b32 v155, 0
    v_mov_b32 v156, 0
    v_mov_b32 v157, 0
    v_mov_b32 v158, 0
    v_mov_b32 v159, 0
    v_mov_b32 v160, 0
    v_mov_b32 v161, 0
    v_mov_b32 v162, 0
    v_mov_b32 v163, 0
    v_mov_b32 v164, 0
    v_mov_b32 v165, 0
    v_mov_b32 v166, 0
    v_mov_b32 v167, 0
    v_mov_b32 v168, 0
    v_mov_b32 v169, 0
    v_mov_b32 v170, 0
    v_mov_b32 v171, 0
    v_mov_b32 v44, 0
    v_mov_b32 v45, 0
    v_mov_b32 v46, 0
    v_mov_b32 v47, 0
    v_mov_b32 v48, 0
    v_mov_b32 v49, 0
    v_mov_b32 v50, 0
    v_mov_b32 v51, 0
    v_mov_b32 v52, 0
    v_mov_b32 v53, 0
    v_mov_b32 v54, 0
    v_mov_b32 v55, 0
    v_mov_b32 v56, 0
    v_mov_b32 v57, 0
    v_mov_b32 v58, 0
    v_mov_b32 v59, 0
    v_mov_b32 v60, 0
    v_mov_b32 v61, 0
    v_mov_b32 v62, 0
    v_mov_b32 v63, 0
    v_mov_b32 v64, 0
    v_mov_b32 v65, 0
    v_mov_b32 v66, 0
    v_mov_b32 v67, 0
    v_mov_b32 v68, 0
    v_mov_b32 v69, 0
    v_mov_b32 v70, 0
    v_mov_b32 v71, 0
    v_mov_b32 v72, 0
    v_mov_b32 v73, 0
    v_mov_b32 v74, 0
    v_mov_b32 v75, 0
    v_mov_b32 v76, 0
    v_mov_b32 v77, 0
    v_mov_b32 v78, 0
    v_mov_b32 v79, 0
    v_mov_b32 v80, 0
    v_mov_b32 v81, 0
    v_mov_b32 v82, 0
    v_mov_b32 v83, 0
    v_mov_b32 v84, 0
    v_mov_b32 v85, 0
    v_mov_b32 v86, 0
    v_mov_b32 v87, 0
    v_mov_b32 v88, 0
    v_mov_b32 v89, 0
    v_mov_b32 v90, 0
    v_mov_b32 v91, 0
    v_mov_b32 v92, 0
    v_mov_b32 v93, 0
    v_mov_b32 v94, 0
    v_mov_b32 v95, 0
    v_mov_b32 v96, 0
    v_mov_b32 v97, 0
    v_mov_b32 v98, 0
    v_mov_b32 v99, 0
    v_mov_b32 v100, 0
    v_mov_b32 v101, 0
    v_mov_b32 v102, 0
    v_mov_b32 v103, 0
    v_mov_b32 v104, 0
    v_mov_b32 v105, 0
    v_mov_b32 v106, 0
    v_mov_b32 v107, 0
    v_accvgpr_write_b32 a128, 0
    v_accvgpr_write_b32 a129, 0
    v_accvgpr_write_b32 a130, 0
    v_accvgpr_write_b32 a131, 0
    v_accvgpr_write_b32 a132, 0
    v_accvgpr_write_b32 a133, 0
    v_accvgpr_write_b32 a134, 0
    v_accvgpr_write_b32 a135, 0
    v_accvgpr_write_b32 a136, 0
    v_accvgpr_write_b32 a137, 0
    v_accvgpr_write_b32 a138, 0
    v_accvgpr_write_b32 a139, 0
    v_accvgpr_write_b32 a140, 0
    v_accvgpr_write_b32 a141, 0
    v_accvgpr_write_b32 a142, 0
    v_accvgpr_write_b32 a143, 0
    s_lshr_b32 s68, s55, 1
    s_lshl_b32 s68, s68, 19
    s_add_u32 s68, s68, 393216
    s_mov_b32 s25, 16
.p2align 3
TA_sl19:
    s_mov_b64 s[64:65], s[40:41]
    s_add_u32 m0, s70, 0
    s_add_u32 s34, s68, 0
    buffer_load_dwordx4 v248, s[64:67], s34 offen lds
    s_add_u32 m0, s70, 1024
    s_add_u32 s34, s68, 64
    buffer_load_dwordx4 v248, s[64:67], s34 offen lds
    s_add_u32 m0, s70, 2048
    s_add_u32 s34, s68, 128
    buffer_load_dwordx4 v248, s[64:67], s34 offen lds
    s_add_u32 m0, s70, 3072
    s_add_u32 s34, s68, 192
    buffer_load_dwordx4 v248, s[64:67], s34 offen lds
    s_add_u32 m0, s70, 4096
    s_add_u32 s34, s68, 4096
    buffer_load_dwordx4 v248, s[64:67], s34 offen lds
    s_add_u32 m0, s70, 5120
    s_add_u32 s34, s68, 4160
    buffer_load_dwordx4 v248, s[64:67], s34 offen lds
    s_add_u32 m0, s70, 6144
    s_add_u32 s34, s68, 4224
    buffer_load_dwordx4 v248, s[64:67], s34 offen lds
    s_add_u32 m0, s70, 7168
    s_add_u32 s34, s68, 4288
    buffer_load_dwordx4 v248, s[64:67], s34 offen lds
    s_mov_b64 s[64:65], s[42:43]
    s_add_u32 m0, s70, 8192
    s_add_u32 s34, s68, 0
    buffer_load_dwordx4 v248, s[64:67], s34 offen lds
    s_add_u32 m0, s70, 9216
    s_add_u32 s34, s68, 64
    buffer_load_dwordx4 v248, s[64:67], s34 offen lds
    s_add_u32 m0, s70, 10240
    s_add_u32 s34, s68, 128
    buffer_load_dwordx4 v248, s[64:67], s34 offen lds
    s_add_u32 m0, s70, 11264
    s_add_u32 s34, s68, 192
    buffer_load_dwordx4 v248, s[64:67], s34 offen lds
    s_add_u32 m0, s70, 12288
    s_add_u32 s34, s68, 4096
    buffer_load_dwordx4 v248, s[64:67], s34 offen lds
    s_add_u32 m0, s70, 13312
    s_add_u32 s34, s68, 4160
    buffer_load_dwordx4 v248, s[64:67], s34 offen lds
    s_add_u32 m0, s70, 14336
    s_add_u32 s34, s68, 4224
    buffer_load_dwordx4 v248, s[64:67], s34 offen lds
    s_add_u32 m0, s70, 15360
    s_add_u32 s34, s68, 4288
    buffer_load_dwordx4 v248, s[64:67], s34 offen lds
    s_waitcnt vmcnt(0)
    ds_read_b128 a[176:179], v249 offset:0
    ds_read_b128 a[180:183], v249 offset:1024
    ds_read_b128 a[184:187], v249 offset:2048
    ds_read_b128 a[188:191], v249 offset:3072
    s_waitcnt lgkmcnt(3)
    v_mfma_f32_16x16x32_bf16 v[12:15], a[176:179], a[192:195], v[220:223]
    v_mfma_f32_16x16x32_bf16 v[16:19], a[176:179], a[196:199], v[224:227]
    v_mfma_f32_16x16x32_bf16 v[20:23], a[176:179], a[200:203], v[228:231]
    v_mfma_f32_16x16x32_bf16 v[24:27], a[176:179], a[204:207], v[232:235]
    s_waitcnt lgkmcnt(2)
    v_mfma_f32_16x16x32_bf16 v[12:15], a[180:183], a[208:211], v[12:15]
    v_mfma_f32_16x16x32_bf16 v[16:19], a[180:183], a[212:215], v[16:19]
    v_mfma_f32_16x16x32_bf16 v[20:23], a[180:183], a[216:219], v[20:23]
    v_mfma_f32_16x16x32_bf16 v[24:27], a[180:183], a[220:223], v[24:27]
    s_waitcnt lgkmcnt(1)
    v_mfma_f32_16x16x32_bf16 v[12:15], a[184:187], a[224:227], v[12:15]
    v_mfma_f32_16x16x32_bf16 v[16:19], a[184:187], a[228:231], v[16:19]
    v_mfma_f32_16x16x32_bf16 v[20:23], a[184:187], a[232:235], v[20:23]
    v_mfma_f32_16x16x32_bf16 v[24:27], a[184:187], a[236:239], v[24:27]
    s_waitcnt lgkmcnt(0)
    v_mfma_f32_16x16x32_bf16 v[12:15], a[188:191], a[240:243], v[12:15]
    v_mfma_f32_16x16x32_bf16 v[16:19], a[188:191], a[244:247], v[16:19]
    v_mfma_f32_16x16x32_bf16 v[20:23], a[188:191], a[248:251], v[20:23]
    v_mfma_f32_16x16x32_bf16 v[24:27], a[188:191], a[252:255], v[24:27]
    ds_read_b128 a[176:179], v249 offset:4096
    ds_read_b128 a[180:183], v249 offset:5120
    ds_read_b128 a[184:187], v249 offset:6144
    ds_read_b128 a[188:191], v249 offset:7168
    s_waitcnt lgkmcnt(3)
    v_mfma_f32_16x16x32_bf16 v[28:31], a[176:179], a[192:195], v[220:223]
    v_mfma_f32_16x16x32_bf16 v[32:35], a[176:179], a[196:199], v[224:227]
    v_mfma_f32_16x16x32_bf16 v[36:39], a[176:179], a[200:203], v[228:231]
    v_mfma_f32_16x16x32_bf16 v[40:43], a[176:179], a[204:207], v[232:235]
    s_waitcnt lgkmcnt(2)
    v_mfma_f32_16x16x32_bf16 v[28:31], a[180:183], a[208:211], v[28:31]
    v_mfma_f32_16x16x32_bf16 v[32:35], a[180:183], a[212:215], v[32:35]
    v_mfma_f32_16x16x32_bf16 v[36:39], a[180:183], a[216:219], v[36:39]
    v_mfma_f32_16x16x32_bf16 v[40:43], a[180:183], a[220:223], v[40:43]
    s_waitcnt lgkmcnt(1)
    v_mfma_f32_16x16x32_bf16 v[28:31], a[184:187], a[224:227], v[28:31]
    v_mfma_f32_16x16x32_bf16 v[32:35], a[184:187], a[228:231], v[32:35]
    v_mfma_f32_16x16x32_bf16 v[36:39], a[184:187], a[232:235], v[36:39]
    v_mfma_f32_16x16x32_bf16 v[40:43], a[184:187], a[236:239], v[40:43]
    s_waitcnt lgkmcnt(0)
    v_mfma_f32_16x16x32_bf16 v[28:31], a[188:191], a[240:243], v[28:31]
    v_mfma_f32_16x16x32_bf16 v[32:35], a[188:191], a[244:247], v[32:35]
    v_mfma_f32_16x16x32_bf16 v[36:39], a[188:191], a[248:251], v[36:39]
    v_mfma_f32_16x16x32_bf16 v[40:43], a[188:191], a[252:255], v[40:43]
    v_exp_f32 v12, v12
    v_exp_f32 v13, v13
    v_exp_f32 v14, v14
    v_exp_f32 v15, v15
    v_cvt_pk_bf16_f32 v204, v12, v13
    v_cvt_pk_bf16_f32 v205, v14, v15
    v_exp_f32 v16, v16
    v_exp_f32 v17, v17
    v_exp_f32 v18, v18
    v_exp_f32 v19, v19
    v_cvt_pk_bf16_f32 v208, v16, v17
    v_cvt_pk_bf16_f32 v209, v18, v19
    v_exp_f32 v20, v20
    v_exp_f32 v21, v21
    v_exp_f32 v22, v22
    v_exp_f32 v23, v23
    v_cvt_pk_bf16_f32 v212, v20, v21
    v_cvt_pk_bf16_f32 v213, v22, v23
    v_exp_f32 v24, v24
    v_exp_f32 v25, v25
    v_exp_f32 v26, v26
    v_exp_f32 v27, v27
    v_cvt_pk_bf16_f32 v216, v24, v25
    v_cvt_pk_bf16_f32 v217, v26, v27
    v_exp_f32 v28, v28
    v_exp_f32 v29, v29
    v_exp_f32 v30, v30
    v_exp_f32 v31, v31
    v_cvt_pk_bf16_f32 v206, v28, v29
    v_cvt_pk_bf16_f32 v207, v30, v31
    v_exp_f32 v32, v32
    v_exp_f32 v33, v33
    v_exp_f32 v34, v34
    v_exp_f32 v35, v35
    v_cvt_pk_bf16_f32 v210, v32, v33
    v_cvt_pk_bf16_f32 v211, v34, v35
    v_exp_f32 v36, v36
    v_exp_f32 v37, v37
    v_exp_f32 v38, v38
    v_exp_f32 v39, v39
    v_cvt_pk_bf16_f32 v214, v36, v37
    v_cvt_pk_bf16_f32 v215, v38, v39
    v_exp_f32 v40, v40
    v_exp_f32 v41, v41
    v_exp_f32 v42, v42
    v_exp_f32 v43, v43
    v_cvt_pk_bf16_f32 v218, v40, v41
    v_cvt_pk_bf16_f32 v219, v42, v43
    v_mfma_f32_16x16x32_bf16 a[128:131], v[236:239], v[204:207], a[128:131]
    v_mfma_f32_16x16x32_bf16 a[132:135], v[236:239], v[208:211], a[132:135]
    v_mfma_f32_16x16x32_bf16 a[136:139], v[236:239], v[212:215], a[136:139]
    v_mfma_f32_16x16x32_bf16 a[140:143], v[236:239], v[216:219], a[140:143]
    s_cmp_eq_u32 s25, 1
    s_cbranch_scc1 TA_slo20
    ds_read_b64_tr_b16 a[176:177], v250 offset:8192
    ds_read_b64_tr_b16 a[178:179], v250 offset:12288
    s_waitcnt lgkmcnt(0)
    v_mfma_f32_16x16x32_bf16 v[108:111], a[176:179], v[204:207], v[108:111]
    v_mfma_f32_16x16x32_bf16 v[112:115], a[176:179], v[208:211], v[112:115]
    v_mfma_f32_16x16x32_bf16 v[116:119], a[176:179], v[212:215], v[116:119]
    v_mfma_f32_16x16x32_bf16 v[120:123], a[176:179], v[216:219], v[120:123]
    ds_read_b64_tr_b16 a[180:181], v251 offset:8192
    ds_read_b64_tr_b16 a[182:183], v251 offset:12288
    s_waitcnt lgkmcnt(0)
    v_mfma_f32_16x16x32_bf16 v[124:127], a[180:183], v[204:207], v[124:127]
    v_mfma_f32_16x16x32_bf16 v[128:131], a[180:183], v[208:211], v[128:131]
    v_mfma_f32_16x16x32_bf16 v[132:135], a[180:183], v[212:215], v[132:135]
    v_mfma_f32_16x16x32_bf16 v[136:139], a[180:183], v[216:219], v[136:139]
    ds_read_b64_tr_b16 a[184:185], v250 offset:9216
    ds_read_b64_tr_b16 a[186:187], v250 offset:13312
    s_waitcnt lgkmcnt(0)
    v_mfma_f32_16x16x32_bf16 v[140:143], a[184:187], v[204:207], v[140:143]
    v_mfma_f32_16x16x32_bf16 v[144:147], a[184:187], v[208:211], v[144:147]
    v_mfma_f32_16x16x32_bf16 v[148:151], a[184:187], v[212:215], v[148:151]
    v_mfma_f32_16x16x32_bf16 v[152:155], a[184:187], v[216:219], v[152:155]
    ds_read_b64_tr_b16 a[188:189], v251 offset:9216
    ds_read_b64_tr_b16 a[190:191], v251 offset:13312
    s_waitcnt lgkmcnt(0)
    v_mfma_f32_16x16x32_bf16 v[156:159], a[188:191], v[204:207], v[156:159]
    v_mfma_f32_16x16x32_bf16 v[160:163], a[188:191], v[208:211], v[160:163]
    v_mfma_f32_16x16x32_bf16 v[164:167], a[188:191], v[212:215], v[164:167]
    v_mfma_f32_16x16x32_bf16 v[168:171], a[188:191], v[216:219], v[168:171]
    ds_read_b64_tr_b16 a[176:177], v250 offset:10240
    ds_read_b64_tr_b16 a[178:179], v250 offset:14336
    s_waitcnt lgkmcnt(0)
    v_mfma_f32_16x16x32_bf16 v[44:47], a[176:179], v[204:207], v[44:47]
    v_mfma_f32_16x16x32_bf16 v[48:51], a[176:179], v[208:211], v[48:51]
    v_mfma_f32_16x16x32_bf16 v[52:55], a[176:179], v[212:215], v[52:55]
    v_mfma_f32_16x16x32_bf16 v[56:59], a[176:179], v[216:219], v[56:59]
    ds_read_b64_tr_b16 a[180:181], v251 offset:10240
    ds_read_b64_tr_b16 a[182:183], v251 offset:14336
    s_waitcnt lgkmcnt(0)
    v_mfma_f32_16x16x32_bf16 v[60:63], a[180:183], v[204:207], v[60:63]
    v_mfma_f32_16x16x32_bf16 v[64:67], a[180:183], v[208:211], v[64:67]
    v_mfma_f32_16x16x32_bf16 v[68:71], a[180:183], v[212:215], v[68:71]
    v_mfma_f32_16x16x32_bf16 v[72:75], a[180:183], v[216:219], v[72:75]
    ds_read_b64_tr_b16 a[184:185], v250 offset:11264
    ds_read_b64_tr_b16 a[186:187], v250 offset:15360
    s_waitcnt lgkmcnt(0)
    v_mfma_f32_16x16x32_bf16 v[76:79], a[184:187], v[204:207], v[76:79]
    v_mfma_f32_16x16x32_bf16 v[80:83], a[184:187], v[208:211], v[80:83]
    v_mfma_f32_16x16x32_bf16 v[84:87], a[184:187], v[212:215], v[84:87]
    v_mfma_f32_16x16x32_bf16 v[88:91], a[184:187], v[216:219], v[88:91]
    ds_read_b64_tr_b16 a[188:189], v251 offset:11264
    ds_read_b64_tr_b16 a[190:191], v251 offset:15360
    s_waitcnt lgkmcnt(0)
    v_mfma_f32_16x16x32_bf16 v[92:95], a[188:191], v[204:207], v[92:95]
    v_mfma_f32_16x16x32_bf16 v[96:99], a[188:191], v[208:211], v[96:99]
    v_mfma_f32_16x16x32_bf16 v[100:103], a[188:191], v[212:215], v[100:103]
    v_mfma_f32_16x16x32_bf16 v[104:107], a[188:191], v[216:219], v[104:107]
    s_add_u32 s68, s68, 8192
    s_sub_u32 s25, s25, 1
    s_cmp_lg_u32 s25, 0
    s_cbranch_scc1 TA_sl19
TA_slo20:
    s_mov_b32 m0, s69
    s_nop 7
    s_nop 7
    s_branch TA_At2norm17
.p2align 6
START_F:
    buffer_load_dword v254, v3, s[72:75], s71 offen offset:128
    s_lshl_b32 s22, s27, 10
    s_add_u32 s22, s22, 90112
    s_add_u32 s22, s22, 8192
    s_sub_u32 s24, s22, s99
    s_min_u32 s22, s22, s24
    v_xor_b32 v3, s22, v7
    s_waitcnt vmcnt(11)
    s_barrier
    ds_read_b64_tr_b16 v[220:221], v3 offset:0
    ds_read_b64_tr_b16 v[222:223], v3 offset:2048
    ds_read_b64_tr_b16 v[224:225], v3 offset:8
    ds_read_b64_tr_b16 v[226:227], v3 offset:2056
    ds_read_b64_tr_b16 v[228:229], v3 offset:4096
    ds_read_b64_tr_b16 v[230:231], v3 offset:6144
    ds_read_b64_tr_b16 v[232:233], v3 offset:4104
    ds_read_b64_tr_b16 v[234:235], v3 offset:6152
    s_add_u32 s22, s22, 8192
    s_sub_u32 s24, s22, s99
    s_min_u32 s22, s22, s24
    v_xor_b32 v3, s22, v7
    s_waitcnt lgkmcnt(8)
    s_barrier
    s_add_u32 s22, s22, 8192
    s_and_b32 s32, s30, 7
    s_lshl_b32 s34, s29, 3
    s_sub_u32 s24, s22, s99
    s_add_u32 s32, s32, s34
    s_sub_u32 s58, s30, 8
    s_lshl_b32 s98, s29, 2
    s_min_u32 s22, s22, s24
    s_lshl_b32 s32, s32, 2
    s_mul_i32 s56, s58, 576
    s_add_u32 s98, s98, s26
    s_add_u32 s32, s32, s26
    s_mul_i32 s71, s98, 82944
    s_lshl_b32 s96, s56, 1
    v_lshrrev_b32 v8, 2, v0
    s_add_u32 s19, m0, 8192
    s_lshl_b32 s32, s32, 14
    s_waitcnt lgkmcnt(6)
    v_mfma_f32_16x16x32_bf16 v[188:191], v[220:223], a[0:3], 0
    s_add_u32 s71, s71, s96
    v_min_u32 v8, 8, v8
    s_sub_u32 s21, s19, s99
    v_mfma_f32_16x16x32_bf16 v[192:195], v[220:223], a[72:75], 0
    ds_read_b128 a[120:123], v250 offset:57344
    s_add_u32 s32, s32, 63963136
    v_mfma_f32_16x16x32_bf16 v[196:199], v[220:223], a[144:147], 0
    ds_read_b128 v[20:23], v251 offset:57344
    s_mov_b32 s33, 0xf0000000
    v_mfma_f32_16x16x32_bf16 v[200:203], v[220:223], a[216:219], 0
    ds_read_b64_tr_b16 v[220:221], v3 offset:0
    s_add_u32 s58, s58, 8
    s_waitcnt lgkmcnt(7)
    v_mfma_f32_16x16x32_bf16 v[204:207], v[224:227], a[0:3], 0
    ds_read_b64_tr_b16 v[222:223], v3 offset:2048
    s_mov_b32 s72, s48
    v_mfma_f32_16x16x32_bf16 v[208:211], v[224:227], a[72:75], 0
    ds_read_b128 a[124:127], v250 offset:61440
    s_mov_b32 s73, s49
    v_mfma_f32_16x16x32_bf16 v[212:215], v[224:227], a[144:147], 0
    ds_read_b128 v[24:27], v251 offset:61440
    s_mov_b32 s74, 5308416
    v_mfma_f32_16x16x32_bf16 v[216:219], v[224:227], a[216:219], 0
    ds_read_b64_tr_b16 v[224:225], v3 offset:8
    s_mov_b32 s75, 0x00020000
    s_waitcnt lgkmcnt(9)
    v_mfma_f32_16x16x32_bf16 v[188:191], v[228:231], a[4:7], v[188:191]
    ds_read_b64_tr_b16 v[226:227], v3 offset:2056
    s_add_u32 s71, s71, 0
    v_mfma_f32_16x16x32_bf16 v[192:195], v[228:231], a[76:79], v[192:195]
    buffer_load_dwordx4 v1, s[4:7], s16 offen lds
    v_mfma_f32_16x16x32_bf16 v[196:199], v[228:231], a[148:151], v[196:199]
    ds_read_b128 a[128:131], v252 offset:0
    v_mul_u32_u24 v8, 9216, v8
    v_mfma_f32_16x16x32_bf16 v[200:203], v[228:231], a[220:223], v[200:203]
    ds_read_b64_tr_b16 v[228:229], v3 offset:4096
    v_mov_b32 v5, 1
    s_waitcnt lgkmcnt(10)
    v_mfma_f32_16x16x32_bf16 v[204:207], v[232:235], a[4:7], v[204:207]
    buffer_load_dwordx4 v1, s[8:11], s16 offen offset:1024 lds
    v_mfma_f32_16x16x32_bf16 v[208:211], v[232:235], a[76:79], v[208:211]
    ds_read_b64_tr_b16 v[230:231], v3 offset:6144
    s_add_u32 s16, s16, s17
    v_mfma_f32_16x16x32_bf16 v[212:215], v[232:235], a[148:151], v[212:215]
    ds_read_b128 v[28:31], v253 offset:0
    s_add_u32 s20, s16, s18
    v_mfma_f32_16x16x32_bf16 v[216:219], v[232:235], a[220:223], v[216:219]
    ds_read_b64_tr_b16 v[232:233], v3 offset:4104
    s_min_u32 m0, s19, s21
    s_waitcnt lgkmcnt(9)
    v_mfma_f32_16x16x32_bf16 v[188:191], v[220:223], a[8:11], v[188:191]
    ds_read_b64_tr_b16 v[234:235], v3 offset:6152
    v_xor_b32 v3, s22, v7
    v_mfma_f32_16x16x32_bf16 v[192:195], v[220:223], a[80:83], v[192:195]
    s_add_u32 s22, s22, 8192
    ds_read_b128 a[132:135], v252 offset:4096
    v_mfma_f32_16x16x32_bf16 v[196:199], v[220:223], a[152:155], v[196:199]
    ds_read_b128 v[32:35], v253 offset:4096
    s_sub_u32 s24, s22, s99
    v_mfma_f32_16x16x32_bf16 v[200:203], v[220:223], a[224:227], v[200:203]
    ds_read_b128 a[136:139], v252 offset:8192
    s_min_u32 s16, s16, s20
    s_waitcnt lgkmcnt(9)
    v_mfma_f32_16x16x32_bf16 v[204:207], v[224:227], a[8:11], v[204:207]
    ds_read_b128 v[36:39], v253 offset:8192
    s_min_u32 s22, s22, s24
    v_mfma_f32_16x16x32_bf16 v[208:211], v[224:227], a[80:83], v[208:211]
    ds_read_b128 a[140:143], v252 offset:12288
    v_mfma_f32_16x16x32_bf16 v[212:215], v[224:227], a[152:155], v[212:215]
    ds_read_b128 v[40:43], v253 offset:12288
    v_mfma_f32_16x16x32_bf16 v[216:219], v[224:227], a[224:227], v[216:219]
    ds_read_b64_tr_b16 v[220:221], v3 offset:0
    ds_read_b64_tr_b16 v[222:223], v3 offset:2048
    ds_read_b64_tr_b16 v[224:225], v3 offset:8
    s_waitcnt lgkmcnt(3)
    s_mov_b32 s25, 2
    s_branch TF_Qp4e2
TF_SW9:
    s_lshl_b32 s59, s28, 5
    s_lshl_b32 s60, s27, 2
    s_add_u32 s59, s59, s60
    s_mul_i32 s59, s59, 9216
    s_lshl_b32 s60, s56, 1
    s_add_u32 s59, s59, s60
    s_add_u32 s4, s48, s59
    s_addc_u32 s5, s49, 0
    s_sub_u32 s6, 5308416, s59
    s_sub_u32 s8, s4, 960
    s_subb_u32 s9, s5, 0
    s_add_u32 s10, s6, 960
    s_mov_b32 s16, 0
    s_mov_b32 s17, 589824
    s_mov_b32 s18, 4289659008
    v_lshrrev_b32 v2, 4, v0
    v_bfe_u32 v1, v0, 2, 2
    v_lshl_add_u32 v2, v2, 3, v1
    v_mul_u32_u24 v2, 9216, v2
    v_and_or_b32 v1, v7, 48, v2
    s_branch TF_SW9r
.p2align 3
TF_Qp41:
    v_mfma_f32_16x16x32_bf16 v[200:203], v[228:231], v[32:35], v[200:203]
    ds_read_b64_tr_b16 v[228:229], v3 offset:4096
    v_mfma_f32_16x16x32_bf16 v[204:207], v[232:235], a[60:63], v[204:207]
    ds_read_b64_tr_b16 v[230:231], v3 offset:6144
    s_add_u32 s22, s22, 8192
    v_mfma_f32_16x16x32_bf16 v[208:211], v[232:235], a[132:135], v[208:211]
    s_sub_u32 s24, s22, s99
    s_min_u32 s22, s22, s24
    v_mfma_f32_16x16x32_bf16 v[212:215], v[232:235], a[204:207], v[212:215]
    buffer_load_dwordx4 v1, s[4:7], s16 offen lds
    v_mfma_f32_16x16x32_bf16 v[216:219], v[232:235], v[32:35], v[216:219]
    ds_read_b64_tr_b16 v[232:233], v3 offset:4104
    s_waitcnt lgkmcnt(3)
    v_mfma_f32_16x16x32_bf16 v[188:191], v[220:223], a[64:67], v[188:191]
    ds_read_b64_tr_b16 v[234:235], v3 offset:6152
    v_xor_b32 v3, s22, v7
    v_mfma_f32_16x16x32_bf16 v[192:195], v[220:223], a[136:139], v[192:195]
    buffer_load_dwordx4 v1, s[8:11], s16 offen offset:1024 lds
    v_mfma_f32_16x16x32_bf16 v[196:199], v[220:223], a[208:211], v[196:199]
    s_waitcnt vmcnt(13)
    s_barrier
    s_add_u32 s19, m0, 8192
    v_mfma_f32_16x16x32_bf16 v[200:203], v[220:223], v[36:39], v[200:203]
    ds_read_b64_tr_b16 v[220:221], v3 offset:0
    s_sub_u32 s21, s19, s99
    v_mfma_f32_16x16x32_bf16 v[204:207], v[224:227], a[64:67], v[204:207]
    ds_read_b64_tr_b16 v[222:223], v3 offset:2048
    s_min_u32 m0, s19, s21
    v_mfma_f32_16x16x32_bf16 v[208:211], v[224:227], a[136:139], v[208:211]
    s_add_u32 s16, s16, s17
    s_add_u32 s20, s16, s18
    s_min_u32 s16, s16, s20
    v_mfma_f32_16x16x32_bf16 v[212:215], v[224:227], a[208:211], v[212:215]
    v_mfma_f32_16x16x32_bf16 v[216:219], v[224:227], v[36:39], v[216:219]
    ds_read_b64_tr_b16 v[224:225], v3 offset:8
    s_waitcnt lgkmcnt(3)
    v_mfma_f32_16x16x32_bf16 v[188:191], v[228:231], a[68:71], v[188:191]
    ds_read_b64_tr_b16 v[226:227], v3 offset:2056
    v_mfma_f32_16x16x32_bf16 v[192:195], v[228:231], a[140:143], v[192:195]
    v_mfma_f32_16x16x32_bf16 v[196:199], v[228:231], a[212:215], v[196:199]
    v_mfma_f32_16x16x32_bf16 v[200:203], v[228:231], v[40:43], v[200:203]
    ds_read_b64_tr_b16 v[228:229], v3 offset:4096
    v_mfma_f32_16x16x32_bf16 v[204:207], v[232:235], a[68:71], v[204:207]
    ds_read_b64_tr_b16 v[230:231], v3 offset:6144
    s_nop 0
    v_cvt_pk_bf16_f32 v172, v188, v189
    v_mfma_f32_16x16x32_bf16 v[208:211], v[232:235], a[140:143], v[208:211]
    s_add_u32 s22, s22, 8192
    v_cvt_pk_bf16_f32 v173, v190, v191
    v_cvt_pk_bf16_f32 v176, v192, v193
    v_mfma_f32_16x16x32_bf16 v[212:215], v[232:235], a[212:215], v[212:215]
    s_sub_u32 s24, s22, s99
    s_min_u32 s22, s22, s24
    v_cvt_pk_bf16_f32 v177, v194, v195
    v_cvt_pk_bf16_f32 v180, v196, v197
    v_mfma_f32_16x16x32_bf16 v[216:219], v[232:235], v[40:43], v[216:219]
    ds_read_b64_tr_b16 v[232:233], v3 offset:4104
    s_waitcnt lgkmcnt(3)
    v_cvt_pk_bf16_f32 v181, v198, v199
    v_mfma_f32_16x16x32_bf16 v[188:191], v[220:223], a[0:3], 0
    ds_read_b64_tr_b16 v[234:235], v3 offset:6152
    v_cvt_pk_bf16_f32 v184, v200, v201
    v_xor_b32 v3, s22, v7
    v_mfma_f32_16x16x32_bf16 v[192:195], v[220:223], a[72:75], 0
    v_cvt_pk_bf16_f32 v185, v202, v203
    v_cvt_pk_bf16_f32 v174, v204, v205
    v_mfma_f32_16x16x32_bf16 v[196:199], v[220:223], a[144:147], 0
    v_cvt_pk_bf16_f32 v175, v206, v207
    v_cvt_pk_bf16_f32 v178, v208, v209
    v_mfma_f32_16x16x32_bf16 v[200:203], v[220:223], a[216:219], 0
    ds_read_b64_tr_b16 v[220:221], v3 offset:0
    v_cvt_pk_bf16_f32 v179, v210, v211
    v_mfma_f32_16x16x32_bf16 v[204:207], v[224:227], a[0:3], 0
    ds_read_b64_tr_b16 v[222:223], v3 offset:2048
    v_cvt_pk_bf16_f32 v182, v212, v213
    v_mfma_f32_16x16x32_bf16 v[208:211], v[224:227], a[72:75], 0
    s_add_u32 s22, s22, 8192
    v_cvt_pk_bf16_f32 v183, v214, v215
    v_cvt_pk_bf16_f32 v186, v216, v217
    v_mfma_f32_16x16x32_bf16 v[212:215], v[224:227], a[144:147], 0
    s_sub_u32 s24, s22, s99
    s_min_u32 s22, s22, s24
    v_cvt_pk_bf16_f32 v187, v218, v219
    v_mfma_f32_16x16x32_bf16 v[216:219], v[224:227], a[216:219], 0
    ds_read_b64_tr_b16 v[224:225], v3 offset:8
    s_waitcnt lgkmcnt(3)
    v_mfma_f32_16x16x32_bf16 v[188:191], v[228:231], a[4:7], v[188:191]
    ds_read_b64_tr_b16 v[226:227], v3 offset:2056
    v_mfma_f32_16x16x32_bf16 v[192:195], v[228:231], a[76:79], v[192:195]
    buffer_load_dwordx4 v1, s[4:7], s16 offen lds
    v_mfma_f32_16x16x32_bf16 v[196:199], v[228:231], a[148:151], v[196:199]
    v_mfma_f32_16x16x32_bf16 v[200:203], v[228:231], a[220:223], v[200:203]
    ds_read_b64_tr_b16 v[228:229], v3 offset:4096
    v_mfma_f32_16x16x32_bf16 v[204:207], v[232:235], a[4:7], v[204:207]
    ds_read_b64_tr_b16 v[230:231], v3 offset:6144
    v_mfma_f32_16x16x32_bf16 v[208:211], v[232:235], a[76:79], v[208:211]
    buffer_load_dwordx4 v1, s[8:11], s16 offen offset:1024 lds
    v_mfma_f32_16x16x32_bf16 v[212:215], v[232:235], a[148:151], v[212:215]
    s_add_u32 s19, m0, 8192
    s_sub_u32 s21, s19, s99
    s_min_u32 m0, s19, s21
    v_mfma_f32_16x16x32_bf16 v[216:219], v[232:235], a[220:223], v[216:219]
    ds_read_b64_tr_b16 v[232:233], v3 offset:4104
    s_waitcnt lgkmcnt(3)
    v_mfma_f32_16x16x32_bf16 v[188:191], v[220:223], a[8:11], v[188:191]
    ds_read_b64_tr_b16 v[234:235], v3 offset:6152
    v_xor_b32 v3, s22, v7
    v_mfma_f32_16x16x32_bf16 v[192:195], v[220:223], a[80:83], v[192:195]
    s_add_u32 s16, s16, s17
    s_add_u32 s20, s16, s18
    s_min_u32 s16, s16, s20
    v_mfma_f32_16x16x32_bf16 v[196:199], v[220:223], a[152:155], v[196:199]
    v_mfma_f32_16x16x32_bf16 v[200:203], v[220:223], a[224:227], v[200:203]
    ds_read_b64_tr_b16 v[220:221], v3 offset:0
    v_mfma_f32_16x16x32_bf16 v[204:207], v[224:227], a[8:11], v[204:207]
    ds_read_b64_tr_b16 v[222:223], v3 offset:2048
    s_add_u32 s22, s22, 8192
    v_mfma_f32_16x16x32_bf16 v[208:211], v[224:227], a[80:83], v[208:211]
    s_sub_u32 s24, s22, s99
    s_min_u32 s22, s22, s24
    v_mfma_f32_16x16x32_bf16 v[212:215], v[224:227], a[152:155], v[212:215]
    v_mfma_f32_16x16x32_bf16 v[216:219], v[224:227], a[224:227], v[216:219]
    ds_read_b64_tr_b16 v[224:225], v3 offset:8
    s_waitcnt lgkmcnt(3)
TF_Qp4e2:
    v_mfma_f32_16x16x32_bf16 v[188:191], v[228:231], a[12:15], v[188:191]
    ds_read_b64_tr_b16 v[226:227], v3 offset:2056
    v_mfma_f32_16x16x32_bf16 v[192:195], v[228:231], a[84:87], v[192:195]
    s_cmp_eq_u32 s25, 0
    s_cbranch_scc1 TF_SW9
TF_SW9r:
    v_mfma_f32_16x16x32_bf16 v[196:199], v[228:231], a[156:159], v[196:199]
    buffer_load_dwordx4 v1, s[4:7], s16 offen lds
    v_mfma_f32_16x16x32_bf16 v[200:203], v[228:231], a[228:231], v[200:203]
    ds_read_b64_tr_b16 v[228:229], v3 offset:4096
    v_mfma_f32_16x16x32_bf16 v[204:207], v[232:235], a[12:15], v[204:207]
    ds_read_b64_tr_b16 v[230:231], v3 offset:6144
    v_mfma_f32_16x16x32_bf16 v[208:211], v[232:235], a[84:87], v[208:211]
    buffer_load_dwordx4 v1, s[8:11], s16 offen offset:1024 lds
    v_mfma_f32_16x16x32_bf16 v[212:215], v[232:235], a[156:159], v[212:215]
    buffer_store_dwordx4 v[172:175], v9, s[12:15], s33 offen offset:0 sc1
    v_mfma_f32_16x16x32_bf16 v[216:219], v[232:235], a[228:231], v[216:219]
    ds_read_b64_tr_b16 v[232:233], v3 offset:4104
    s_waitcnt lgkmcnt(3)
    v_mfma_f32_16x16x32_bf16 v[188:191], v[220:223], a[16:19], v[188:191]
    ds_read_b64_tr_b16 v[234:235], v3 offset:6152
    v_xor_b32 v3, s22, v7
    v_mfma_f32_16x16x32_bf16 v[192:195], v[220:223], a[88:91], v[192:195]
    s_add_u32 s19, m0, 8192
    s_sub_u32 s21, s19, s99
    s_min_u32 m0, s19, s21
    v_mfma_f32_16x16x32_bf16 v[196:199], v[220:223], a[160:163], v[196:199]
    s_waitcnt vmcnt(9)
    s_barrier
    s_add_u32 s16, s16, s17
    v_mfma_f32_16x16x32_bf16 v[200:203], v[220:223], a[232:235], v[200:203]
    ds_read_b64_tr_b16 v[220:221], v3 offset:0
    s_add_u32 s20, s16, s18
    s_min_u32 s16, s16, s20
    v_mfma_f32_16x16x32_bf16 v[204:207], v[224:227], a[16:19], v[204:207]
    ds_read_b64_tr_b16 v[222:223], v3 offset:2048
    s_add_u32 s22, s22, 8192
    v_mfma_f32_16x16x32_bf16 v[208:211], v[224:227], a[88:91], v[208:211]
    s_sub_u32 s24, s22, s99
    s_min_u32 s22, s22, s24
    v_mfma_f32_16x16x32_bf16 v[212:215], v[224:227], a[160:163], v[212:215]
    buffer_load_dwordx4 v1, s[4:7], s16 offen lds
    v_mfma_f32_16x16x32_bf16 v[216:219], v[224:227], a[232:235], v[216:219]
    ds_read_b64_tr_b16 v[224:225], v3 offset:8
    s_waitcnt lgkmcnt(3)
    v_mfma_f32_16x16x32_bf16 v[188:191], v[228:231], a[20:23], v[188:191]
    ds_read_b64_tr_b16 v[226:227], v3 offset:2056
    v_mfma_f32_16x16x32_bf16 v[192:195], v[228:231], a[92:95], v[192:195]
    buffer_load_dwordx4 v1, s[8:11], s16 offen offset:1024 lds
    v_mfma_f32_16x16x32_bf16 v[196:199], v[228:231], a[164:167], v[196:199]
    s_add_u32 s19, m0, 8192
    s_sub_u32 s21, s19, s99
    s_min_u32 m0, s19, s21
    v_mfma_f32_16x16x32_bf16 v[200:203], v[228:231], a[236:239], v[200:203]
    ds_read_b64_tr_b16 v[228:229], v3 offset:4096
    s_add_u32 s16, s16, s17
    v_mfma_f32_16x16x32_bf16 v[204:207], v[232:235], a[20:23], v[204:207]
    ds_read_b64_tr_b16 v[230:231], v3 offset:6144
    s_add_u32 s20, s16, s18
    v_mfma_f32_16x16x32_bf16 v[208:211], v[232:235], a[92:95], v[208:211]
    buffer_store_dwordx4 v[176:179], v9, s[12:15], s33 offen offset:1024 sc1
    v_mfma_f32_16x16x32_bf16 v[212:215], v[232:235], a[164:167], v[212:215]
    s_min_u32 s16, s16, s20
    v_mfma_f32_16x16x32_bf16 v[216:219], v[232:235], a[236:239], v[216:219]
    ds_read_b64_tr_b16 v[232:233], v3 offset:4104
    s_waitcnt lgkmcnt(3)
    v_mfma_f32_16x16x32_bf16 v[188:191], v[220:223], a[24:27], v[188:191]
    ds_read_b64_tr_b16 v[234:235], v3 offset:6152
    v_xor_b32 v3, s22, v7
    v_mfma_f32_16x16x32_bf16 v[192:195], v[220:223], a[96:99], v[192:195]
    v_mfma_f32_16x16x32_bf16 v[196:199], v[220:223], a[168:171], v[196:199]
    v_mfma_f32_16x16x32_bf16 v[200:203], v[220:223], a[240:243], v[200:203]
    ds_read_b64_tr_b16 v[220:221], v3 offset:0
    v_mfma_f32_16x16x32_bf16 v[204:207], v[224:227], a[24:27], v[204:207]
    ds_read_b64_tr_b16 v[222:223], v3 offset:2048
    s_add_u32 s22, s22, 8192
    v_mfma_f32_16x16x32_bf16 v[208:211], v[224:227], a[96:99], v[208:211]
    s_sub_u32 s24, s22, s99
    s_min_u32 s22, s22, s24
    v_mfma_f32_16x16x32_bf16 v[212:215], v[224:227], a[168:171], v[212:215]
    buffer_load_dwordx4 v1, s[4:7], s16 offen lds
    v_mfma_f32_16x16x32_bf16 v[216:219], v[224:227], a[240:243], v[216:219]
    ds_read_b64_tr_b16 v[224:225], v3 offset:8
    s_waitcnt lgkmcnt(3)
    v_mfma_f32_16x16x32_bf16 v[188:191], v[228:231], a[28:31], v[188:191]
    ds_read_b64_tr_b16 v[226:227], v3 offset:2056
    v_mfma_f32_16x16x32_bf16 v[192:195], v[228:231], a[100:103], v[192:195]
    buffer_load_dwordx4 v1, s[8:11], s16 offen offset:1024 lds
    v_mfma_f32_16x16x32_bf16 v[196:199], v[228:231], a[172:175], v[196:199]
    s_add_u32 s19, m0, 8192
    s_sub_u32 s21, s19, s99
    s_min_u32 m0, s19, s21
    v_mfma_f32_16x16x32_bf16 v[200:203], v[228:231], a[244:247], v[200:203]
    ds_read_b64_tr_b16 v[228:229], v3 offset:4096
    s_add_u32 s16, s16, s17
    v_mfma_f32_16x16x32_bf16 v[204:207], v[232:235], a[28:31], v[204:207]
    ds_read_b64_tr_b16 v[230:231], v3 offset:6144
    s_add_u32 s20, s16, s18
    v_mfma_f32_16x16x32_bf16 v[208:211], v[232:235], a[100:103], v[208:211]
    buffer_store_dwordx4 v[180:183], v9, s[12:15], s33 offen offset:2048 sc1
    v_mfma_f32_16x16x32_bf16 v[212:215], v[232:235], a[172:175], v[212:215]
    s_min_u32 s16, s16, s20
    v_mfma_f32_16x16x32_bf16 v[216:219], v[232:235], a[244:247], v[216:219]
    ds_read_b64_tr_b16 v[232:233], v3 offset:4104
    s_waitcnt lgkmcnt(3)
    v_mfma_f32_16x16x32_bf16 v[188:191], v[220:223], a[32:35], v[188:191]
    ds_read_b64_tr_b16 v[234:235], v3 offset:6152
    v_xor_b32 v3, s22, v7
    v_mfma_f32_16x16x32_bf16 v[192:195], v[220:223], a[104:107], v[192:195]
    v_mfma_f32_16x16x32_bf16 v[196:199], v[220:223], a[176:179], v[196:199]
    buffer_load_dwordx4 v1, s[4:7], s16 offen lds
    v_mfma_f32_16x16x32_bf16 v[200:203], v[220:223], a[248:251], v[200:203]
    ds_read_b64_tr_b16 v[220:221], v3 offset:0
    v_mfma_f32_16x16x32_bf16 v[204:207], v[224:227], a[32:35], v[204:207]
    ds_read_b64_tr_b16 v[222:223], v3 offset:2048
    s_add_u32 s22, s22, 8192
    v_mfma_f32_16x16x32_bf16 v[208:211], v[224:227], a[104:107], v[208:211]
    s_sub_u32 s24, s22, s99
    s_min_u32 s22, s22, s24
    v_mfma_f32_16x16x32_bf16 v[212:215], v[224:227], a[176:179], v[212:215]
    buffer_load_dwordx4 v1, s[8:11], s16 offen offset:1024 lds
    v_mfma_f32_16x16x32_bf16 v[216:219], v[224:227], a[248:251], v[216:219]
    ds_read_b64_tr_b16 v[224:225], v3 offset:8
    s_waitcnt lgkmcnt(3)
    v_mfma_f32_16x16x32_bf16 v[188:191], v[228:231], a[36:39], v[188:191]
    ds_read_b64_tr_b16 v[226:227], v3 offset:2056
    s_add_u32 s19, m0, 8192
    v_mfma_f32_16x16x32_bf16 v[192:195], v[228:231], a[108:111], v[192:195]
    buffer_load_dword v254, v8, s[72:75], s71 offen
    v_mfma_f32_16x16x32_bf16 v[196:199], v[228:231], a[180:183], v[196:199]
    s_add_u32 s71, s71, 128
    s_sub_u32 s21, s19, s99
    s_min_u32 m0, s19, s21
    v_mfma_f32_16x16x32_bf16 v[200:203], v[228:231], a[252:255], v[200:203]
    ds_read_b64_tr_b16 v[228:229], v3 offset:4096
    s_add_u32 s16, s16, s17
    v_mfma_f32_16x16x32_bf16 v[204:207], v[232:235], a[36:39], v[204:207]
    ds_read_b64_tr_b16 v[230:231], v3 offset:6144
    s_add_u32 s20, s16, s18
    v_mfma_f32_16x16x32_bf16 v[208:211], v[232:235], a[108:111], v[208:211]
    buffer_store_dwordx4 v[184:187], v9, s[12:15], s33 offen offset:3072 sc1
    v_mfma_f32_16x16x32_bf16 v[212:215], v[232:235], a[180:183], v[212:215]
    s_min_u32 s16, s16, s20
    s_mov_b32 s33, s32
    s_add_u32 s32, s32, 4096
    v_mfma_f32_16x16x32_bf16 v[216:219], v[232:235], a[252:255], v[216:219]
    ds_read_b64_tr_b16 v[232:233], v3 offset:4104
    s_waitcnt lgkmcnt(3)
    v_mfma_f32_16x16x32_bf16 v[188:191], v[220:223], a[40:43], v[188:191]
    ds_read_b64_tr_b16 v[234:235], v3 offset:6152
    v_xor_b32 v3, s22, v7
    v_mfma_f32_16x16x32_bf16 v[192:195], v[220:223], a[112:115], v[192:195]
    buffer_load_dwordx4 v1, s[4:7], s16 offen lds
    v_mfma_f32_16x16x32_bf16 v[196:199], v[220:223], a[184:187], v[196:199]
    s_waitcnt vmcnt(14)
    s_barrier
    v_mfma_f32_16x16x32_bf16 v[200:203], v[220:223], v[12:15], v[200:203]
    ds_read_b64_tr_b16 v[220:221], v3 offset:0
    v_mfma_f32_16x16x32_bf16 v[204:207], v[224:227], a[40:43], v[204:207]
    ds_read_b64_tr_b16 v[222:223], v3 offset:2048
    s_add_u32 s22, s22, 8192
    v_mfma_f32_16x16x32_bf16 v[208:211], v[224:227], a[112:115], v[208:211]
    s_sub_u32 s24, s22, s99
    s_min_u32 s22, s22, s24
    v_mfma_f32_16x16x32_bf16 v[212:215], v[224:227], a[184:187], v[212:215]
    buffer_load_dwordx4 v1, s[8:11], s16 offen offset:1024 lds
    v_mfma_f32_16x16x32_bf16 v[216:219], v[224:227], v[12:15], v[216:219]
    ds_read_b64_tr_b16 v[224:225], v3 offset:8
    s_waitcnt lgkmcnt(3)
    v_mfma_f32_16x16x32_bf16 v[188:191], v[228:231], a[44:47], v[188:191]
    ds_read_b64_tr_b16 v[226:227], v3 offset:2056
    s_add_u32 s19, m0, 8192
    v_mfma_f32_16x16x32_bf16 v[192:195], v[228:231], a[116:119], v[192:195]
    s_sub_u32 s21, s19, s99
    s_min_u32 m0, s19, s21
    s_add_u32 s16, s16, s17
    v_mfma_f32_16x16x32_bf16 v[196:199], v[228:231], a[188:191], v[196:199]
    s_add_u32 s20, s16, s18
    s_min_u32 s16, s16, s20
    v_mfma_f32_16x16x32_bf16 v[200:203], v[228:231], v[16:19], v[200:203]
    ds_read_b64_tr_b16 v[228:229], v3 offset:4096
    v_mfma_f32_16x16x32_bf16 v[204:207], v[232:235], a[44:47], v[204:207]
    ds_read_b64_tr_b16 v[230:231], v3 offset:6144
    v_mfma_f32_16x16x32_bf16 v[208:211], v[232:235], a[116:119], v[208:211]
    v_mfma_f32_16x16x32_bf16 v[212:215], v[232:235], a[188:191], v[212:215]
    v_mfma_f32_16x16x32_bf16 v[216:219], v[232:235], v[16:19], v[216:219]
    ds_read_b64_tr_b16 v[232:233], v3 offset:4104
    s_waitcnt lgkmcnt(3)
    v_mfma_f32_16x16x32_bf16 v[188:191], v[220:223], a[48:51], v[188:191]
    ds_read_b64_tr_b16 v[234:235], v3 offset:6152
    v_xor_b32 v3, s22, v7
    v_mfma_f32_16x16x32_bf16 v[192:195], v[220:223], a[120:123], v[192:195]
    buffer_load_dwordx4 v1, s[4:7], s16 offen lds
    v_mfma_f32_16x16x32_bf16 v[196:199], v[220:223], a[192:195], v[196:199]
    v_mfma_f32_16x16x32_bf16 v[200:203], v[220:223], v[20:23], v[200:203]
    ds_read_b64_tr_b16 v[220:221], v3 offset:0
    v_mfma_f32_16x16x32_bf16 v[204:207], v[224:227], a[48:51], v[204:207]
    ds_read_b64_tr_b16 v[222:223], v3 offset:2048
    s_add_u32 s22, s22, 8192
    v_mfma_f32_16x16x32_bf16 v[208:211], v[224:227], a[120:123], v[208:211]
    s_sub_u32 s24, s22, s99
    s_min_u32 s22, s22, s24
    v_mfma_f32_16x16x32_bf16 v[212:215], v[224:227], a[192:195], v[212:215]
    buffer_load_dwordx4 v1, s[8:11], s16 offen offset:1024 lds
    v_mfma_f32_16x16x32_bf16 v[216:219], v[224:227], v[20:23], v[216:219]
    ds_read_b64_tr_b16 v[224:225], v3 offset:8
    s_waitcnt lgkmcnt(3)
    v_mfma_f32_16x16x32_bf16 v[188:191], v[228:231], a[52:55], v[188:191]
    ds_read_b64_tr_b16 v[226:227], v3 offset:2056
    s_add_u32 s19, m0, 8192
    v_mfma_f32_16x16x32_bf16 v[192:195], v[228:231], a[124:127], v[192:195]
    s_sub_u32 s21, s19, s99
    s_min_u32 m0, s19, s21
    s_add_u32 s16, s16, s17
    v_mfma_f32_16x16x32_bf16 v[196:199], v[228:231], a[196:199], v[196:199]
    s_add_u32 s20, s16, s18
    s_min_u32 s16, s16, s20
    v_mfma_f32_16x16x32_bf16 v[200:203], v[228:231], v[24:27], v[200:203]
    ds_read_b64_tr_b16 v[228:229], v3 offset:4096
    v_mfma_f32_16x16x32_bf16 v[204:207], v[232:235], a[52:55], v[204:207]
    ds_read_b64_tr_b16 v[230:231], v3 offset:6144
    v_mfma_f32_16x16x32_bf16 v[208:211], v[232:235], a[124:127], v[208:211]
    v_mfma_f32_16x16x32_bf16 v[212:215], v[232:235], a[196:199], v[212:215]
    buffer_load_dwordx4 v1, s[4:7], s16 offen lds
    v_mfma_f32_16x16x32_bf16 v[216:219], v[232:235], v[24:27], v[216:219]
    ds_read_b64_tr_b16 v[232:233], v3 offset:4104
    s_waitcnt lgkmcnt(3)
    v_mfma_f32_16x16x32_bf16 v[188:191], v[220:223], a[56:59], v[188:191]
    ds_read_b64_tr_b16 v[234:235], v3 offset:6152
    v_xor_b32 v3, s22, v7
    v_mfma_f32_16x16x32_bf16 v[192:195], v[220:223], a[128:131], v[192:195]
    buffer_load_dwordx4 v1, s[8:11], s16 offen offset:1024 lds
    v_mfma_f32_16x16x32_bf16 v[196:199], v[220:223], a[200:203], v[196:199]
    s_add_u32 s19, m0, 8192
    s_sub_u32 s21, s19, s99
    s_min_u32 m0, s19, s21
    v_mfma_f32_16x16x32_bf16 v[200:203], v[220:223], v[28:31], v[200:203]
    ds_read_b64_tr_b16 v[220:221], v3 offset:0
    s_add_u32 s16, s16, s17
    v_mfma_f32_16x16x32_bf16 v[204:207], v[224:227], a[56:59], v[204:207]
    ds_read_b64_tr_b16 v[222:223], v3 offset:2048
    s_add_u32 s20, s16, s18
    v_mfma_f32_16x16x32_bf16 v[208:211], v[224:227], a[128:131], v[208:211]
    s_min_u32 s16, s16, s20
    v_mfma_f32_16x16x32_bf16 v[212:215], v[224:227], a[200:203], v[212:215]
    v_mfma_f32_16x16x32_bf16 v[216:219], v[224:227], v[28:31], v[216:219]
    ds_read_b64_tr_b16 v[224:225], v3 offset:8
    s_waitcnt lgkmcnt(3)
    v_mfma_f32_16x16x32_bf16 v[188:191], v[228:231], a[60:63], v[188:191]
    ds_read_b64_tr_b16 v[226:227], v3 offset:2056
    v_mfma_f32_16x16x32_bf16 v[192:195], v[228:231], a[132:135], v[192:195]
    v_mfma_f32_16x16x32_bf16 v[196:199], v[228:231], a[204:207], v[196:199]
    s_sub_u32 s25, s25, 1
    s_cbranch_scc0 TF_Qp41
    v_mfma_f32_16x16x32_bf16 v[200:203], v[228:231], v[32:35], v[200:203]
    ds_read_b64_tr_b16 v[228:229], v3 offset:4096
    s_mov_b64 s[64:65], s[92:93]
    v_mfma_f32_16x16x32_bf16 v[204:207], v[232:235], a[60:63], v[204:207]
    ds_read_b64_tr_b16 v[230:231], v3 offset:6144
    s_mov_b32 s66, 256
    v_mfma_f32_16x16x32_bf16 v[208:211], v[232:235], a[132:135], v[208:211]
    s_mov_b32 s67, 0x00020000
    s_lshl_b32 s95, s29, 2
    v_mov_b32 v64, 1
    v_mfma_f32_16x16x32_bf16 v[212:215], v[232:235], a[204:207], v[212:215]
    s_mov_b64 exec, s[38:39]
    buffer_load_dword v64, off, s[64:67], s95 sc1
    s_mov_b64 exec, -1
    v_mfma_f32_16x16x32_bf16 v[216:219], v[232:235], v[32:35], v[216:219]
    ds_read_b64_tr_b16 v[232:233], v3 offset:4104
    s_lshl_b32 s22, s27, 5
    s_waitcnt lgkmcnt(5)
    v_mfma_f32_16x16x32_bf16 v[188:191], v[220:223], a[64:67], v[188:191]
    ds_read_b64_tr_b16 v[234:235], v3 offset:6152
    s_add_u32 s22, s22, 16384
    v_mfma_f32_16x16x32_bf16 v[192:195], v[220:223], a[136:139], v[192:195]
    buffer_load_dwordx4 v1, s[4:7], s16 offen lds
    v_mfma_f32_16x16x32_bf16 v[196:199], v[220:223], a[208:211], v[196:199]
    s_add_u32 s22, s22, 8192
    s_sub_u32 s24, s22, s99
    s_min_u32 s22, s22, s24
    v_mfma_f32_16x16x32_bf16 v[200:203], v[220:223], v[36:39], v[200:203]
    s_waitcnt vmcnt(12)
    s_barrier
    v_xor_b32 v3, s22, v6
    s_waitcnt lgkmcnt(4)
    v_mfma_f32_16x16x32_bf16 v[204:207], v[224:227], a[64:67], v[204:207]
    ds_read_b64_tr_b16 v[220:221], v3 offset:0
    s_add_u32 s22, s22, 8192
    v_mfma_f32_16x16x32_bf16 v[208:211], v[224:227], a[136:139], v[208:211]
    ds_read_b64_tr_b16 v[222:223], v3 offset:2048
    s_sub_u32 s24, s22, s99
    v_mfma_f32_16x16x32_bf16 v[212:215], v[224:227], a[208:211], v[212:215]
    buffer_load_dwordx4 v1, s[8:11], s16 offen offset:1024 lds
    v_mfma_f32_16x16x32_bf16 v[216:219], v[224:227], v[36:39], v[216:219]
    ds_read_b64_tr_b16 v[224:225], v3 offset:1024
    s_min_u32 s22, s22, s24
    s_waitcnt lgkmcnt(5)
    v_mfma_f32_16x16x32_bf16 v[188:191], v[228:231], a[68:71], v[188:191]
    ds_read_b64_tr_b16 v[226:227], v3 offset:3072
    s_add_u32 s19, m0, 8192
    v_mfma_f32_16x16x32_bf16 v[192:195], v[228:231], a[140:143], v[192:195]
    s_add_u32 s16, s16, s17
    s_sub_u32 s21, s19, s99
    s_add_u32 s20, s16, s18
    v_mfma_f32_16x16x32_bf16 v[196:199], v[228:231], a[212:215], v[196:199]
    s_min_u32 m0, s19, s21
    s_min_u32 s16, s16, s20
    v_cvt_pk_bf16_f32 v172, v188, v189
    v_mfma_f32_16x16x32_bf16 v[200:203], v[228:231], v[40:43], v[200:203]
    ds_read_b64_tr_b16 v[228:229], v3 offset:4096
    v_cvt_pk_bf16_f32 v173, v190, v191
    s_waitcnt lgkmcnt(5)
    v_mfma_f32_16x16x32_bf16 v[204:207], v[232:235], a[68:71], v[204:207]
    ds_read_b64_tr_b16 v[230:231], v3 offset:6144
    v_cvt_pk_bf16_f32 v176, v192, v193
    v_mfma_f32_16x16x32_bf16 v[208:211], v[232:235], a[140:143], v[208:211]
    s_mov_b32 s96, s56
    v_cvt_pk_bf16_f32 v177, v194, v195
    v_cvt_pk_bf16_f32 v180, v196, v197
    v_mfma_f32_16x16x32_bf16 v[212:215], v[232:235], a[212:215], v[212:215]
    s_mul_i32 s96, s96, 1152
    v_cvt_pk_bf16_f32 v181, v198, v199
    v_cvt_pk_bf16_f32 v184, v200, v201
    v_mfma_f32_16x16x32_bf16 v[216:219], v[232:235], v[40:43], v[216:219]
    ds_read_b64_tr_b16 v[232:233], v3 offset:5120
    v_cvt_pk_bf16_f32 v185, v202, v203
    s_waitcnt lgkmcnt(5)
    v_mfma_f32_16x16x32_bf16 v[188:191], v[220:223], a[0:3], 0
    ds_read_b64_tr_b16 v[234:235], v3 offset:7168
    v_cvt_pk_bf16_f32 v174, v204, v205
    v_mfma_f32_16x16x32_bf16 v[192:195], v[220:223], a[72:75], 0
    s_lshl_b32 s98, s29, 2
    v_cvt_pk_bf16_f32 v175, v206, v207
    v_cvt_pk_bf16_f32 v178, v208, v209
    v_mfma_f32_16x16x32_bf16 v[196:199], v[220:223], a[144:147], 0
    buffer_store_dwordx4 v[172:175], v9, s[12:15], s33 offen offset:0 sc1
    v_mfma_f32_16x16x32_bf16 v[200:203], v[220:223], a[216:219], 0
    s_add_u32 s19, m0, 8192
    v_cvt_pk_bf16_f32 v179, v210, v211
    v_cvt_pk_bf16_f32 v182, v212, v213
    s_waitcnt lgkmcnt(4)
    v_mfma_f32_16x16x32_bf16 v[204:207], v[224:227], a[0:3], 0
    buffer_store_dwordx4 v[176:179], v9, s[12:15], s33 offen offset:1024 sc1
    v_mfma_f32_16x16x32_bf16 v[208:211], v[224:227], a[72:75], 0
    s_add_u32 s96, s50, s96
    s_addc_u32 s97, s51, 0
    v_cvt_pk_bf16_f32 v183, v214, v215
    v_mfma_f32_16x16x32_bf16 v[212:215], v[224:227], a[144:147], 0
    buffer_store_dwordx4 v[180:183], v9, s[12:15], s33 offen offset:2048 sc1
    v_xor_b32 v3, s22, v6
    v_cvt_pk_bf16_f32 v186, v216, v217
    v_cvt_pk_bf16_f32 v187, v218, v219
    v_mfma_f32_16x16x32_bf16 v[216:219], v[224:227], a[216:219], 0
    ds_read_b64_tr_b16 v[220:221], v3 offset:0
    ds_read_b64_tr_b16 v[222:223], v3 offset:2048
    s_waitcnt lgkmcnt(4)
    v_mfma_f32_16x16x32_bf16 v[188:191], v[228:231], a[4:7], v[188:191]
    ds_read_b64_tr_b16 v[224:225], v3 offset:1024
    s_add_u32 s22, s22, 8192
    v_mfma_f32_16x16x32_bf16 v[192:195], v[228:231], a[76:79], v[192:195]
    ds_read_b64_tr_b16 v[226:227], v3 offset:3072
    s_sub_u32 s24, s22, s99
    v_mfma_f32_16x16x32_bf16 v[196:199], v[228:231], a[148:151], v[196:199]
    buffer_store_dwordx4 v[184:187], v9, s[12:15], s33 offen offset:3072 sc1
    v_mfma_f32_16x16x32_bf16 v[200:203], v[228:231], a[220:223], v[200:203]
    buffer_load_dwordx4 v1, s[4:7], s16 offen lds
    s_waitcnt lgkmcnt(4)
    v_mfma_f32_16x16x32_bf16 v[204:207], v[232:235], a[4:7], v[204:207]
    buffer_load_dwordx4 v1, s[8:11], s16 offen offset:1024 lds
    v_mfma_f32_16x16x32_bf16 v[208:211], v[232:235], a[76:79], v[208:211]
    s_min_u32 s22, s22, s24
    ds_read_b64_tr_b16 v[228:229], v3 offset:4096
    v_mfma_f32_16x16x32_bf16 v[212:215], v[232:235], a[148:151], v[212:215]
    ds_read_b64_tr_b16 v[230:231], v3 offset:6144
    s_add_u32 s16, s16, s17
    v_mfma_f32_16x16x32_bf16 v[216:219], v[232:235], a[220:223], v[216:219]
    ds_read_b64_tr_b16 v[232:233], v3 offset:5120
    ds_read_b64_tr_b16 v[234:235], v3 offset:7168
    v_xor_b32 v3, s22, v6
    s_add_u32 s22, s22, 8192
    s_waitcnt lgkmcnt(6)
    v_mfma_f32_16x16x32_bf16 v[188:191], v[220:223], a[8:11], v[188:191]
    s_add_u32 s98, s98, s26
    v_lshrrev_b32 v253, 2, v0
    s_sub_u32 s21, s19, s99
    v_mfma_f32_16x16x32_bf16 v[192:195], v[220:223], a[80:83], v[192:195]
    s_add_u32 s20, s16, s18
    s_sub_u32 s24, s22, s99
    s_mov_b32 s76, s96
    v_mfma_f32_16x16x32_bf16 v[196:199], v[220:223], a[152:155], v[196:199]
    s_mov_b32 s77, s97
    s_mov_b32 s78, 663552
    s_mov_b32 s79, 0x00020000
    v_mfma_f32_16x16x32_bf16 v[200:203], v[220:223], a[224:227], v[200:203]
    ds_read_b64_tr_b16 v[220:221], v3 offset:0
    s_mul_i32 s80, s98, 2048
    s_waitcnt lgkmcnt(5)
    v_mfma_f32_16x16x32_bf16 v[204:207], v[224:227], a[8:11], v[204:207]
    ds_read_b64_tr_b16 v[222:223], v3 offset:2048
    v_lshlrev_b32 v253, 7, v253
    v_mfma_f32_16x16x32_bf16 v[208:211], v[224:227], a[80:83], v[208:211]
    s_mov_b32 s31, 0
    s_mov_b32 s36, -16
    s_mov_b32 s55, 0xf0000000
    v_mfma_f32_16x16x32_bf16 v[212:215], v[224:227], a[152:155], v[212:215]
    s_min_u32 s16, s16, s20
    s_min_u32 s22, s22, s24
    s_min_u32 m0, s19, s21
    v_mfma_f32_16x16x32_bf16 v[216:219], v[224:227], a[224:227], v[216:219]
    ds_read_b64_tr_b16 v[224:225], v3 offset:1024
    s_waitcnt lgkmcnt(3)
    s_waitcnt vmcnt(8)
    v_readfirstlane_b32 s34, v64
    s_nop 0
    s_cmp_eq_u32 s34, 0
    s_cbranch_scc1 TF_RP3
TF_RB4:
    s_mov_b32 s25, 8
    s_branch TF_F1e6
TF_SW10:
    s_mov_b32 s59, s56
    s_lshl_b32 s60, s26, 4
    s_add_u32 s59, s59, s60
    s_mul_i32 s59, s59, 1152
    s_add_u32 s4, s50, s59
    s_addc_u32 s5, s51, 0
    s_sub_u32 s6, 5308416, s59
    s_sub_u32 s8, s4, 960
    s_subb_u32 s9, s5, 0
    s_add_u32 s10, s6, 960
    s_mul_i32 s60, s27, 36864
    s_add_u32 s8, s8, 18432
    s_addc_u32 s9, s9, 0
    s_sub_u32 s8, s8, s60
    s_subb_u32 s9, s9, 0
    s_sub_u32 s10, s10, 18432
    s_add_u32 s10, s10, s60
    s_mov_b32 s16, 0
    s_mov_b32 s17, 73728
    s_mov_b32 s18, 4294303872
    v_lshrrev_b32 v2, 2, v0
    v_mul_u32_u24 v2, 1152, v2
    v_and_or_b32 v1, v7, 48, v2
    s_branch TF_SW10r
.p2align 3
TF_F15:
    v_mfma_f32_16x16x32_bf16 v[200:203], v[228:231], v[32:35], v[200:203]
    ds_read_b64_tr_b16 v[228:229], v3 offset:4096
    v_mfma_f32_16x16x32_bf16 v[204:207], v[232:235], a[60:63], v[204:207]
    ds_read_b64_tr_b16 v[230:231], v3 offset:6144
    s_add_u32 s22, s22, 8192
    v_mfma_f32_16x16x32_bf16 v[208:211], v[232:235], a[132:135], v[208:211]
    s_sub_u32 s24, s22, s99
    s_min_u32 s22, s22, s24
    v_mfma_f32_16x16x32_bf16 v[212:215], v[232:235], a[204:207], v[212:215]
    buffer_load_dwordx4 v1, s[4:7], s16 offen lds
    v_mfma_f32_16x16x32_bf16 v[216:219], v[232:235], v[32:35], v[216:219]
    ds_read_b64_tr_b16 v[232:233], v3 offset:5120
    s_waitcnt lgkmcnt(3)
    v_mfma_f32_16x16x32_bf16 v[188:191], v[220:223], a[64:67], v[188:191]
    ds_read_b64_tr_b16 v[234:235], v3 offset:7168
    v_xor_b32 v3, s22, v6
    v_mfma_f32_16x16x32_bf16 v[192:195], v[220:223], a[136:139], v[192:195]
    buffer_load_dwordx4 v1, s[8:11], s16 offen offset:1024 lds
    v_mfma_f32_16x16x32_bf16 v[196:199], v[220:223], a[208:211], v[196:199]
    s_waitcnt vmcnt(12)
    s_barrier
    s_add_u32 s19, m0, 8192
    v_mfma_f32_16x16x32_bf16 v[200:203], v[220:223], v[36:39], v[200:203]
    ds_read_b64_tr_b16 v[220:221], v3 offset:0
    s_sub_u32 s21, s19, s99
    v_mfma_f32_16x16x32_bf16 v[204:207], v[224:227], a[64:67], v[204:207]
    ds_read_b64_tr_b16 v[222:223], v3 offset:2048
    s_add_u32 s16, s16, s17
    v_mfma_f32_16x16x32_bf16 v[208:211], v[224:227], a[136:139], v[208:211]
    s_add_u32 s20, s16, s18
    s_min_u32 s16, s16, s20
    v_mfma_f32_16x16x32_bf16 v[212:215], v[224:227], a[208:211], v[212:215]
    v_mfma_f32_16x16x32_bf16 v[216:219], v[224:227], v[36:39], v[216:219]
    ds_read_b64_tr_b16 v[224:225], v3 offset:1024
    s_waitcnt lgkmcnt(3)
    v_mfma_f32_16x16x32_bf16 v[188:191], v[228:231], a[68:71], v[188:191]
    ds_read_b64_tr_b16 v[226:227], v3 offset:3072
    v_mfma_f32_16x16x32_bf16 v[192:195], v[228:231], a[140:143], v[192:195]
    s_min_u32 m0, s19, s21
    v_mfma_f32_16x16x32_bf16 v[196:199], v[228:231], a[212:215], v[196:199]
    v_mfma_f32_16x16x32_bf16 v[200:203], v[228:231], v[40:43], v[200:203]
    ds_read_b64_tr_b16 v[228:229], v3 offset:4096
    v_mfma_f32_16x16x32_bf16 v[204:207], v[232:235], a[68:71], v[204:207]
    ds_read_b64_tr_b16 v[230:231], v3 offset:6144
    v_cvt_pk_bf16_f32 v236, v188, v189
    v_mfma_f32_16x16x32_bf16 v[208:211], v[232:235], a[140:143], v[208:211]
    s_add_u32 s22, s22, 8192
    v_cvt_pk_bf16_f32 v237, v190, v191
    v_cvt_pk_bf16_f32 v240, v192, v193
    v_mfma_f32_16x16x32_bf16 v[212:215], v[232:235], a[212:215], v[212:215]
    s_sub_u32 s24, s22, s99
    s_min_u32 s22, s22, s24
    v_cvt_pk_bf16_f32 v241, v194, v195
    v_cvt_pk_bf16_f32 v244, v196, v197
    v_mfma_f32_16x16x32_bf16 v[216:219], v[232:235], v[40:43], v[216:219]
    ds_read_b64_tr_b16 v[232:233], v3 offset:5120
    s_waitcnt lgkmcnt(3)
    v_cvt_pk_bf16_f32 v245, v198, v199
    v_mfma_f32_16x16x32_bf16 v[188:191], v[220:223], a[0:3], 0
    ds_read_b64_tr_b16 v[234:235], v3 offset:7168
    v_cvt_pk_bf16_f32 v248, v200, v201
    v_xor_b32 v3, s22, v6
    v_mfma_f32_16x16x32_bf16 v[192:195], v[220:223], a[72:75], 0
    v_cvt_pk_bf16_f32 v249, v202, v203
    v_cvt_pk_bf16_f32 v238, v204, v205
    v_mfma_f32_16x16x32_bf16 v[196:199], v[220:223], a[144:147], 0
    v_cvt_pk_bf16_f32 v239, v206, v207
    v_cvt_pk_bf16_f32 v242, v208, v209
    v_mfma_f32_16x16x32_bf16 v[200:203], v[220:223], a[216:219], 0
    ds_read_b64_tr_b16 v[220:221], v3 offset:0
    v_cvt_pk_bf16_f32 v243, v210, v211
    v_mfma_f32_16x16x32_bf16 v[204:207], v[224:227], a[0:3], 0
    ds_read_b64_tr_b16 v[222:223], v3 offset:2048
    v_cvt_pk_bf16_f32 v246, v212, v213
    v_mfma_f32_16x16x32_bf16 v[208:211], v[224:227], a[72:75], 0
    s_add_u32 s22, s22, 8192
    v_cvt_pk_bf16_f32 v247, v214, v215
    v_cvt_pk_bf16_f32 v250, v216, v217
    v_mfma_f32_16x16x32_bf16 v[212:215], v[224:227], a[144:147], 0
    s_sub_u32 s24, s22, s99
    s_min_u32 s22, s22, s24
    v_cvt_pk_bf16_f32 v251, v218, v219
    v_mfma_f32_16x16x32_bf16 v[216:219], v[224:227], a[216:219], 0
    ds_read_b64_tr_b16 v[224:225], v3 offset:1024
    s_waitcnt lgkmcnt(3)
    v_mfma_f32_16x16x32_bf16 v[188:191], v[228:231], a[4:7], v[188:191]
    ds_read_b64_tr_b16 v[226:227], v3 offset:3072
    v_pk_max_i16 v236, v236, 0
    v_mfma_f32_16x16x32_bf16 v[192:195], v[228:231], a[76:79], v[192:195]
    buffer_load_dwordx4 v1, s[4:7], s16 offen lds
    v_mfma_f32_16x16x32_bf16 v[196:199], v[228:231], a[148:151], v[196:199]
    v_mfma_f32_16x16x32_bf16 v[200:203], v[228:231], a[220:223], v[200:203]
    ds_read_b64_tr_b16 v[228:229], v3 offset:4096
    v_pk_max_i16 v237, v237, 0
    v_mfma_f32_16x16x32_bf16 v[204:207], v[232:235], a[4:7], v[204:207]
    ds_read_b64_tr_b16 v[230:231], v3 offset:6144
    v_pk_max_i16 v238, v238, 0
    v_mfma_f32_16x16x32_bf16 v[208:211], v[232:235], a[76:79], v[208:211]
    buffer_load_dwordx4 v1, s[8:11], s16 offen offset:1024 lds
    v_mfma_f32_16x16x32_bf16 v[212:215], v[232:235], a[148:151], v[212:215]
    s_add_u32 s19, m0, 8192
    s_sub_u32 s21, s19, s99
    s_add_u32 s16, s16, s17
    v_mfma_f32_16x16x32_bf16 v[216:219], v[232:235], a[220:223], v[216:219]
    ds_read_b64_tr_b16 v[232:233], v3 offset:5120
    s_waitcnt lgkmcnt(3)
    v_mfma_f32_16x16x32_bf16 v[188:191], v[220:223], a[8:11], v[188:191]
    ds_read_b64_tr_b16 v[234:235], v3 offset:7168
    v_xor_b32 v3, s22, v6
    v_mfma_f32_16x16x32_bf16 v[192:195], v[220:223], a[80:83], v[192:195]
    s_add_u32 s20, s16, s18
    s_min_u32 s16, s16, s20
    v_pk_max_i16 v239, v239, 0
    v_mfma_f32_16x16x32_bf16 v[196:199], v[220:223], a[152:155], v[196:199]
    v_mfma_f32_16x16x32_bf16 v[200:203], v[220:223], a[224:227], v[200:203]
    ds_read_b64_tr_b16 v[220:221], v3 offset:0
    v_pk_max_i16 v240, v240, 0
    v_mfma_f32_16x16x32_bf16 v[204:207], v[224:227], a[8:11], v[204:207]
    ds_read_b64_tr_b16 v[222:223], v3 offset:2048
    s_add_u32 s22, s22, 8192
    v_mfma_f32_16x16x32_bf16 v[208:211], v[224:227], a[80:83], v[208:211]
    s_sub_u32 s24, s22, s99
    s_min_u32 s22, s22, s24
    s_min_u32 m0, s19, s21
    v_mfma_f32_16x16x32_bf16 v[212:215], v[224:227], a[152:155], v[212:215]
    v_mfma_f32_16x16x32_bf16 v[216:219], v[224:227], a[224:227], v[216:219]
    ds_read_b64_tr_b16 v[224:225], v3 offset:1024
    s_waitcnt lgkmcnt(3)
TF_F1e6:
    v_mfma_f32_16x16x32_bf16 v[188:191], v[228:231], a[12:15], v[188:191]
    ds_read_b64_tr_b16 v[226:227], v3 offset:3072
    v_pk_max_i16 v241, v241, 0
    v_mfma_f32_16x16x32_bf16 v[192:195], v[228:231], a[84:87], v[192:195]
    s_cmp_eq_u32 s25, 0
    s_cbranch_scc1 TF_SW10
TF_SW10r:
    v_mfma_f32_16x16x32_bf16 v[196:199], v[228:231], a[156:159], v[196:199]
    buffer_load_dwordx4 v1, s[4:7], s16 offen lds
    v_mfma_f32_16x16x32_bf16 v[200:203], v[228:231], a[228:231], v[200:203]
    ds_read_b64_tr_b16 v[228:229], v3 offset:4096
    v_pk_max_i16 v242, v242, 0
    v_mfma_f32_16x16x32_bf16 v[204:207], v[232:235], a[12:15], v[204:207]
    ds_read_b64_tr_b16 v[230:231], v3 offset:6144
    v_pk_max_i16 v243, v243, 0
    v_mfma_f32_16x16x32_bf16 v[208:211], v[232:235], a[84:87], v[208:211]
    buffer_load_dwordx4 v1, s[8:11], s16 offen offset:1024 lds
    v_mfma_f32_16x16x32_bf16 v[212:215], v[232:235], a[156:159], v[212:215]
    s_add_u32 s19, m0, 8192
    s_sub_u32 s21, s19, s99
    s_add_u32 s16, s16, s17
    v_mfma_f32_16x16x32_bf16 v[216:219], v[232:235], a[228:231], v[216:219]
    ds_read_b64_tr_b16 v[232:233], v3 offset:5120
    s_waitcnt lgkmcnt(3)
    v_mfma_f32_16x16x32_bf16 v[188:191], v[220:223], a[16:19], v[188:191]
    ds_read_b64_tr_b16 v[234:235], v3 offset:7168
    v_xor_b32 v3, s22, v6
    v_mfma_f32_16x16x32_bf16 v[192:195], v[220:223], a[88:91], v[192:195]
    s_set_gpr_idx_on s31, gpr_idx(DST)
    v_mov_b64 v[44:45], v[236:237]
    s_set_gpr_idx_off
    v_mfma_f32_16x16x32_bf16 v[196:199], v[220:223], a[160:163], v[196:199]
    s_waitcnt vmcnt(8)
    s_barrier
    s_add_u32 s20, s16, s18
    s_min_u32 s16, s16, s20
    v_mfma_f32_16x16x32_bf16 v[200:203], v[220:223], a[232:235], v[200:203]
    ds_read_b64_tr_b16 v[220:221], v3 offset:0
    s_min_u32 m0, s19, s21
    v_mfma_f32_16x16x32_bf16 v[204:207], v[224:227], a[16:19], v[204:207]
    ds_read_b64_tr_b16 v[222:223], v3 offset:2048
    s_add_u32 s22, s22, 8192
    v_mfma_f32_16x16x32_bf16 v[208:211], v[224:227], a[88:91], v[208:211]
    s_sub_u32 s24, s22, s99
    s_min_u32 s22, s22, s24
    v_pk_max_i16 v244, v244, 0
    v_mfma_f32_16x16x32_bf16 v[212:215], v[224:227], a[160:163], v[212:215]
    buffer_load_dwordx4 v1, s[4:7], s16 offen lds
    v_mfma_f32_16x16x32_bf16 v[216:219], v[224:227], a[232:235], v[216:219]
    ds_read_b64_tr_b16 v[224:225], v3 offset:1024
    s_waitcnt lgkmcnt(3)
    v_mfma_f32_16x16x32_bf16 v[188:191], v[228:231], a[20:23], v[188:191]
    ds_read_b64_tr_b16 v[226:227], v3 offset:3072
    v_pk_max_i16 v245, v245, 0
    v_mfma_f32_16x16x32_bf16 v[192:195], v[228:231], a[92:95], v[192:195]
    buffer_load_dwordx4 v1, s[8:11], s16 offen offset:1024 lds
    v_mfma_f32_16x16x32_bf16 v[196:199], v[228:231], a[164:167], v[196:199]
    s_add_u32 s19, m0, 8192
    s_sub_u32 s21, s19, s99
    s_add_u32 s16, s16, s17
    v_mfma_f32_16x16x32_bf16 v[200:203], v[228:231], a[236:239], v[200:203]
    ds_read_b64_tr_b16 v[228:229], v3 offset:4096
    s_add_u32 s20, s16, s18
    v_mfma_f32_16x16x32_bf16 v[204:207], v[232:235], a[20:23], v[204:207]
    ds_read_b64_tr_b16 v[230:231], v3 offset:6144
    s_min_u32 s16, s16, s20
    v_mfma_f32_16x16x32_bf16 v[208:211], v[232:235], a[92:95], v[208:211]
    s_set_gpr_idx_on s31, gpr_idx(DST)
    v_mov_b64 v[46:47], v[238:239]
    s_set_gpr_idx_off
    v_mfma_f32_16x16x32_bf16 v[212:215], v[232:235], a[164:167], v[212:215]
    v_mfma_f32_16x16x32_bf16 v[216:219], v[232:235], a[236:239], v[216:219]
    ds_read_b64_tr_b16 v[232:233], v3 offset:5120
    s_waitcnt lgkmcnt(3)
    v_mfma_f32_16x16x32_bf16 v[188:191], v[220:223], a[24:27], v[188:191]
    ds_read_b64_tr_b16 v[234:235], v3 offset:7168
    v_xor_b32 v3, s22, v6
    v_mfma_f32_16x16x32_bf16 v[192:195], v[220:223], a[96:99], v[192:195]
    v_mfma_f32_16x16x32_bf16 v[196:199], v[220:223], a[168:171], v[196:199]
    s_min_u32 m0, s19, s21
    v_mfma_f32_16x16x32_bf16 v[200:203], v[220:223], a[240:243], v[200:203]
    ds_read_b64_tr_b16 v[220:221], v3 offset:0
    v_pk_max_i16 v246, v246, 0
    v_mfma_f32_16x16x32_bf16 v[204:207], v[224:227], a[24:27], v[204:207]
    ds_read_b64_tr_b16 v[222:223], v3 offset:2048
    s_add_u32 s22, s22, 8192
    v_mfma_f32_16x16x32_bf16 v[208:211], v[224:227], a[96:99], v[208:211]
    s_sub_u32 s24, s22, s99
    s_min_u32 s22, s22, s24
    v_pk_max_i16 v247, v247, 0
    v_mfma_f32_16x16x32_bf16 v[212:215], v[224:227], a[168:171], v[212:215]
    buffer_load_dwordx4 v1, s[4:7], s16 offen lds
    v_mfma_f32_16x16x32_bf16 v[216:219], v[224:227], a[240:243], v[216:219]
    ds_read_b64_tr_b16 v[224:225], v3 offset:1024
    s_waitcnt lgkmcnt(3)
    v_mfma_f32_16x16x32_bf16 v[188:191], v[228:231], a[28:31], v[188:191]
    ds_read_b64_tr_b16 v[226:227], v3 offset:3072
    v_pk_max_i16 v248, v248, 0
    v_mfma_f32_16x16x32_bf16 v[192:195], v[228:231], a[100:103], v[192:195]
    buffer_load_dwordx4 v1, s[8:11], s16 offen offset:1024 lds
    v_mfma_f32_16x16x32_bf16 v[196:199], v[228:231], a[172:175], v[196:199]
    s_add_u32 s19, m0, 8192
    s_sub_u32 s21, s19, s99
    s_add_u32 s16, s16, s17
    v_mfma_f32_16x16x32_bf16 v[200:203], v[228:231], a[244:247], v[200:203]
    ds_read_b64_tr_b16 v[228:229], v3 offset:4096
    s_add_u32 s20, s16, s18
    v_mfma_f32_16x16x32_bf16 v[204:207], v[232:235], a[28:31], v[204:207]
    ds_read_b64_tr_b16 v[230:231], v3 offset:6144
    s_min_u32 s16, s16, s20
    v_mfma_f32_16x16x32_bf16 v[208:211], v[232:235], a[100:103], v[208:211]
    buffer_load_dword v254, v8, s[72:75], s71 offen
    v_mfma_f32_16x16x32_bf16 v[212:215], v[232:235], a[172:175], v[212:215]
    s_add_u32 s71, s71, 128
    s_set_gpr_idx_on s31, gpr_idx(DST)
    v_mov_b64 v[48:49], v[240:241]
    s_set_gpr_idx_off
    v_mfma_f32_16x16x32_bf16 v[216:219], v[232:235], a[244:247], v[216:219]
    ds_read_b64_tr_b16 v[232:233], v3 offset:5120
    s_waitcnt lgkmcnt(3)
    v_mfma_f32_16x16x32_bf16 v[188:191], v[220:223], a[32:35], v[188:191]
    ds_read_b64_tr_b16 v[234:235], v3 offset:7168
    v_xor_b32 v3, s22, v6
    v_mfma_f32_16x16x32_bf16 v[192:195], v[220:223], a[104:107], v[192:195]
    s_min_u32 m0, s19, s21
    v_mfma_f32_16x16x32_bf16 v[196:199], v[220:223], a[176:179], v[196:199]
    buffer_load_dwordx4 v1, s[4:7], s16 offen lds
    v_mfma_f32_16x16x32_bf16 v[200:203], v[220:223], a[248:251], v[200:203]
    ds_read_b64_tr_b16 v[220:221], v3 offset:0
    v_pk_max_i16 v249, v249, 0
    v_mfma_f32_16x16x32_bf16 v[204:207], v[224:227], a[32:35], v[204:207]
    ds_read_b64_tr_b16 v[222:223], v3 offset:2048
    s_add_u32 s22, s22, 8192
    v_mfma_f32_16x16x32_bf16 v[208:211], v[224:227], a[104:107], v[208:211]
    s_sub_u32 s24, s22, s99
    s_min_u32 s22, s22, s24
    v_pk_max_i16 v250, v250, 0
    v_mfma_f32_16x16x32_bf16 v[212:215], v[224:227], a[176:179], v[212:215]
    buffer_load_dwordx4 v1, s[8:11], s16 offen offset:1024 lds
    v_mfma_f32_16x16x32_bf16 v[216:219], v[224:227], a[248:251], v[216:219]
    ds_read_b64_tr_b16 v[224:225], v3 offset:1024
    s_waitcnt lgkmcnt(3)
    s_add_u32 s19, m0, 8192
    v_mfma_f32_16x16x32_bf16 v[188:191], v[228:231], a[36:39], v[188:191]
    ds_read_b64_tr_b16 v[226:227], v3 offset:3072
    s_sub_u32 s21, s19, s99
    v_mfma_f32_16x16x32_bf16 v[192:195], v[228:231], a[108:111], v[192:195]
    s_set_gpr_idx_on s31, gpr_idx(DST)
    v_mov_b64 v[50:51], v[242:243]
    s_set_gpr_idx_off
    v_mfma_f32_16x16x32_bf16 v[196:199], v[228:231], a[180:183], v[196:199]
    s_add_u32 s16, s16, s17
    s_add_u32 s20, s16, s18
    s_min_u32 s16, s16, s20
    v_mfma_f32_16x16x32_bf16 v[200:203], v[228:231], a[252:255], v[200:203]
    ds_read_b64_tr_b16 v[228:229], v3 offset:4096
    v_pk_max_i16 v251, v251, 0
    v_mfma_f32_16x16x32_bf16 v[204:207], v[232:235], a[36:39], v[204:207]
    ds_read_b64_tr_b16 v[230:231], v3 offset:6144
    v_mfma_f32_16x16x32_bf16 v[208:211], v[232:235], a[108:111], v[208:211]
    v_mfma_f32_16x16x32_bf16 v[212:215], v[232:235], a[180:183], v[212:215]
    v_mfma_f32_16x16x32_bf16 v[216:219], v[232:235], a[252:255], v[216:219]
    ds_read_b64_tr_b16 v[232:233], v3 offset:5120
    s_waitcnt lgkmcnt(3)
    s_min_u32 m0, s19, s21
    v_mfma_f32_16x16x32_bf16 v[188:191], v[220:223], a[40:43], v[188:191]
    ds_read_b64_tr_b16 v[234:235], v3 offset:7168
    v_xor_b32 v3, s22, v6
    v_mfma_f32_16x16x32_bf16 v[192:195], v[220:223], a[112:115], v[192:195]
    buffer_load_dwordx4 v1, s[4:7], s16 offen lds
    v_mfma_f32_16x16x32_bf16 v[196:199], v[220:223], a[184:187], v[196:199]
    s_waitcnt vmcnt(10)
    s_barrier
    v_mfma_f32_16x16x32_bf16 v[200:203], v[220:223], v[12:15], v[200:203]
    ds_read_b64_tr_b16 v[220:221], v3 offset:0
    v_mfma_f32_16x16x32_bf16 v[204:207], v[224:227], a[40:43], v[204:207]
    ds_read_b64_tr_b16 v[222:223], v3 offset:2048
    s_add_u32 s22, s22, 8192
    v_mfma_f32_16x16x32_bf16 v[208:211], v[224:227], a[112:115], v[208:211]
    s_sub_u32 s24, s22, s99
    s_min_u32 s22, s22, s24
    v_mfma_f32_16x16x32_bf16 v[212:215], v[224:227], a[184:187], v[212:215]
    buffer_load_dwordx4 v1, s[8:11], s16 offen offset:1024 lds
    v_mfma_f32_16x16x32_bf16 v[216:219], v[224:227], v[12:15], v[216:219]
    ds_read_b64_tr_b16 v[224:225], v3 offset:1024
    s_waitcnt lgkmcnt(3)
    s_add_u32 s19, m0, 8192
    v_mfma_f32_16x16x32_bf16 v[188:191], v[228:231], a[44:47], v[188:191]
    ds_read_b64_tr_b16 v[226:227], v3 offset:3072
    s_sub_u32 s21, s19, s99
    v_mfma_f32_16x16x32_bf16 v[192:195], v[228:231], a[116:119], v[192:195]
    buffer_load_dword v254, v253, s[76:79], s80 offen
    v_mfma_f32_16x16x32_bf16 v[196:199], v[228:231], a[188:191], v[196:199]
    s_add_u32 s80, s80, 131072
    s_set_gpr_idx_on s31, gpr_idx(DST)
    v_mov_b64 v[52:53], v[244:245]
    s_set_gpr_idx_off
    v_mfma_f32_16x16x32_bf16 v[200:203], v[228:231], v[16:19], v[200:203]
    ds_read_b64_tr_b16 v[228:229], v3 offset:4096
    s_add_u32 s16, s16, s17
    v_mfma_f32_16x16x32_bf16 v[204:207], v[232:235], a[44:47], v[204:207]
    ds_read_b64_tr_b16 v[230:231], v3 offset:6144
    s_add_u32 s20, s16, s18
    v_mfma_f32_16x16x32_bf16 v[208:211], v[232:235], a[116:119], v[208:211]
    s_min_u32 m0, s19, s21
    s_min_u32 s16, s16, s20
    v_mfma_f32_16x16x32_bf16 v[212:215], v[232:235], a[188:191], v[212:215]
    v_mfma_f32_16x16x32_bf16 v[216:219], v[232:235], v[16:19], v[216:219]
    ds_read_b64_tr_b16 v[232:233], v3 offset:5120
    s_waitcnt lgkmcnt(3)
    v_mfma_f32_16x16x32_bf16 v[188:191], v[220:223], a[48:51], v[188:191]
    ds_read_b64_tr_b16 v[234:235], v3 offset:7168
    v_xor_b32 v3, s22, v6
    v_mfma_f32_16x16x32_bf16 v[192:195], v[220:223], a[120:123], v[192:195]
    buffer_load_dwordx4 v1, s[4:7], s16 offen lds
    v_mfma_f32_16x16x32_bf16 v[196:199], v[220:223], a[192:195], v[196:199]
    s_cmp_eq_u32 s25, 6
    s_cselect_b32 s55, s81, s55
    v_mfma_f32_16x16x32_bf16 v[200:203], v[220:223], v[20:23], v[200:203]
    ds_read_b64_tr_b16 v[220:221], v3 offset:0
    v_mfma_f32_16x16x32_bf16 v[204:207], v[224:227], a[48:51], v[204:207]
    ds_read_b64_tr_b16 v[222:223], v3 offset:2048
    s_add_u32 s22, s22, 8192
    v_mfma_f32_16x16x32_bf16 v[208:211], v[224:227], a[120:123], v[208:211]
    s_sub_u32 s24, s22, s99
    s_min_u32 s22, s22, s24
    v_mfma_f32_16x16x32_bf16 v[212:215], v[224:227], a[192:195], v[212:215]
    buffer_load_dwordx4 v1, s[8:11], s16 offen offset:1024 lds
    v_mfma_f32_16x16x32_bf16 v[216:219], v[224:227], v[20:23], v[216:219]
    ds_read_b64_tr_b16 v[224:225], v3 offset:1024
    s_waitcnt lgkmcnt(3)
    s_add_u32 s19, m0, 8192
    v_mfma_f32_16x16x32_bf16 v[188:191], v[228:231], a[52:55], v[188:191]
    ds_read_b64_tr_b16 v[226:227], v3 offset:3072
    s_sub_u32 s21, s19, s99
    v_mfma_f32_16x16x32_bf16 v[192:195], v[228:231], a[124:127], v[192:195]
    s_mov_b64 exec, s[38:39]
    buffer_store_dword v5, off, s[12:15], s55 offset:256 sc1
    s_mov_b64 exec, -1
    v_mfma_f32_16x16x32_bf16 v[196:199], v[228:231], a[196:199], v[196:199]
    s_set_gpr_idx_on s31, gpr_idx(DST)
    v_mov_b64 v[54:55], v[246:247]
    s_set_gpr_idx_off
    v_mfma_f32_16x16x32_bf16 v[200:203], v[228:231], v[24:27], v[200:203]
    ds_read_b64_tr_b16 v[228:229], v3 offset:4096
    s_add_u32 s16, s16, s17
    v_mfma_f32_16x16x32_bf16 v[204:207], v[232:235], a[52:55], v[204:207]
    ds_read_b64_tr_b16 v[230:231], v3 offset:6144
    s_min_u32 m0, s19, s21
    v_mfma_f32_16x16x32_bf16 v[208:211], v[232:235], a[124:127], v[208:211]
    s_add_u32 s20, s16, s18
    s_min_u32 s16, s16, s20
    v_mfma_f32_16x16x32_bf16 v[212:215], v[232:235], a[196:199], v[212:215]
    buffer_load_dwordx4 v1, s[4:7], s16 offen lds
    v_mfma_f32_16x16x32_bf16 v[216:219], v[232:235], v[24:27], v[216:219]
    ds_read_b64_tr_b16 v[232:233], v3 offset:5120
    s_waitcnt lgkmcnt(3)
    v_mfma_f32_16x16x32_bf16 v[188:191], v[220:223], a[56:59], v[188:191]
    ds_read_b64_tr_b16 v[234:235], v3 offset:7168
    v_xor_b32 v3, s22, v6
    v_mfma_f32_16x16x32_bf16 v[192:195], v[220:223], a[128:131], v[192:195]
    buffer_load_dwordx4 v1, s[8:11], s16 offen offset:1024 lds
    v_mfma_f32_16x16x32_bf16 v[196:199], v[220:223], a[200:203], v[196:199]
    s_add_u32 s19, m0, 8192
    s_sub_u32 s21, s19, s99
    s_add_u32 s16, s16, s17
    v_mfma_f32_16x16x32_bf16 v[200:203], v[220:223], v[28:31], v[200:203]
    ds_read_b64_tr_b16 v[220:221], v3 offset:0
    s_add_u32 s20, s16, s18
    v_mfma_f32_16x16x32_bf16 v[204:207], v[224:227], a[56:59], v[204:207]
    ds_read_b64_tr_b16 v[222:223], v3 offset:2048
    s_min_u32 s16, s16, s20
    v_mfma_f32_16x16x32_bf16 v[208:211], v[224:227], a[128:131], v[208:211]
    s_set_gpr_idx_on s31, gpr_idx(DST)
    v_mov_b64 v[56:57], v[248:249]
    s_set_gpr_idx_off
    v_mfma_f32_16x16x32_bf16 v[212:215], v[224:227], a[200:203], v[212:215]
    s_set_gpr_idx_on s31, gpr_idx(DST)
    v_mov_b64 v[58:59], v[250:251]
    s_set_gpr_idx_off
    v_mfma_f32_16x16x32_bf16 v[216:219], v[224:227], v[28:31], v[216:219]
    ds_read_b64_tr_b16 v[224:225], v3 offset:1024
    s_waitcnt lgkmcnt(3)
    v_mfma_f32_16x16x32_bf16 v[188:191], v[228:231], a[60:63], v[188:191]
    ds_read_b64_tr_b16 v[226:227], v3 offset:3072
    s_add_u32 s36, s36, 16
    v_mfma_f32_16x16x32_bf16 v[192:195], v[228:231], a[132:135], v[192:195]
    s_max_i32 s31, s36, 0
    v_mfma_f32_16x16x32_bf16 v[196:199], v[228:231], a[204:207], v[196:199]
    s_min_u32 m0, s19, s21
    s_sub_u32 s25, s25, 1
    s_cbranch_scc0 TF_F15
    v_mfma_f32_16x16x32_bf16 v[200:203], v[228:231], v[32:35], v[200:203]
    ds_read_b64_tr_b16 v[228:229], v3 offset:4096
    s_lshl_b32 s34, s26, 13
    v_mfma_f32_16x16x32_bf16 v[204:207], v[232:235], a[60:63], v[204:207]
    ds_read_b64_tr_b16 v[230:231], v3 offset:6144
    s_add_u32 s34, s34, 98304
    v_mfma_f32_16x16x32_bf16 v[208:211], v[232:235], a[132:135], v[208:211]
    buffer_load_dwordx4 v1, s[4:7], s16 offen lds
    v_mfma_f32_16x16x32_bf16 v[212:215], v[232:235], a[204:207], v[212:215]
    s_lshl_b32 s22, s27, 10
    v_add_u32 v10, s34, v9
    s_add_u32 s22, s22, 90112
    v_mfma_f32_16x16x32_bf16 v[216:219], v[232:235], v[32:35], v[216:219]
    ds_write_b128 v10, v[44:47] offset:0
    s_waitcnt lgkmcnt(5)
    v_mfma_f32_16x16x32_bf16 v[188:191], v[220:223], a[64:67], v[188:191]
    ds_write_b128 v10, v[48:51] offset:1024
    v_mfma_f32_16x16x32_bf16 v[192:195], v[220:223], a[136:139], v[192:195]
    ds_write_b128 v10, v[52:55] offset:2048
    v_mfma_f32_16x16x32_bf16 v[196:199], v[220:223], a[208:211], v[196:199]
    ds_write_b128 v10, v[56:59] offset:3072
    v_mfma_f32_16x16x32_bf16 v[200:203], v[220:223], v[36:39], v[200:203]
    ds_write_b128 v10, v[60:63] offset:4096
    s_waitcnt lgkmcnt(7)
    v_mfma_f32_16x16x32_bf16 v[204:207], v[224:227], a[64:67], v[204:207]
    ds_write_b128 v10, v[64:67] offset:5120
    v_mfma_f32_16x16x32_bf16 v[208:211], v[224:227], a[136:139], v[208:211]
    ds_write_b128 v10, v[68:71] offset:6144
    v_mfma_f32_16x16x32_bf16 v[212:215], v[224:227], a[208:211], v[212:215]
    ds_write_b128 v10, v[72:75] offset:7168
    v_mfma_f32_16x16x32_bf16 v[216:219], v[224:227], v[36:39], v[216:219]
    ds_read_b64_tr_b16 v[232:233], v3 offset:5120
    ds_read_b64_tr_b16 v[234:235], v3 offset:7168
    s_add_u32 s22, s22, 8192
    s_sub_u32 s24, s22, s99
    s_min_u32 s22, s22, s24
    v_xor_b32 v3, s22, v6
    s_waitcnt lgkmcnt(2)
    s_barrier
    s_waitcnt vmcnt(11)
    s_barrier
    ds_read_b64_tr_b16 a[216:217], v3 offset:0
    ds_read_b64_tr_b16 a[218:219], v3 offset:4096
    buffer_load_dwordx4 v1, s[8:11], s16 offen offset:1024 lds
    v_mfma_f32_16x16x32_bf16 v[188:191], v[228:231], a[68:71], v[188:191]
    ds_read_b64_tr_b16 a[224:225], v3 offset:2048
    v_xor_b32 v4, 32, v3
    v_mfma_f32_16x16x32_bf16 v[192:195], v[228:231], a[140:143], v[192:195]
    ds_read_b64_tr_b16 a[220:221], v4 offset:0
    v_xor_b32 v11, 8192, v10
    v_mfma_f32_16x16x32_bf16 v[196:199], v[228:231], a[212:215], v[196:199]
    ds_read_b64_tr_b16 a[222:223], v4 offset:4096
    s_nop 0
    v_cvt_pk_bf16_f32 v236, v188, v189
    v_mfma_f32_16x16x32_bf16 v[200:203], v[228:231], v[40:43], v[200:203]
    ds_read_b128 a[0:3], v11 offset:0
    ds_read_b64_tr_b16 a[226:227], v3 offset:6144
    ds_read_b128 a[4:7], v11 offset:1024
    v_cvt_pk_bf16_f32 v237, v190, v191
    s_waitcnt lgkmcnt(8)
    v_mfma_f32_16x16x32_bf16 v[204:207], v[232:235], a[68:71], v[204:207]
    ds_read_b128 a[8:11], v11 offset:2048
    v_cvt_pk_bf16_f32 v240, v192, v193
    v_mfma_f32_16x16x32_bf16 v[208:211], v[232:235], a[140:143], v[208:211]
    ds_read_b128 a[12:15], v11 offset:3072
    v_cvt_pk_bf16_f32 v241, v194, v195
    v_mfma_f32_16x16x32_bf16 v[212:215], v[232:235], a[212:215], v[212:215]
    ds_read_b64_tr_b16 a[228:229], v4 offset:2048
    v_cvt_pk_bf16_f32 v244, v196, v197
    v_mfma_f32_16x16x32_bf16 v[216:219], v[232:235], v[40:43], v[216:219]
    ds_read_b64_tr_b16 a[230:231], v4 offset:6144
    v_cvt_pk_bf16_f32 v245, v198, v199
    s_waitcnt lgkmcnt(10)
    v_mfma_f32_16x16x32_bf16 v[188:191], a[216:219], v[44:47], 0
    s_add_u32 s22, s22, 8192
    v_cvt_pk_bf16_f32 v248, v200, v201
    v_cvt_pk_bf16_f32 v249, v202, v203
    v_mfma_f32_16x16x32_bf16 v[192:195], a[216:219], v[48:51], 0
    s_sub_u32 s24, s22, s99
    v_cvt_pk_bf16_f32 v238, v204, v205
    v_cvt_pk_bf16_f32 v239, v206, v207
    v_mfma_f32_16x16x32_bf16 v[196:199], a[216:219], v[52:55], 0
    s_min_u32 s22, s22, s24
    v_cvt_pk_bf16_f32 v242, v208, v209
    v_cvt_pk_bf16_f32 v243, v210, v211
    v_mfma_f32_16x16x32_bf16 v[200:203], a[216:219], v[56:59], 0
    ds_read_b128 a[16:19], v11 offset:4096
    v_cvt_pk_bf16_f32 v246, v212, v213
    s_waitcnt lgkmcnt(8)
    v_mfma_f32_16x16x32_bf16 v[204:207], a[220:223], v[44:47], 0
    ds_read_b128 a[20:23], v11 offset:5120
    v_cvt_pk_bf16_f32 v247, v214, v215
    v_mfma_f32_16x16x32_bf16 v[208:211], a[220:223], v[48:51], 0
    ds_read_b128 a[24:27], v11 offset:6144
    v_xor_b32 v3, s22, v6
    v_mfma_f32_16x16x32_bf16 v[212:215], a[220:223], v[52:55], 0
    ds_read_b64_tr_b16 a[216:217], v3 offset:0
    ds_read_b64_tr_b16 a[218:219], v3 offset:4096
    v_cvt_pk_bf16_f32 v250, v216, v217
    v_cvt_pk_bf16_f32 v251, v218, v219
    v_mfma_f32_16x16x32_bf16 v[216:219], a[220:223], v[56:59], 0
    ds_read_b128 a[28:31], v11 offset:7168
    v_xor_b32 v4, 32, v3
    s_waitcnt lgkmcnt(11)
    v_mfma_f32_16x16x32_bf16 v[188:191], a[224:227], a[0:3], v[188:191]
    ds_write_b128 v10, v[76:79] offset:32768
    s_waitcnt lgkmcnt(11)
    v_mfma_f32_16x16x32_bf16 v[192:195], a[224:227], a[4:7], v[192:195]
    ds_write_b128 v10, v[80:83] offset:33792
    s_waitcnt lgkmcnt(11)
    v_mfma_f32_16x16x32_bf16 v[196:199], a[224:227], a[8:11], v[196:199]
    ds_write_b128 v10, v[84:87] offset:34816
    s_waitcnt lgkmcnt(11)
    v_mfma_f32_16x16x32_bf16 v[200:203], a[224:227], a[12:15], v[200:203]
    ds_read_b64_tr_b16 a[220:221], v4 offset:0
    ds_read_b64_tr_b16 a[222:223], v4 offset:4096
    s_waitcnt lgkmcnt(11)
    v_mfma_f32_16x16x32_bf16 v[204:207], a[228:231], a[0:3], v[204:207]
    ds_write_b128 v10, v[88:91] offset:35840
    v_mfma_f32_16x16x32_bf16 v[208:211], a[228:231], a[4:7], v[208:211]
    ds_write_b128 v10, v[92:95] offset:36864
    v_mfma_f32_16x16x32_bf16 v[212:215], a[228:231], a[8:11], v[212:215]
    ds_write_b128 v10, v[96:99] offset:37888
    v_mfma_f32_16x16x32_bf16 v[216:219], a[228:231], a[12:15], v[216:219]
    ds_write_b128 v10, v[100:103] offset:38912
    s_waitcnt lgkmcnt(10)
    v_mfma_f32_16x16x32_bf16 v[188:191], a[216:219], v[60:63], v[188:191]
    ds_write_b128 v10, v[104:107] offset:39936
    ds_read_b64_tr_b16 a[224:225], v3 offset:2048
    ds_read_b64_tr_b16 a[226:227], v3 offset:6144
    s_add_u32 s19, m0, 8192
    s_add_u32 s16, s16, s17
    s_lshl_b32 s71, s26, 12
    v_lshrrev_b32 v253, 1, v0
    s_sub_u32 s21, s19, s99
    s_add_u32 s20, s16, s18
    s_sub_u32 s72, s84, 0
    s_mov_b32 s73, s85
    s_mov_b32 s74, TEXT_end-TEXT_start
    s_mov_b32 s75, 0x00020000
    s_add_u32 s71, s71, TAIL_start-TEXT_start
    v_lshlrev_b32 v253, 7, v253
    s_min_u32 s16, s16, s20
    s_min_u32 m0, s19, s21
    buffer_load_dword v254, v253, s[72:75], s71 offen
    s_waitcnt lgkmcnt(2)
    s_barrier
    buffer_load_dwordx4 v1, s[4:7], s16 offen lds
    v_mfma_f32_16x16x32_bf16 v[192:195], a[216:219], v[64:67], v[192:195]
    ds_read_b64_tr_b16 a[228:229], v4 offset:2048
    s_add_u32 s22, s22, 8192
    v_mfma_f32_16x16x32_bf16 v[196:199], a[216:219], v[68:71], v[196:199]
    ds_read_b64_tr_b16 a[230:231], v4 offset:6144
    s_sub_u32 s24, s22, s99
    v_mfma_f32_16x16x32_bf16 v[200:203], a[216:219], v[72:75], v[200:203]
    buffer_load_dwordx4 v1, s[8:11], s16 offen offset:1024 lds
    v_mfma_f32_16x16x32_bf16 v[204:207], a[220:223], v[60:63], v[204:207]
    s_min_u32 s22, s22, s24
    v_xor_b32 v3, s22, v6
    v_xor_b32 v4, 32, v3
    v_mfma_f32_16x16x32_bf16 v[208:211], a[220:223], v[64:67], v[208:211]
    ds_read_b64_tr_b16 a[216:217], v3 offset:0
    s_add_u32 s19, m0, 8192
    v_mfma_f32_16x16x32_bf16 v[212:215], a[220:223], v[68:71], v[212:215]
    ds_read_b64_tr_b16 a[218:219], v3 offset:4096
    s_add_u32 s16, s16, s17
    v_mfma_f32_16x16x32_bf16 v[216:219], a[220:223], v[72:75], v[216:219]
    ds_read_b128 a[32:35], v11 offset:32768
    v_mov_b32 v31, -1
    s_waitcnt lgkmcnt(5)
    v_mfma_f32_16x16x32_bf16 v[188:191], a[224:227], a[16:19], v[188:191]
    ds_read_b128 a[36:39], v11 offset:33792
    v_lshlrev_b32 v28, 9, v0
    v_mfma_f32_16x16x32_bf16 v[192:195], a[224:227], a[20:23], v[192:195]
    s_mov_b64 exec, s[38:39]
    buffer_store_dword v31, v28, s[12:15], s35 offen sc1
    s_mov_b64 exec, -1
    v_mfma_f32_16x16x32_bf16 v[196:199], a[224:227], a[24:27], v[196:199]
    ds_read_b128 a[40:43], v11 offset:34816
    s_sub_u32 s21, s19, s99
    v_mfma_f32_16x16x32_bf16 v[200:203], a[224:227], a[28:31], v[200:203]
    ds_read_b128 a[44:47], v11 offset:35840
    ds_read_b128 a[48:51], v11 offset:36864
    s_waitcnt lgkmcnt(7)
    v_mfma_f32_16x16x32_bf16 v[204:207], a[228:231], a[16:19], v[204:207]
    ds_read_b128 a[52:55], v11 offset:37888
    ds_read_b128 a[72:75], v11 offset:38912
    v_mfma_f32_16x16x32_bf16 v[208:211], a[228:231], a[20:23], v[208:211]
    ds_read_b128 a[76:79], v11 offset:39936
    ds_read_b64_tr_b16 a[220:221], v4 offset:0
    v_mfma_f32_16x16x32_bf16 v[212:215], a[228:231], a[24:27], v[212:215]
    ds_read_b64_tr_b16 a[222:223], v4 offset:4096
    s_add_u32 s20, s16, s18
    v_mfma_f32_16x16x32_bf16 v[216:219], a[228:231], a[28:31], v[216:219]
    ds_write_b128 v10, v[108:111] offset:0
    s_waitcnt lgkmcnt(11)
    v_mfma_f32_16x16x32_bf16 v[188:191], a[216:219], v[76:79], v[188:191]
    ds_write_b128 v10, v[112:115] offset:1024
    v_mfma_f32_16x16x32_bf16 v[192:195], a[216:219], v[80:83], v[192:195]
    ds_write_b128 v10, v[116:119] offset:2048
    v_mfma_f32_16x16x32_bf16 v[196:199], a[216:219], v[84:87], v[196:199]
    ds_read_b64_tr_b16 a[224:225], v3 offset:2048
    ds_read_b64_tr_b16 a[226:227], v3 offset:6144
    v_mfma_f32_16x16x32_bf16 v[200:203], a[216:219], v[88:91], v[200:203]
    ds_write_b128 v10, v[120:123] offset:3072
    ds_write_b128 v10, v[124:127] offset:4096
    ds_write_b128 v10, v[128:131] offset:5120
    ds_write_b128 v10, v[132:135] offset:6144
    ds_write_b128 v10, v[136:139] offset:7168
    ds_read_b64_tr_b16 a[228:229], v4 offset:2048
    ds_read_b64_tr_b16 a[230:231], v4 offset:6144
    s_min_u32 m0, s19, s21
    s_min_u32 s16, s16, s20
    s_add_u32 s22, s22, 8192
    s_sub_u32 s24, s22, s99
    s_min_u32 s22, s22, s24
    s_waitcnt lgkmcnt(2)
    s_barrier
    buffer_load_dwordx4 v1, s[4:7], s16 offen lds
    v_mfma_f32_16x16x32_bf16 v[204:207], a[220:223], v[76:79], v[204:207]
    s_waitcnt vmcnt(8)
    s_barrier
    v_xor_b32 v3, s22, v6
    v_mfma_f32_16x16x32_bf16 v[208:211], a[220:223], v[80:83], v[208:211]
    ds_read_b64_tr_b16 a[216:217], v3 offset:0
    v_xor_b32 v4, 32, v3
    v_mfma_f32_16x16x32_bf16 v[212:215], a[220:223], v[84:87], v[212:215]
    ds_read_b64_tr_b16 a[218:219], v3 offset:4096
    s_add_u32 s19, m0, 8192
    v_mfma_f32_16x16x32_bf16 v[216:219], a[220:223], v[88:91], v[216:219]
    buffer_load_dwordx4 v1, s[8:11], s16 offen offset:1024 lds
    v_mfma_f32_16x16x32_bf16 v[188:191], a[224:227], a[32:35], v[188:191]
    ds_read_b64_tr_b16 a[220:221], v4 offset:0
    s_add_u32 s16, s16, s17
    v_mfma_f32_16x16x32_bf16 v[192:195], a[224:227], a[36:39], v[192:195]
    ds_read_b64_tr_b16 a[222:223], v4 offset:4096
    s_sub_u32 s21, s19, s99
    v_mfma_f32_16x16x32_bf16 v[196:199], a[224:227], a[40:43], v[196:199]
    s_add_u32 s20, s16, s18
    s_min_u32 m0, s19, s21
    s_min_u32 s16, s16, s20
    v_mfma_f32_16x16x32_bf16 v[200:203], a[224:227], a[44:47], v[200:203]
    buffer_load_dwordx4 v1, s[4:7], s16 offen lds
    s_waitcnt lgkmcnt(4)
    v_mfma_f32_16x16x32_bf16 v[204:207], a[228:231], a[32:35], v[204:207]
    ds_read_b64_tr_b16 a[224:225], v3 offset:2048
    s_add_u32 s22, s22, 8192
    v_mfma_f32_16x16x32_bf16 v[208:211], a[228:231], a[36:39], v[208:211]
    ds_read_b64_tr_b16 a[226:227], v3 offset:6144
    s_sub_u32 s24, s22, s99
    v_mfma_f32_16x16x32_bf16 v[212:215], a[228:231], a[40:43], v[212:215]
    buffer_load_dwordx4 v1, s[8:11], s16 offen offset:1024 lds
    v_mfma_f32_16x16x32_bf16 v[216:219], a[228:231], a[44:47], v[216:219]
    ds_read_b64_tr_b16 a[228:229], v4 offset:2048
    s_min_u32 s22, s22, s24
    s_waitcnt lgkmcnt(5)
    v_mfma_f32_16x16x32_bf16 v[188:191], a[216:219], v[92:95], v[188:191]
    ds_read_b64_tr_b16 a[230:231], v4 offset:6144
    v_xor_b32 v3, s22, v6
    v_mfma_f32_16x16x32_bf16 v[192:195], a[216:219], v[96:99], v[192:195]
    ds_read_b128 a[80:83], v11 offset:0
    v_xor_b32 v4, 32, v3
    v_mfma_f32_16x16x32_bf16 v[196:199], a[216:219], v[100:103], v[196:199]
    ds_read_b128 a[84:87], v11 offset:1024
    s_add_u32 s19, m0, 8192
    v_mfma_f32_16x16x32_bf16 v[200:203], a[216:219], v[104:107], v[200:203]
    ds_read_b64_tr_b16 a[216:217], v3 offset:0
    s_add_u32 s16, s16, s17
    s_waitcnt lgkmcnt(7)
    v_mfma_f32_16x16x32_bf16 v[204:207], a[220:223], v[92:95], v[204:207]
    ds_read_b64_tr_b16 a[218:219], v3 offset:4096
    s_sub_u32 s21, s19, s99
    v_mfma_f32_16x16x32_bf16 v[208:211], a[220:223], v[96:99], v[208:211]
    ds_read_b128 a[88:91], v11 offset:2048
    s_add_u32 s20, s16, s18
    v_mfma_f32_16x16x32_bf16 v[212:215], a[220:223], v[100:103], v[212:215]
    ds_read_b128 a[92:95], v11 offset:3072
    s_min_u32 m0, s19, s21
    v_mfma_f32_16x16x32_bf16 v[216:219], a[220:223], v[104:107], v[216:219]
    ds_read_b128 a[96:99], v11 offset:4096
    s_min_u32 s16, s16, s20
    s_waitcnt lgkmcnt(9)
    v_mfma_f32_16x16x32_bf16 v[188:191], a[224:227], a[48:51], v[188:191]
    ds_read_b128 a[100:103], v11 offset:5120
    ds_read_b128 a[104:107], v11 offset:6144
    v_mfma_f32_16x16x32_bf16 v[192:195], a[224:227], a[52:55], v[192:195]
    ds_read_b128 a[108:111], v11 offset:7168
    s_add_u32 s22, s22, 8192
    v_mfma_f32_16x16x32_bf16 v[196:199], a[224:227], a[72:75], v[196:199]
    ds_write_b128 v10, v[140:143] offset:32768
    v_mfma_f32_16x16x32_bf16 v[200:203], a[224:227], a[76:79], v[200:203]
    ds_read_b64_tr_b16 a[220:221], v4 offset:0
    ds_read_b64_tr_b16 a[222:223], v4 offset:4096
    ds_write_b128 v10, v[144:147] offset:33792
    ds_write_b128 v10, v[148:151] offset:34816
    buffer_load_dwordx4 v1, s[4:7], s16 offen lds
    s_waitcnt lgkmcnt(15)
    v_mfma_f32_16x16x32_bf16 v[204:207], a[228:231], a[48:51], v[204:207]
    ds_write_b128 v10, v[152:155] offset:35840
    v_mfma_f32_16x16x32_bf16 v[208:211], a[228:231], a[52:55], v[208:211]
    ds_write_b128 v10, v[156:159] offset:36864
    v_mfma_f32_16x16x32_bf16 v[212:215], a[228:231], a[72:75], v[212:215]
    ds_write_b128 v10, v[160:163] offset:37888
    v_mfma_f32_16x16x32_bf16 v[216:219], a[228:231], a[76:79], v[216:219]
    ds_write_b128 v10, v[164:167] offset:38912
    s_waitcnt lgkmcnt(15)
    v_mfma_f32_16x16x32_bf16 v[188:191], a[216:219], v[108:111], v[188:191]
    ds_write_b128 v10, v[168:171] offset:39936
    ds_read_b64_tr_b16 a[224:225], v3 offset:2048
    ds_read_b64_tr_b16 a[226:227], v3 offset:6144
    ds_read_b64_tr_b16 a[228:229], v4 offset:2048
    ds_read_b64_tr_b16 a[230:231], v4 offset:6144
    s_sub_u32 s24, s22, s99
    s_waitcnt lgkmcnt(4)
    s_barrier
    buffer_load_dwordx4 v1, s[8:11], s16 offen offset:1024 lds
    v_mfma_f32_16x16x32_bf16 v[192:195], a[216:219], v[112:115], v[192:195]
    s_min_u32 s22, s22, s24
    v_xor_b32 v3, s22, v6
    v_xor_b32 v4, 32, v3
    v_mfma_f32_16x16x32_bf16 v[196:199], a[216:219], v[116:119], v[196:199]
    s_add_u32 s19, m0, 8192
    s_add_u32 s16, s16, s17
    s_sub_u32 s21, s19, s99
    v_mfma_f32_16x16x32_bf16 v[200:203], a[216:219], v[120:123], v[200:203]
    ds_read_b64_tr_b16 a[216:217], v3 offset:0
    s_add_u32 s20, s16, s18
    v_mfma_f32_16x16x32_bf16 v[204:207], a[220:223], v[108:111], v[204:207]
    ds_read_b64_tr_b16 a[218:219], v3 offset:4096
    s_min_u32 m0, s19, s21
    v_mfma_f32_16x16x32_bf16 v[208:211], a[220:223], v[112:115], v[208:211]
    s_min_u32 s16, s16, s20
    s_add_u32 s22, s22, 8192
    s_sub_u32 s24, s22, s99
    v_mfma_f32_16x16x32_bf16 v[212:215], a[220:223], v[116:119], v[212:215]
    buffer_load_dwordx4 v1, s[4:7], s16 offen lds
    v_mfma_f32_16x16x32_bf16 v[216:219], a[220:223], v[120:123], v[216:219]
    ds_read_b64_tr_b16 a[220:221], v4 offset:0
    s_min_u32 s22, s22, s24
    s_waitcnt lgkmcnt(5)
    v_mfma_f32_16x16x32_bf16 v[188:191], a[224:227], a[80:83], v[188:191]
    ds_read_b64_tr_b16 a[222:223], v4 offset:4096
    v_pk_max_i16 v172, v236, 0
    v_mfma_f32_16x16x32_bf16 v[192:195], a[224:227], a[84:87], v[192:195]
    buffer_load_dwordx4 v1, s[8:11], s16 offen offset:1024 lds
    v_mfma_f32_16x16x32_bf16 v[196:199], a[224:227], a[88:91], v[196:199]
    ds_read_b128 a[112:115], v11 offset:32768
    v_pk_max_i16 v173, v237, 0
    v_mfma_f32_16x16x32_bf16 v[200:203], a[224:227], a[92:95], v[200:203]
    ds_read_b64_tr_b16 a[224:225], v3 offset:2048
    v_pk_max_i16 v174, v238, 0
    s_waitcnt lgkmcnt(6)
    v_mfma_f32_16x16x32_bf16 v[204:207], a[228:231], a[80:83], v[204:207]
    ds_read_b64_tr_b16 a[226:227], v3 offset:6144
    v_xor_b32 v3, s22, v6
    v_mfma_f32_16x16x32_bf16 v[208:211], a[228:231], a[84:87], v[208:211]
    ds_read_b128 a[116:119], v11 offset:33792
    v_pk_max_i16 v175, v239, 0
    v_mfma_f32_16x16x32_bf16 v[212:215], a[228:231], a[88:91], v[212:215]
    ds_read_b128 a[120:123], v11 offset:34816
    v_pk_max_i16 v176, v240, 0
    v_mfma_f32_16x16x32_bf16 v[216:219], a[228:231], a[92:95], v[216:219]
    ds_read_b64_tr_b16 a[228:229], v4 offset:2048
    v_pk_max_i16 v177, v241, 0
    s_waitcnt lgkmcnt(8)
    v_mfma_f32_16x16x32_bf16 v[188:191], a[216:219], v[124:127], v[188:191]
    ds_read_b64_tr_b16 a[230:231], v4 offset:6144
    v_xor_b32 v4, 32, v3
    v_mfma_f32_16x16x32_bf16 v[192:195], a[216:219], v[128:131], v[192:195]
    ds_read_b128 a[124:127], v11 offset:35840
    v_pk_max_i16 v178, v242, 0
    v_mfma_f32_16x16x32_bf16 v[196:199], a[216:219], v[132:135], v[196:199]
    ds_read_b128 a[144:147], v11 offset:36864
    v_pk_max_i16 v179, v243, 0
    v_mfma_f32_16x16x32_bf16 v[200:203], a[216:219], v[136:139], v[200:203]
    ds_read_b128 a[148:151], v11 offset:37888
    s_add_u32 s19, m0, 8192
    s_waitcnt lgkmcnt(10)
    v_mfma_f32_16x16x32_bf16 v[204:207], a[220:223], v[124:127], v[204:207]
    ds_read_b128 a[152:155], v11 offset:38912
    s_add_u32 s16, s16, s17
    v_mfma_f32_16x16x32_bf16 v[208:211], a[220:223], v[128:131], v[208:211]
    ds_read_b128 a[156:159], v11 offset:39936
    v_pk_max_i16 v180, v244, 0
    v_mfma_f32_16x16x32_bf16 v[212:215], a[220:223], v[132:135], v[212:215]
    ds_write_b128 v10, v[172:175] offset:0
    v_mfma_f32_16x16x32_bf16 v[216:219], a[220:223], v[136:139], v[216:219]
    s_waitcnt vmcnt(8)
    s_barrier
    ds_read_b64_tr_b16 a[216:217], v3 offset:0
    s_waitcnt lgkmcnt(11)
    v_mfma_f32_16x16x32_bf16 v[188:191], a[224:227], a[96:99], v[188:191]
    ds_read_b64_tr_b16 a[218:219], v3 offset:4096
    v_pk_max_i16 v181, v245, 0
    v_mfma_f32_16x16x32_bf16 v[192:195], a[224:227], a[100:103], v[192:195]
    ds_write_b128 v10, v[176:179] offset:1024
    v_mfma_f32_16x16x32_bf16 v[196:199], a[224:227], a[104:107], v[196:199]
    ds_read_b64_tr_b16 a[220:221], v4 offset:0
    v_pk_max_i16 v182, v246, 0
    v_mfma_f32_16x16x32_bf16 v[200:203], a[224:227], a[108:111], v[200:203]
    ds_read_b64_tr_b16 a[222:223], v4 offset:4096
    v_pk_max_i16 v183, v247, 0
    s_sub_u32 s21, s19, s99
    s_add_u32 s20, s16, s18
    v_pk_max_i16 v184, v248, 0
    v_pk_max_i16 v185, v249, 0
    v_pk_max_i16 v186, v250, 0
    v_pk_max_i16 v187, v251, 0
    s_min_u32 m0, s19, s21
    s_min_u32 s16, s16, s20
    ds_write_b128 v10, v[180:183] offset:2048
    buffer_load_dwordx4 v1, s[4:7], s16 offen lds
    s_waitcnt lgkmcnt(12)
    v_mfma_f32_16x16x32_bf16 v[204:207], a[228:231], a[96:99], v[204:207]
    ds_write_b128 v10, v[184:187] offset:3072
    v_mfma_f32_16x16x32_bf16 v[208:211], a[228:231], a[100:103], v[208:211]
    ds_read_b64_tr_b16 a[224:225], v3 offset:2048
    s_add_u32 s19, m0, 8192
    v_mfma_f32_16x16x32_bf16 v[212:215], a[228:231], a[104:107], v[212:215]
    ds_read_b64_tr_b16 a[226:227], v3 offset:6144
    s_sub_u32 s21, s19, s99
    v_mfma_f32_16x16x32_bf16 v[216:219], a[228:231], a[108:111], v[216:219]
    s_waitcnt lgkmcnt(2)
    s_barrier
    buffer_load_dwordx4 v1, s[8:11], s16 offen offset:1024 lds
    v_mfma_f32_16x16x32_bf16 v[188:191], a[216:219], v[140:143], v[188:191]
    ds_read_b64_tr_b16 a[228:229], v4 offset:2048
    s_add_u32 s16, s16, s17
    v_mfma_f32_16x16x32_bf16 v[192:195], a[216:219], v[144:147], v[192:195]
    ds_read_b64_tr_b16 a[230:231], v4 offset:6144
    s_add_u32 s20, s16, s18
    v_mfma_f32_16x16x32_bf16 v[196:199], a[216:219], v[148:151], v[196:199]
    s_min_u32 m0, s19, s21
    s_min_u32 s16, s16, s20
    s_mul_i32 s32, s29, 2359296
    v_mfma_f32_16x16x32_bf16 v[200:203], a[216:219], v[152:155], v[200:203]
    buffer_load_dwordx4 v1, s[4:7], s16 offen lds
    v_mfma_f32_16x16x32_bf16 v[204:207], a[220:223], v[140:143], v[204:207]
    buffer_load_dwordx4 v1, s[8:11], s16 offen offset:1024 lds
    v_mfma_f32_16x16x32_bf16 v[208:211], a[220:223], v[144:147], v[208:211]
    s_mul_i32 s34, s58, 147456
    s_add_u32 s22, s22, 8192
    s_add_u32 s32, s32, s34
    v_mfma_f32_16x16x32_bf16 v[212:215], a[220:223], v[148:151], v[212:215]
    s_sub_u32 s24, s22, s99
    s_add_u32 s32, s32, 4194304
    s_lshl_b32 s34, s27, 13
    v_mfma_f32_16x16x32_bf16 v[216:219], a[220:223], v[152:155], v[216:219]
    s_min_u32 s22, s22, s24
    s_add_u32 s32, s32, s34
    v_xor_b32 v3, s22, v6
    s_waitcnt lgkmcnt(2)
    v_mfma_f32_16x16x32_bf16 v[188:191], a[224:227], a[112:115], v[188:191]
    s_lshl_b32 s34, s28, 12
    s_add_u32 s22, s22, 8192
    s_add_u32 s32, s32, s34
    v_mfma_f32_16x16x32_bf16 v[192:195], a[224:227], a[116:119], v[192:195]
    s_mov_b32 s33, 0xf0000000
    v_xor_b32 v4, 32, v3
    s_sub_u32 s24, s22, s99
    v_mfma_f32_16x16x32_bf16 v[196:199], a[224:227], a[120:123], v[196:199]
    s_add_u32 s19, m0, 8192
    s_add_u32 s16, s16, s17
    s_mov_b32 s33, s32
    v_mfma_f32_16x16x32_bf16 v[200:203], a[224:227], a[124:127], v[200:203]
    ds_read_b128 a[160:163], v11 offset:0
    s_min_u32 s22, s22, s24
    s_waitcnt lgkmcnt(1)
    v_mfma_f32_16x16x32_bf16 v[204:207], a[228:231], a[112:115], v[204:207]
    ds_read_b128 a[164:167], v11 offset:1024
    s_sub_u32 s21, s19, s99
    v_mfma_f32_16x16x32_bf16 v[208:211], a[228:231], a[116:119], v[208:211]
    ds_read_b128 a[168:171], v11 offset:2048
    s_add_u32 s20, s16, s18
    v_mfma_f32_16x16x32_bf16 v[212:215], a[228:231], a[120:123], v[212:215]
    ds_read_b128 a[172:175], v11 offset:3072
    v_add_u32 v31, 1, v31
    v_mfma_f32_16x16x32_bf16 v[216:219], a[228:231], a[124:127], v[216:219]
    ds_read_b64_tr_b16 a[216:217], v3 offset:0
    ds_read_b64_tr_b16 a[218:219], v3 offset:4096
    ds_read_b64_tr_b16 a[220:221], v4 offset:0
    ds_read_b64_tr_b16 a[222:223], v4 offset:4096
    ds_read_b64_tr_b16 a[224:225], v3 offset:2048
    ds_read_b64_tr_b16 a[226:227], v3 offset:6144
    ds_read_b64_tr_b16 a[228:229], v4 offset:2048
    s_add_u32 s32, s32, 16384
    s_min_u32 m0, s19, s21
    s_min_u32 s16, s16, s20
    v_xor_b32 v3, s22, v6
    s_waitcnt lgkmcnt(7)
    s_waitcnt lgkmcnt(3)
    s_mov_b32 s25, 8
    s_branch TF_F2e8
TF_SW11:
    s_mov_b32 s6, 0
    s_mov_b32 s10, 0
    s_branch TF_SW11r
.p2align 3
TF_F27:
    v_mfma_f32_16x16x32_bf16 v[200:203], a[216:219], v[168:171], v[200:203]
    ds_read_b64_tr_b16 a[216:217], v3 offset:0
    v_mfma_f32_16x16x32_bf16 v[204:207], a[220:223], v[156:159], v[204:207]
    ds_read_b64_tr_b16 a[218:219], v3 offset:4096
    v_mfma_f32_16x16x32_bf16 v[208:211], a[220:223], v[160:163], v[208:211]
    buffer_load_dwordx4 v1, s[8:11], s16 offen offset:1024 lds
    v_mfma_f32_16x16x32_bf16 v[212:215], a[220:223], v[164:167], v[212:215]
    s_add_u32 s19, m0, 8192
    s_sub_u32 s21, s19, s99
    s_min_u32 m0, s19, s21
    v_mfma_f32_16x16x32_bf16 v[216:219], a[220:223], v[168:171], v[216:219]
    ds_read_b64_tr_b16 a[220:221], v4 offset:0
    s_waitcnt lgkmcnt(3)
    v_mfma_f32_16x16x32_bf16 v[188:191], a[224:227], a[144:147], v[188:191]
    ds_read_b64_tr_b16 a[222:223], v4 offset:4096
    s_add_u32 s22, s22, 8192
    v_mfma_f32_16x16x32_bf16 v[192:195], a[224:227], a[148:151], v[192:195]
    s_sub_u32 s24, s22, s99
    s_min_u32 s22, s22, s24
    s_add_u32 s16, s16, s17
    v_mfma_f32_16x16x32_bf16 v[196:199], a[224:227], a[152:155], v[196:199]
    s_add_u32 s20, s16, s18
    s_min_u32 s16, s16, s20
    v_mfma_f32_16x16x32_bf16 v[200:203], a[224:227], a[156:159], v[200:203]
    ds_read_b64_tr_b16 a[224:225], v3 offset:2048
    v_mfma_f32_16x16x32_bf16 v[204:207], a[228:231], a[144:147], v[204:207]
    ds_read_b64_tr_b16 a[226:227], v3 offset:6144
    v_xor_b32 v3, s22, v6
    v_mfma_f32_16x16x32_bf16 v[208:211], a[228:231], a[148:151], v[208:211]
    v_mfma_f32_16x16x32_bf16 v[212:215], a[228:231], a[152:155], v[212:215]
    v_mfma_f32_16x16x32_bf16 v[216:219], a[228:231], a[156:159], v[216:219]
    ds_read_b64_tr_b16 a[228:229], v4 offset:2048
    s_waitcnt lgkmcnt(3)
    v_mfma_f32_16x16x32_bf16 v[188:191], a[216:219], v[172:175], v[188:191]
    ds_read_b64_tr_b16 a[230:231], v4 offset:6144
    v_xor_b32 v4, 32, v3
    v_mfma_f32_16x16x32_bf16 v[192:195], a[216:219], v[176:179], v[192:195]
    buffer_load_dwordx4 v1, s[4:7], s16 offen lds
    v_mfma_f32_16x16x32_bf16 v[196:199], a[216:219], v[180:183], v[196:199]
    s_waitcnt vmcnt(9)
    s_barrier
    v_mfma_f32_16x16x32_bf16 v[200:203], a[216:219], v[184:187], v[200:203]
    ds_read_b64_tr_b16 a[216:217], v3 offset:0
    v_mfma_f32_16x16x32_bf16 v[204:207], a[220:223], v[172:175], v[204:207]
    ds_read_b64_tr_b16 a[218:219], v3 offset:4096
    v_mfma_f32_16x16x32_bf16 v[208:211], a[220:223], v[176:179], v[208:211]
    buffer_load_dwordx4 v1, s[8:11], s16 offen offset:1024 lds
    v_mfma_f32_16x16x32_bf16 v[212:215], a[220:223], v[180:183], v[212:215]
    s_add_u32 s19, m0, 8192
    s_sub_u32 s21, s19, s99
    s_min_u32 m0, s19, s21
    v_mfma_f32_16x16x32_bf16 v[216:219], a[220:223], v[184:187], v[216:219]
    ds_read_b64_tr_b16 a[220:221], v4 offset:0
    s_waitcnt lgkmcnt(3)
    v_mfma_f32_16x16x32_bf16 v[188:191], a[224:227], a[160:163], v[188:191]
    ds_read_b64_tr_b16 a[222:223], v4 offset:4096
    s_add_u32 s22, s22, 8192
    v_mfma_f32_16x16x32_bf16 v[192:195], a[224:227], a[164:167], v[192:195]
    s_sub_u32 s24, s22, s99
    s_min_u32 s22, s22, s24
    s_add_u32 s16, s16, s17
    v_mfma_f32_16x16x32_bf16 v[196:199], a[224:227], a[168:171], v[196:199]
    s_add_u32 s20, s16, s18
    s_min_u32 s16, s16, s20
    v_mfma_f32_16x16x32_bf16 v[200:203], a[224:227], a[172:175], v[200:203]
    ds_read_b64_tr_b16 a[224:225], v3 offset:2048
    v_mfma_f32_16x16x32_bf16 v[204:207], a[228:231], a[160:163], v[204:207]
    ds_read_b64_tr_b16 a[226:227], v3 offset:6144
    v_cvt_pk_bf16_f32 v220, v188, v189
    v_xor_b32 v3, s22, v6
    v_mfma_f32_16x16x32_bf16 v[208:211], a[228:231], a[164:167], v[208:211]
    v_cvt_pk_bf16_f32 v221, v190, v191
    v_cvt_pk_bf16_f32 v224, v192, v193
    v_mfma_f32_16x16x32_bf16 v[212:215], a[228:231], a[168:171], v[212:215]
    s_waitcnt lgkmcnt(2)
    v_cvt_pk_bf16_f32 v225, v194, v195
    v_cvt_pk_bf16_f32 v228, v196, v197
    v_mfma_f32_16x16x32_bf16 v[216:219], a[228:231], a[172:175], v[216:219]
    ds_read_b64_tr_b16 a[228:229], v4 offset:2048
    v_cvt_pk_bf16_f32 v229, v198, v199
    v_mfma_f32_16x16x32_bf16 v[188:191], a[216:219], v[44:47], 0
    ds_read_b64_tr_b16 a[230:231], v4 offset:6144
    v_cvt_pk_bf16_f32 v232, v200, v201
    v_mfma_f32_16x16x32_bf16 v[192:195], a[216:219], v[48:51], 0
    s_add_u32 s22, s22, 8192
    v_cvt_pk_bf16_f32 v233, v202, v203
    v_cvt_pk_bf16_f32 v222, v204, v205
    v_mfma_f32_16x16x32_bf16 v[196:199], a[216:219], v[52:55], 0
    s_sub_u32 s24, s22, s99
    v_cvt_pk_bf16_f32 v223, v206, v207
    v_cvt_pk_bf16_f32 v226, v208, v209
    v_mfma_f32_16x16x32_bf16 v[200:203], a[216:219], v[56:59], 0
    ds_read_b64_tr_b16 a[216:217], v3 offset:0
    v_cvt_pk_bf16_f32 v227, v210, v211
    v_mfma_f32_16x16x32_bf16 v[204:207], a[220:223], v[44:47], 0
    ds_read_b64_tr_b16 a[218:219], v3 offset:4096
    v_cvt_pk_bf16_f32 v230, v212, v213
    v_mfma_f32_16x16x32_bf16 v[208:211], a[220:223], v[48:51], 0
    s_min_u32 s22, s22, s24
    v_cvt_pk_bf16_f32 v231, v214, v215
    v_cvt_pk_bf16_f32 v234, v216, v217
    v_mfma_f32_16x16x32_bf16 v[212:215], a[220:223], v[52:55], 0
    v_cvt_pk_bf16_f32 v235, v218, v219
    v_xor_b32 v4, 32, v3
    v_mfma_f32_16x16x32_bf16 v[216:219], a[220:223], v[56:59], 0
    ds_read_b64_tr_b16 a[220:221], v4 offset:0
    s_waitcnt lgkmcnt(3)
    v_mfma_f32_16x16x32_bf16 v[188:191], a[224:227], a[0:3], v[188:191]
    ds_read_b64_tr_b16 a[222:223], v4 offset:4096
    v_mfma_f32_16x16x32_bf16 v[192:195], a[224:227], a[4:7], v[192:195]
    buffer_store_dwordx4 v[220:223], v9, s[12:15], s33 offen offset:0 sc1
    v_mfma_f32_16x16x32_bf16 v[196:199], a[224:227], a[8:11], v[196:199]
    buffer_load_dwordx4 v1, s[4:7], s16 offen lds
    v_mfma_f32_16x16x32_bf16 v[200:203], a[224:227], a[12:15], v[200:203]
    ds_read_b64_tr_b16 a[224:225], v3 offset:2048
    v_mfma_f32_16x16x32_bf16 v[204:207], a[228:231], a[0:3], v[204:207]
    ds_read_b64_tr_b16 a[226:227], v3 offset:6144
    v_xor_b32 v3, s22, v6
    v_mfma_f32_16x16x32_bf16 v[208:211], a[228:231], a[4:7], v[208:211]
    buffer_load_dwordx4 v1, s[8:11], s16 offen offset:1024 lds
    v_mfma_f32_16x16x32_bf16 v[212:215], a[228:231], a[8:11], v[212:215]
    s_add_u32 s19, m0, 8192
    s_sub_u32 s21, s19, s99
    s_min_u32 m0, s19, s21
    v_mfma_f32_16x16x32_bf16 v[216:219], a[228:231], a[12:15], v[216:219]
    ds_read_b64_tr_b16 a[228:229], v4 offset:2048
    s_waitcnt lgkmcnt(3)
    v_mfma_f32_16x16x32_bf16 v[188:191], a[216:219], v[60:63], v[188:191]
    ds_read_b64_tr_b16 a[230:231], v4 offset:6144
    v_xor_b32 v4, 32, v3
    v_mfma_f32_16x16x32_bf16 v[192:195], a[216:219], v[64:67], v[192:195]
    s_add_u32 s22, s22, 8192
    s_sub_u32 s24, s22, s99
    s_min_u32 s22, s22, s24
    v_mfma_f32_16x16x32_bf16 v[196:199], a[216:219], v[68:71], v[196:199]
    s_add_u32 s16, s16, s17
    s_add_u32 s20, s16, s18
    s_min_u32 s16, s16, s20
    v_mfma_f32_16x16x32_bf16 v[200:203], a[216:219], v[72:75], v[200:203]
    ds_read_b64_tr_b16 a[216:217], v3 offset:0
    v_mfma_f32_16x16x32_bf16 v[204:207], a[220:223], v[60:63], v[204:207]
    ds_read_b64_tr_b16 a[218:219], v3 offset:4096
    v_mfma_f32_16x16x32_bf16 v[208:211], a[220:223], v[64:67], v[208:211]
    v_mfma_f32_16x16x32_bf16 v[212:215], a[220:223], v[68:71], v[212:215]
    s_mov_b64 exec, s[38:39]
    buffer_store_dword v31, v28, s[12:15], s35 offen sc1
    s_mov_b64 exec, -1
    v_mfma_f32_16x16x32_bf16 v[216:219], a[220:223], v[72:75], v[216:219]
    ds_read_b64_tr_b16 a[220:221], v4 offset:0
    s_waitcnt lgkmcnt(3)
    v_mfma_f32_16x16x32_bf16 v[188:191], a[224:227], a[16:19], v[188:191]
    ds_read_b64_tr_b16 a[222:223], v4 offset:4096
    v_add_u32 v31, 1, v31
    v_mfma_f32_16x16x32_bf16 v[192:195], a[224:227], a[20:23], v[192:195]
    buffer_store_dwordx4 v[224:227], v9, s[12:15], s33 offen offset:1024 sc1
    v_mfma_f32_16x16x32_bf16 v[196:199], a[224:227], a[24:27], v[196:199]
    s_cmp_eq_u32 s25, 0
    s_cbranch_scc1 TF_SW11
TF_SW11r:
    v_mfma_f32_16x16x32_bf16 v[200:203], a[224:227], a[28:31], v[200:203]
    ds_read_b64_tr_b16 a[224:225], v3 offset:2048
    v_mfma_f32_16x16x32_bf16 v[204:207], a[228:231], a[16:19], v[204:207]
    ds_read_b64_tr_b16 a[226:227], v3 offset:6144
    v_xor_b32 v3, s22, v6
    v_mfma_f32_16x16x32_bf16 v[208:211], a[228:231], a[20:23], v[208:211]
    buffer_load_dwordx4 v1, s[4:7], s16 offen lds
    v_mfma_f32_16x16x32_bf16 v[212:215], a[228:231], a[24:27], v[212:215]
    v_mfma_f32_16x16x32_bf16 v[216:219], a[228:231], a[28:31], v[216:219]
    ds_read_b64_tr_b16 a[228:229], v4 offset:2048
    s_waitcnt lgkmcnt(3)
    v_mfma_f32_16x16x32_bf16 v[188:191], a[216:219], v[76:79], v[188:191]
    ds_read_b64_tr_b16 a[230:231], v4 offset:6144
    v_xor_b32 v4, 32, v3
    v_mfma_f32_16x16x32_bf16 v[192:195], a[216:219], v[80:83], v[192:195]
    s_add_u32 s22, s22, 8192
    s_sub_u32 s24, s22, s99
    s_min_u32 s22, s22, s24
    v_mfma_f32_16x16x32_bf16 v[196:199], a[216:219], v[84:87], v[196:199]
    s_waitcnt vmcnt(9)
    s_barrier
    buffer_load_dwordx4 v1, s[8:11], s16 offen offset:1024 lds
    v_mfma_f32_16x16x32_bf16 v[200:203], a[216:219], v[88:91], v[200:203]
    ds_read_b64_tr_b16 a[216:217], v3 offset:0
    s_add_u32 s19, m0, 8192
    s_add_u32 s16, s16, s17
    v_mfma_f32_16x16x32_bf16 v[204:207], a[220:223], v[76:79], v[204:207]
    ds_read_b64_tr_b16 a[218:219], v3 offset:4096
    s_sub_u32 s21, s19, s99
    v_mfma_f32_16x16x32_bf16 v[208:211], a[220:223], v[80:83], v[208:211]
    s_min_u32 m0, s19, s21
    s_add_u32 s20, s16, s18
    s_min_u32 s16, s16, s20
    v_mfma_f32_16x16x32_bf16 v[212:215], a[220:223], v[84:87], v[212:215]
    buffer_load_dwordx4 v1, s[4:7], s16 offen lds
    v_mfma_f32_16x16x32_bf16 v[216:219], a[220:223], v[88:91], v[216:219]
    ds_read_b64_tr_b16 a[220:221], v4 offset:0
    s_waitcnt lgkmcnt(3)
    v_mfma_f32_16x16x32_bf16 v[188:191], a[224:227], a[32:35], v[188:191]
    ds_read_b64_tr_b16 a[222:223], v4 offset:4096
    v_mfma_f32_16x16x32_bf16 v[192:195], a[224:227], a[36:39], v[192:195]
    buffer_store_dwordx4 v[228:231], v9, s[12:15], s33 offen offset:2048 sc1
    v_mfma_f32_16x16x32_bf16 v[196:199], a[224:227], a[40:43], v[196:199]
    buffer_load_dwordx4 v1, s[8:11], s16 offen offset:1024 lds
    v_mfma_f32_16x16x32_bf16 v[200:203], a[224:227], a[44:47], v[200:203]
    ds_read_b64_tr_b16 a[224:225], v3 offset:2048
    s_add_u32 s19, m0, 8192
    v_mfma_f32_16x16x32_bf16 v[204:207], a[228:231], a[32:35], v[204:207]
    ds_read_b64_tr_b16 a[226:227], v3 offset:6144
    v_xor_b32 v3, s22, v6
    v_mfma_f32_16x16x32_bf16 v[208:211], a[228:231], a[36:39], v[208:211]
    s_sub_u32 s21, s19, s99
    s_min_u32 m0, s19, s21
    s_add_u32 s16, s16, s17
    v_mfma_f32_16x16x32_bf16 v[212:215], a[228:231], a[40:43], v[212:215]
    s_add_u32 s20, s16, s18
    s_min_u32 s16, s16, s20
    v_mfma_f32_16x16x32_bf16 v[216:219], a[228:231], a[44:47], v[216:219]
    ds_read_b64_tr_b16 a[228:229], v4 offset:2048
    s_waitcnt lgkmcnt(3)
    v_mfma_f32_16x16x32_bf16 v[188:191], a[216:219], v[92:95], v[188:191]
    ds_read_b64_tr_b16 a[230:231], v4 offset:6144
    v_xor_b32 v4, 32, v3
    v_mfma_f32_16x16x32_bf16 v[192:195], a[216:219], v[96:99], v[192:195]
    s_add_u32 s22, s22, 8192
    s_sub_u32 s24, s22, s99
    s_min_u32 s22, s22, s24
    v_mfma_f32_16x16x32_bf16 v[196:199], a[216:219], v[100:103], v[196:199]
    v_mfma_f32_16x16x32_bf16 v[200:203], a[216:219], v[104:107], v[200:203]
    ds_read_b64_tr_b16 a[216:217], v3 offset:0
    v_mfma_f32_16x16x32_bf16 v[204:207], a[220:223], v[92:95], v[204:207]
    ds_read_b64_tr_b16 a[218:219], v3 offset:4096
    v_mfma_f32_16x16x32_bf16 v[208:211], a[220:223], v[96:99], v[208:211]
    buffer_load_dwordx4 v1, s[4:7], s16 offen lds
    v_mfma_f32_16x16x32_bf16 v[212:215], a[220:223], v[100:103], v[212:215]
    v_mfma_f32_16x16x32_bf16 v[216:219], a[220:223], v[104:107], v[216:219]
    ds_read_b64_tr_b16 a[220:221], v4 offset:0
    s_waitcnt lgkmcnt(3)
    v_mfma_f32_16x16x32_bf16 v[188:191], a[224:227], a[48:51], v[188:191]
    ds_read_b64_tr_b16 a[222:223], v4 offset:4096
    v_mfma_f32_16x16x32_bf16 v[192:195], a[224:227], a[52:55], v[192:195]
    buffer_store_dwordx4 v[232:235], v9, s[12:15], s33 offen offset:3072 sc1
    v_mfma_f32_16x16x32_bf16 v[196:199], a[224:227], a[72:75], v[196:199]
    buffer_load_dwordx4 v1, s[8:11], s16 offen offset:1024 lds
    v_mfma_f32_16x16x32_bf16 v[200:203], a[224:227], a[76:79], v[200:203]
    ds_read_b64_tr_b16 a[224:225], v3 offset:2048
    s_add_u32 s19, m0, 8192
    v_mfma_f32_16x16x32_bf16 v[204:207], a[228:231], a[48:51], v[204:207]
    ds_read_b64_tr_b16 a[226:227], v3 offset:6144
    v_xor_b32 v3, s22, v6
    v_mfma_f32_16x16x32_bf16 v[208:211], a[228:231], a[52:55], v[208:211]
    s_sub_u32 s21, s19, s99
    s_min_u32 m0, s19, s21
    s_add_u32 s16, s16, s17
    v_mfma_f32_16x16x32_bf16 v[212:215], a[228:231], a[72:75], v[212:215]
    s_add_u32 s20, s16, s18
    s_min_u32 s16, s16, s20
    s_mov_b32 s33, s32
    v_mfma_f32_16x16x32_bf16 v[216:219], a[228:231], a[76:79], v[216:219]
    ds_read_b64_tr_b16 a[228:229], v4 offset:2048
    s_waitcnt lgkmcnt(3)
    v_mfma_f32_16x16x32_bf16 v[188:191], a[216:219], v[108:111], v[188:191]
    ds_read_b64_tr_b16 a[230:231], v4 offset:6144
    v_xor_b32 v4, 32, v3
    v_mfma_f32_16x16x32_bf16 v[192:195], a[216:219], v[112:115], v[192:195]
    s_add_u32 s22, s22, 8192
    s_sub_u32 s24, s22, s99
    s_min_u32 s22, s22, s24
    v_mfma_f32_16x16x32_bf16 v[196:199], a[216:219], v[116:119], v[196:199]
    s_add_u32 s32, s32, 16384
    v_mfma_f32_16x16x32_bf16 v[200:203], a[216:219], v[120:123], v[200:203]
    ds_read_b64_tr_b16 a[216:217], v3 offset:0
    v_mfma_f32_16x16x32_bf16 v[204:207], a[220:223], v[108:111], v[204:207]
    ds_read_b64_tr_b16 a[218:219], v3 offset:4096
    v_mfma_f32_16x16x32_bf16 v[208:211], a[220:223], v[112:115], v[208:211]
    buffer_load_dwordx4 v1, s[4:7], s16 offen lds
    v_mfma_f32_16x16x32_bf16 v[212:215], a[220:223], v[116:119], v[212:215]
    v_mfma_f32_16x16x32_bf16 v[216:219], a[220:223], v[120:123], v[216:219]
    ds_read_b64_tr_b16 a[220:221], v4 offset:0
    s_waitcnt lgkmcnt(3)
    v_mfma_f32_16x16x32_bf16 v[188:191], a[224:227], a[80:83], v[188:191]
    ds_read_b64_tr_b16 a[222:223], v4 offset:4096
    v_mfma_f32_16x16x32_bf16 v[192:195], a[224:227], a[84:87], v[192:195]
    buffer_load_dwordx4 v1, s[8:11], s16 offen offset:1024 lds
    v_mfma_f32_16x16x32_bf16 v[196:199], a[224:227], a[88:91], v[196:199]
    s_add_u32 s19, m0, 8192
    s_sub_u32 s21, s19, s99
    s_min_u32 m0, s19, s21
    v_mfma_f32_16x16x32_bf16 v[200:203], a[224:227], a[92:95], v[200:203]
    ds_read_b64_tr_b16 a[224:225], v3 offset:2048
    s_add_u32 s16, s16, s17
    v_mfma_f32_16x16x32_bf16 v[204:207], a[228:231], a[80:83], v[204:207]
    ds_read_b64_tr_b16 a[226:227], v3 offset:6144
    v_xor_b32 v3, s22, v6
    v_mfma_f32_16x16x32_bf16 v[208:211], a[228:231], a[84:87], v[208:211]
    s_add_u32 s20, s16, s18
    s_min_u32 s16, s16, s20
    v_mfma_f32_16x16x32_bf16 v[212:215], a[228:231], a[88:91], v[212:215]
    v_mfma_f32_16x16x32_bf16 v[216:219], a[228:231], a[92:95], v[216:219]
    ds_read_b64_tr_b16 a[228:229], v4 offset:2048
    s_waitcnt lgkmcnt(3)
    v_mfma_f32_16x16x32_bf16 v[188:191], a[216:219], v[124:127], v[188:191]
    ds_read_b64_tr_b16 a[230:231], v4 offset:6144
    v_xor_b32 v4, 32, v3
    v_mfma_f32_16x16x32_bf16 v[192:195], a[216:219], v[128:131], v[192:195]
    s_add_u32 s22, s22, 8192
    s_sub_u32 s24, s22, s99
    s_min_u32 s22, s22, s24
    v_mfma_f32_16x16x32_bf16 v[196:199], a[216:219], v[132:135], v[196:199]
    s_waitcnt vmcnt(11)
    s_barrier
    v_mfma_f32_16x16x32_bf16 v[200:203], a[216:219], v[136:139], v[200:203]
    ds_read_b64_tr_b16 a[216:217], v3 offset:0
    v_mfma_f32_16x16x32_bf16 v[204:207], a[220:223], v[124:127], v[204:207]
    ds_read_b64_tr_b16 a[218:219], v3 offset:4096
    v_mfma_f32_16x16x32_bf16 v[208:211], a[220:223], v[128:131], v[208:211]
    buffer_load_dwordx4 v1, s[4:7], s16 offen lds
    v_mfma_f32_16x16x32_bf16 v[212:215], a[220:223], v[132:135], v[212:215]
    v_mfma_f32_16x16x32_bf16 v[216:219], a[220:223], v[136:139], v[216:219]
    ds_read_b64_tr_b16 a[220:221], v4 offset:0
    s_waitcnt lgkmcnt(3)
    v_mfma_f32_16x16x32_bf16 v[188:191], a[224:227], a[96:99], v[188:191]
    ds_read_b64_tr_b16 a[222:223], v4 offset:4096
    v_mfma_f32_16x16x32_bf16 v[192:195], a[224:227], a[100:103], v[192:195]
    buffer_load_dwordx4 v1, s[8:11], s16 offen offset:1024 lds
    v_mfma_f32_16x16x32_bf16 v[196:199], a[224:227], a[104:107], v[196:199]
    s_add_u32 s19, m0, 8192
    s_sub_u32 s21, s19, s99
    s_min_u32 m0, s19, s21
    v_mfma_f32_16x16x32_bf16 v[200:203], a[224:227], a[108:111], v[200:203]
    ds_read_b64_tr_b16 a[224:225], v3 offset:2048
    s_add_u32 s16, s16, s17
    v_mfma_f32_16x16x32_bf16 v[204:207], a[228:231], a[96:99], v[204:207]
    ds_read_b64_tr_b16 a[226:227], v3 offset:6144
    v_xor_b32 v3, s22, v6
    v_mfma_f32_16x16x32_bf16 v[208:211], a[228:231], a[100:103], v[208:211]
    s_add_u32 s20, s16, s18
    s_min_u32 s16, s16, s20
    v_mfma_f32_16x16x32_bf16 v[212:215], a[228:231], a[104:107], v[212:215]
    v_mfma_f32_16x16x32_bf16 v[216:219], a[228:231], a[108:111], v[216:219]
    ds_read_b64_tr_b16 a[228:229], v4 offset:2048
    s_waitcnt lgkmcnt(3)
    v_mfma_f32_16x16x32_bf16 v[188:191], a[216:219], v[140:143], v[188:191]
    ds_read_b64_tr_b16 a[230:231], v4 offset:6144
    v_xor_b32 v4, 32, v3
    v_mfma_f32_16x16x32_bf16 v[192:195], a[216:219], v[144:147], v[192:195]
    s_add_u32 s22, s22, 8192
    s_sub_u32 s24, s22, s99
    s_min_u32 s22, s22, s24
    v_mfma_f32_16x16x32_bf16 v[196:199], a[216:219], v[148:151], v[196:199]
    buffer_load_dwordx4 v1, s[4:7], s16 offen lds
    v_mfma_f32_16x16x32_bf16 v[200:203], a[216:219], v[152:155], v[200:203]
    ds_read_b64_tr_b16 a[216:217], v3 offset:0
    v_mfma_f32_16x16x32_bf16 v[204:207], a[220:223], v[140:143], v[204:207]
    ds_read_b64_tr_b16 a[218:219], v3 offset:4096
    v_mfma_f32_16x16x32_bf16 v[208:211], a[220:223], v[144:147], v[208:211]
    buffer_load_dwordx4 v1, s[8:11], s16 offen offset:1024 lds
    v_mfma_f32_16x16x32_bf16 v[212:215], a[220:223], v[148:151], v[212:215]
    s_add_u32 s19, m0, 8192
    s_sub_u32 s21, s19, s99
    s_min_u32 m0, s19, s21
    v_mfma_f32_16x16x32_bf16 v[216:219], a[220:223], v[152:155], v[216:219]
    ds_read_b64_tr_b16 a[220:221], v4 offset:0
    s_waitcnt lgkmcnt(3)
    v_mfma_f32_16x16x32_bf16 v[188:191], a[224:227], a[112:115], v[188:191]
    ds_read_b64_tr_b16 a[222:223], v4 offset:4096
    s_add_u32 s16, s16, s17
    v_mfma_f32_16x16x32_bf16 v[192:195], a[224:227], a[116:119], v[192:195]
    s_add_u32 s20, s16, s18
    s_min_u32 s16, s16, s20
    v_mfma_f32_16x16x32_bf16 v[196:199], a[224:227], a[120:123], v[196:199]
    v_mfma_f32_16x16x32_bf16 v[200:203], a[224:227], a[124:127], v[200:203]
    ds_read_b64_tr_b16 a[224:225], v3 offset:2048
    v_mfma_f32_16x16x32_bf16 v[204:207], a[228:231], a[112:115], v[204:207]
    ds_read_b64_tr_b16 a[226:227], v3 offset:6144
    v_xor_b32 v3, s22, v6
    v_mfma_f32_16x16x32_bf16 v[208:211], a[228:231], a[116:119], v[208:211]
    v_mfma_f32_16x16x32_bf16 v[212:215], a[228:231], a[120:123], v[212:215]
    v_mfma_f32_16x16x32_bf16 v[216:219], a[228:231], a[124:127], v[216:219]
    ds_read_b64_tr_b16 a[228:229], v4 offset:2048
    s_waitcnt lgkmcnt(3)
TF_F2e8:
    v_mfma_f32_16x16x32_bf16 v[188:191], a[216:219], v[156:159], v[188:191]
    ds_read_b64_tr_b16 a[230:231], v4 offset:6144
    v_xor_b32 v4, 32, v3
    v_mfma_f32_16x16x32_bf16 v[192:195], a[216:219], v[160:163], v[192:195]
    buffer_load_dwordx4 v1, s[4:7], s16 offen lds
    v_mfma_f32_16x16x32_bf16 v[196:199], a[216:219], v[164:167], v[196:199]
    s_sub_u32 s25, s25, 1
    s_cbranch_scc0 TF_F27
    v_mfma_f32_16x16x32_bf16 v[200:203], a[216:219], v[168:171], v[200:203]
    ds_read_b64_tr_b16 a[216:217], v3 offset:0
    s_and_b32 s34, s30, 7
    v_mfma_f32_16x16x32_bf16 v[204:207], a[220:223], v[156:159], v[204:207]
    ds_read_b64_tr_b16 a[218:219], v3 offset:4096
    s_mul_i32 s40, s29, 2359296
    v_mfma_f32_16x16x32_bf16 v[208:211], a[220:223], v[160:163], v[208:211]
    s_lshl_b32 s24, s34, 10
    s_add_u32 s40, s40, s24
    s_lshl_b32 s24, s26, 13
    v_mfma_f32_16x16x32_bf16 v[212:215], a[220:223], v[164:167], v[212:215]
    s_add_u32 s40, s40, s24
    s_lshl_b32 s41, s34, 4
    s_lshl_b32 s24, s29, 7
    v_mfma_f32_16x16x32_bf16 v[216:219], a[220:223], v[168:171], v[216:219]
    s_add_u32 s41, s41, s24
    v_lshrrev_b32 v253, 2, v0
    v_mul_u32_u24 v253, 1152, v253
    s_waitcnt lgkmcnt(4)
    v_mfma_f32_16x16x32_bf16 v[188:191], a[224:227], a[144:147], v[188:191]
    s_mul_i32 s41, s41, 1152
    v_and_b32 v254, 3, v0
    s_lshl_b32 s24, s26, 6
    v_mfma_f32_16x16x32_bf16 v[192:195], a[224:227], a[148:151], v[192:195]
    s_mov_b64 s[76:77], s[88:89]
    s_mov_b32 s78, 2359296
    s_mov_b32 s79, 0x00020000
    v_mfma_f32_16x16x32_bf16 v[196:199], a[224:227], a[152:155], v[196:199]
    s_add_u32 s41, s41, s24
    v_lshl_add_u32 v253, v254, 4, v253
    v_and_b32 v254, 15, v0
    v_mfma_f32_16x16x32_bf16 v[200:203], a[224:227], a[156:159], v[200:203]
    buffer_load_dwordx4 a[232:235], v253, s[76:79], s41 offen offset:0
    buffer_load_dwordx4 a[236:239], v253, s[76:79], s41 offen offset:256
    ds_read_b64_tr_b16 a[220:221], v4 offset:0
    ds_read_b64_tr_b16 a[222:223], v4 offset:4096
    buffer_load_dwordx4 a[240:243], v253, s[76:79], s41 offen offset:512
    buffer_load_dwordx4 a[244:247], v253, s[76:79], s41 offen offset:768
    v_lshlrev_b32 v254, 2, v254
    s_add_u32 s19, m0, 8192
    buffer_load_dwordx4 a[248:251], v253, s[76:79], s41 offen offset:1024
    buffer_load_dword v8, v254, s[12:15], s81 offen sc1
    buffer_load_dwordx4 v1, s[8:11], s16 offen offset:1024 lds
    s_waitcnt lgkmcnt(4)
    v_mfma_f32_16x16x32_bf16 v[204:207], a[228:231], a[144:147], v[204:207]
    ds_read_b64_tr_b16 a[224:225], v3 offset:2048
    s_add_u32 s16, s16, s17
    v_mfma_f32_16x16x32_bf16 v[208:211], a[228:231], a[148:151], v[208:211]
    ds_read_b64_tr_b16 a[226:227], v3 offset:6144
    s_sub_u32 s21, s19, s99
    v_mfma_f32_16x16x32_bf16 v[212:215], a[228:231], a[152:155], v[212:215]
    s_add_u32 s20, s16, s18
    s_min_u32 m0, s19, s21
    s_min_u32 s16, s16, s20
    v_mfma_f32_16x16x32_bf16 v[216:219], a[228:231], a[156:159], v[216:219]
    ds_read_b64_tr_b16 a[228:229], v4 offset:2048
    s_add_u32 s19, m0, 8192
    s_waitcnt lgkmcnt(5)
    v_mfma_f32_16x16x32_bf16 v[188:191], a[216:219], v[172:175], v[188:191]
    ds_read_b64_tr_b16 a[230:231], v4 offset:6144
    s_sub_u32 s21, s19, s99
    v_mfma_f32_16x16x32_bf16 v[192:195], a[216:219], v[176:179], v[192:195]
    buffer_load_dwordx4 v1, s[4:7], s16 offen lds
    v_mfma_f32_16x16x32_bf16 v[196:199], a[216:219], v[180:183], v[196:199]
    s_add_u32 s40, s40, 4194304
    s_mov_b64 s[72:73], s[90:91]
    s_mov_b32 s74, 2359296
    v_mfma_f32_16x16x32_bf16 v[200:203], a[216:219], v[184:187], v[200:203]
    s_mov_b32 s75, 0x00020000
    s_mov_b32 s87, 0x40000
    s_waitcnt lgkmcnt(4)
    v_mfma_f32_16x16x32_bf16 v[204:207], a[220:223], v[172:175], v[204:207]
    buffer_load_dwordx4 v1, s[8:11], s16 offen offset:1024 lds
    v_mfma_f32_16x16x32_bf16 v[208:211], a[220:223], v[176:179], v[208:211]
    s_add_u32 s16, s16, s17
    s_add_u32 s20, s16, s18
    s_min_u32 m0, s19, s21
    v_mfma_f32_16x16x32_bf16 v[212:215], a[220:223], v[180:183], v[212:215]
    s_min_u32 s16, s16, s20
    v_mfma_f32_16x16x32_bf16 v[216:219], a[220:223], v[184:187], v[216:219]
    s_waitcnt lgkmcnt(2)
    v_mfma_f32_16x16x32_bf16 v[188:191], a[224:227], a[160:163], v[188:191]
    v_mfma_f32_16x16x32_bf16 v[192:195], a[224:227], a[164:167], v[192:195]
    v_mfma_f32_16x16x32_bf16 v[196:199], a[224:227], a[168:171], v[196:199]
    s_nop 5
    v_cvt_pk_bf16_f32 v220, v188, v189
    v_mfma_f32_16x16x32_bf16 v[200:203], a[224:227], a[172:175], v[200:203]
    v_cvt_pk_bf16_f32 v221, v190, v191
    v_cvt_pk_bf16_f32 v224, v192, v193
    s_waitcnt lgkmcnt(0)
    v_mfma_f32_16x16x32_bf16 v[204:207], a[228:231], a[160:163], v[204:207]
    v_cvt_pk_bf16_f32 v225, v194, v195
    v_cvt_pk_bf16_f32 v228, v196, v197
    v_mfma_f32_16x16x32_bf16 v[208:211], a[228:231], a[164:167], v[208:211]
    v_cvt_pk_bf16_f32 v229, v198, v199
    v_cvt_pk_bf16_f32 v232, v200, v201
    v_mfma_f32_16x16x32_bf16 v[212:215], a[228:231], a[168:171], v[212:215]
    s_nop 1
    v_cvt_pk_bf16_f32 v222, v204, v205
    v_mfma_f32_16x16x32_bf16 v[216:219], a[228:231], a[172:175], v[216:219]
    v_cvt_pk_bf16_f32 v223, v206, v207
    v_cvt_pk_bf16_f32 v226, v208, v209
    v_cvt_pk_bf16_f32 v227, v210, v211
    v_cvt_pk_bf16_f32 v233, v202, v203
    buffer_store_dwordx4 v[220:223], v9, s[12:15], s33 offen offset:0 sc1
    v_cvt_pk_bf16_f32 v230, v212, v213
    v_cvt_pk_bf16_f32 v231, v214, v215
    s_nop 0
    v_cvt_pk_bf16_f32 v234, v216, v217
    v_cvt_pk_bf16_f32 v235, v218, v219
    buffer_store_dwordx4 v[224:227], v9, s[12:15], s33 offen offset:1024 sc1
    buffer_store_dwordx4 v[228:231], v9, s[12:15], s33 offen offset:2048 sc1
    buffer_store_dwordx4 v[232:235], v9, s[12:15], s33 offen offset:3072 sc1
    v_mov_b32 v31, 9
    s_waitcnt vmcnt(0)
    s_barrier
    s_mov_b64 exec, s[38:39]
    buffer_store_dword v31, v28, s[12:15], s35 offen sc1
    s_mov_b64 exec, -1
    s_branch TAIL_start
TF_RP3:
    s_mov_b32 s25, 0x40000
TF_RP3l:
    buffer_load_dword v64, off, s[64:67], s95 sc1
    s_waitcnt vmcnt(0)
    v_readfirstlane_b32 s34, v64
    s_nop 3
    s_cmp_lg_u32 s34, 0
    s_cbranch_scc1 TF_RB4
    s_sleep 2
    s_sub_u32 s25, s25, 1
    s_cbranch_scc0 TF_RP3l
    s_branch TF_RB4
.p2align 6
TAIL_start:
    v_mov_b32 v15, v253
    v_mov_b32 v14, v254
    s_mov_b32 s94, 0xffff0000
    s_mov_b32 s53, 1040356334
    s_mov_b64 s[42:43], 0
    s_mov_b32 s44, 0
    s_mov_b32 s45, 0
    s_mul_i32 s46, s28, 0xffff
    s_mov_b32 s54, 0
    s_sub_u32 s55, 4, s28
    s_lshl_b32 s47, s28, 4
    s_lshl_b32 s24, s26, 13
    v_add_u32 v23, s24, v9
    v_and_b32 v22, 15, v0
    v_lshlrev_b32 v22, 6, v22
    v_lshrrev_b32 v2, 4, v0
    v_lshl_add_u32 v22, v2, 3, v22
    v_add_u32 v22, s24, v22
    v_mov_b32 v6, 0
    v_mov_b32 v40, 0x3f80
    v_and_b32 v36, 1, v0
    v_lshlrev_b32 v36, 4, v36
    v_lshlrev_b32 v36, v36, v40
    v_lshlrev_b32 v37, 1, v2
    v_bfe_u32 v41, v0, 1, 3
    v_cmp_eq_u32 vcc, v37, v41
    s_nop 1
    v_cndmask_b32 v38, 0, v36, vcc
    v_add_u32 v37, 1, v37
    v_cmp_eq_u32 vcc, v37, v41
    s_nop 1
    v_cndmask_b32 v39, 0, v36, vcc
    v_mov_b32 v36, 0
    v_mov_b32 v37, 0
    v_mov_b32 v40, 0
    v_mov_b32 v41, 0
    v_add_u32 v16, 0, v9
    v_add_u32 v17, 32768, v9
    v_add_u32 v18, 65536, v9
    v_add_u32 v19, 98304, v9
    v_add_u32 v20, 131072, v9
    s_add_u32 s56, s40, 0
    s_add_u32 s57, s40, 294912
    s_add_u32 s58, s40, 589824
    s_add_u32 s59, s40, 884736
    s_add_u32 s60, s40, 1179648
    s_add_u32 s61, s40, 1474560
    s_add_u32 s62, s40, 1769472
    s_add_u32 s63, s40, 2064384
    v_add_u32 v28, 147456, v16
    v_add_u32 v29, 147456, v17
    v_add_u32 v30, 147456, v18
    v_add_u32 v31, 147456, v19
    v_add_u32 v32, 147456, v20
    v_mov_b32 v5, v8
    s_branch TAILGO
TAILL:
    v_mov_b32 v6, v5
    buffer_load_dword v5, v14, s[12:15], s81 offen sc1
    s_waitcnt vmcnt(0)
    s_sub_u32 s87, s87, 1
    s_cbranch_scc0 TAILGO
    s_mov_b32 s87, 0
    v_mov_b32 v5, 9
TAILGO:
    s_mov_b64 s[48:49], s[42:43]
    s_mov_b64 s[50:51], s[44:45]
    s_mov_b32 s52, s46
    s_mov_b32 s16, 0
    s_add_u32 s17, s28, 0
    v_cmp_lt_i32 vcc, s17, v5
    s_nop 3
    s_andn2_b32 s18, vcc_lo, s42
    s_and_b32 s18, s18, 0xffff
    s_cbranch_scc0 TAILN0
    s_or_b32 s42, s42, s18
    s_bcnt1_i32_b32 s34, s18
    s_add_u32 s16, s16, s34
    s_bitcmp1_b32 s18, 0
    s_cbranch_scc0 TAILK0_0
    buffer_load_dwordx4 a[160:163], v16, s[12:15], s56 offen sc1
TAILK0_0:
    s_bitcmp1_b32 s18, 1
    s_cbranch_scc0 TAILK0_1
    buffer_load_dwordx4 a[164:167], v28, s[12:15], s56 offen sc1
TAILK0_1:
    s_bitcmp1_b32 s18, 2
    s_cbranch_scc0 TAILK0_2
    buffer_load_dwordx4 a[168:171], v16, s[12:15], s57 offen sc1
TAILK0_2:
    s_bitcmp1_b32 s18, 3
    s_cbranch_scc0 TAILK0_3
    buffer_load_dwordx4 a[172:175], v28, s[12:15], s57 offen sc1
TAILK0_3:
    s_bitcmp1_b32 s18, 4
    s_cbranch_scc0 TAILK0_4
    buffer_load_dwordx4 a[176:179], v16, s[12:15], s58 offen sc1
TAILK0_4:
    s_bitcmp1_b32 s18, 5
    s_cbranch_scc0 TAILK0_5
    buffer_load_dwordx4 a[180:183], v28, s[12:15], s58 offen sc1
TAILK0_5:
    s_bitcmp1_b32 s18, 6
    s_cbranch_scc0 TAILK0_6
    buffer_load_dwordx4 a[184:187], v16, s[12:15], s59 offen sc1
TAILK0_6:
    s_bitcmp1_b32 s18, 7
    s_cbranch_scc0 TAILK0_7
    buffer_load_dwordx4 a[188:191], v28, s[12:15], s59 offen sc1
TAILK0_7:
    s_bitcmp1_b32 s18, 8
    s_cbranch_scc0 TAILK0_8
    buffer_load_dwordx4 a[0:3], v16, s[12:15], s60 offen sc1
TAILK0_8:
    s_bitcmp1_b32 s18, 9
    s_cbranch_scc0 TAILK0_9
    buffer_load_dwordx4 a[20:23], v28, s[12:15], s60 offen sc1
TAILK0_9:
    s_bitcmp1_b32 s18, 10
    s_cbranch_scc0 TAILK0_10
    buffer_load_dwordx4 a[40:43], v16, s[12:15], s61 offen sc1
TAILK0_10:
    s_bitcmp1_b32 s18, 11
    s_cbranch_scc0 TAILK0_11
    buffer_load_dwordx4 a[60:63], v28, s[12:15], s61 offen sc1
TAILK0_11:
    s_bitcmp1_b32 s18, 12
    s_cbranch_scc0 TAILK0_12
    buffer_load_dwordx4 a[80:83], v16, s[12:15], s62 offen sc1
TAILK0_12:
    s_bitcmp1_b32 s18, 13
    s_cbranch_scc0 TAILK0_13
    buffer_load_dwordx4 a[100:103], v28, s[12:15], s62 offen sc1
TAILK0_13:
    s_bitcmp1_b32 s18, 14
    s_cbranch_scc0 TAILK0_14
    buffer_load_dwordx4 a[120:123], v16, s[12:15], s63 offen sc1
TAILK0_14:
    s_bitcmp1_b32 s18, 15
    s_cbranch_scc0 TAILK0_15
    buffer_load_dwordx4 a[140:143], v28, s[12:15], s63 offen sc1
TAILK0_15:
    s_cmp_ge_u32 s16, 16
    s_cbranch_scc1 TAILN4
TAILN0:
    s_add_u32 s17, s28, 2
    v_cmp_lt_i32 vcc, s17, v5
    s_nop 3
    s_andn2_b32 s18, vcc_lo, s43
    s_and_b32 s18, s18, 0xffff
    s_cbranch_scc0 TAILN1
    s_or_b32 s43, s43, s18
    s_bcnt1_i32_b32 s34, s18
    s_add_u32 s16, s16, s34
    s_bitcmp1_b32 s18, 0
    s_cbranch_scc0 TAILK1_0
    buffer_load_dwordx4 a[192:195], v17, s[12:15], s56 offen sc1
TAILK1_0:
    s_bitcmp1_b32 s18, 1
    s_cbranch_scc0 TAILK1_1
    buffer_load_dwordx4 a[196:199], v29, s[12:15], s56 offen sc1
TAILK1_1:
    s_bitcmp1_b32 s18, 2
    s_cbranch_scc0 TAILK1_2
    buffer_load_dwordx4 a[200:203], v17, s[12:15], s57 offen sc1
TAILK1_2:
    s_bitcmp1_b32 s18, 3
    s_cbranch_scc0 TAILK1_3
    buffer_load_dwordx4 a[204:207], v29, s[12:15], s57 offen sc1
TAILK1_3:
    s_bitcmp1_b32 s18, 4
    s_cbranch_scc0 TAILK1_4
    buffer_load_dwordx4 a[208:211], v17, s[12:15], s58 offen sc1
TAILK1_4:
    s_bitcmp1_b32 s18, 5
    s_cbranch_scc0 TAILK1_5
    buffer_load_dwordx4 a[212:215], v29, s[12:15], s58 offen sc1
TAILK1_5:
    s_bitcmp1_b32 s18, 6
    s_cbranch_scc0 TAILK1_6
    buffer_load_dwordx4 a[216:219], v17, s[12:15], s59 offen sc1
TAILK1_6:
    s_bitcmp1_b32 s18, 7
    s_cbranch_scc0 TAILK1_7
    buffer_load_dwordx4 a[220:223], v29, s[12:15], s59 offen sc1
TAILK1_7:
    s_bitcmp1_b32 s18, 8
    s_cbranch_scc0 TAILK1_8
    buffer_load_dwordx4 a[4:7], v17, s[12:15], s60 offen sc1
TAILK1_8:
    s_bitcmp1_b32 s18, 9
    s_cbranch_scc0 TAILK1_9
    buffer_load_dwordx4 a[24:27], v29, s[12:15], s60 offen sc1
TAILK1_9:
    s_bitcmp1_b32 s18, 10
    s_cbranch_scc0 TAILK1_10
    buffer_load_dwordx4 a[44:47], v17, s[12:15], s61 offen sc1
TAILK1_10:
    s_bitcmp1_b32 s18, 11
    s_cbranch_scc0 TAILK1_11
    buffer_load_dwordx4 a[64:67], v29, s[12:15], s61 offen sc1
TAILK1_11:
    s_bitcmp1_b32 s18, 12
    s_cbranch_scc0 TAILK1_12
    buffer_load_dwordx4 a[84:87], v17, s[12:15], s62 offen sc1
TAILK1_12:
    s_bitcmp1_b32 s18, 13
    s_cbranch_scc0 TAILK1_13
    buffer_load_dwordx4 a[104:107], v29, s[12:15], s62 offen sc1
TAILK1_13:
    s_bitcmp1_b32 s18, 14
    s_cbranch_scc0 TAILK1_14
    buffer_load_dwordx4 a[124:127], v17, s[12:15], s63 offen sc1
TAILK1_14:
    s_bitcmp1_b32 s18, 15
    s_cbranch_scc0 TAILK1_15
    buffer_load_dwordx4 a[144:147], v29, s[12:15], s63 offen sc1
TAILK1_15:
    s_cmp_ge_u32 s16, 16
    s_cbranch_scc1 TAILN4
TAILN1:
    s_add_u32 s17, s28, 4
    v_cmp_lt_i32 vcc, s17, v5
    s_nop 3
    s_andn2_b32 s18, vcc_lo, s44
    s_and_b32 s18, s18, 0xffff
    s_cbranch_scc0 TAILN2
    s_or_b32 s44, s44, s18
    s_bcnt1_i32_b32 s34, s18
    s_add_u32 s16, s16, s34
    s_bitcmp1_b32 s18, 0
    s_cbranch_scc0 TAILK2_0
    buffer_load_dwordx4 v[132:135], v18, s[12:15], s56 offen sc1
TAILK2_0:
    s_bitcmp1_b32 s18, 1
    s_cbranch_scc0 TAILK2_1
    buffer_load_dwordx4 v[136:139], v30, s[12:15], s56 offen sc1
TAILK2_1:
    s_bitcmp1_b32 s18, 2
    s_cbranch_scc0 TAILK2_2
    buffer_load_dwordx4 v[140:143], v18, s[12:15], s57 offen sc1
TAILK2_2:
    s_bitcmp1_b32 s18, 3
    s_cbranch_scc0 TAILK2_3
    buffer_load_dwordx4 v[144:147], v30, s[12:15], s57 offen sc1
TAILK2_3:
    s_bitcmp1_b32 s18, 4
    s_cbranch_scc0 TAILK2_4
    buffer_load_dwordx4 v[148:151], v18, s[12:15], s58 offen sc1
TAILK2_4:
    s_bitcmp1_b32 s18, 5
    s_cbranch_scc0 TAILK2_5
    buffer_load_dwordx4 v[152:155], v30, s[12:15], s58 offen sc1
TAILK2_5:
    s_bitcmp1_b32 s18, 6
    s_cbranch_scc0 TAILK2_6
    buffer_load_dwordx4 v[156:159], v18, s[12:15], s59 offen sc1
TAILK2_6:
    s_bitcmp1_b32 s18, 7
    s_cbranch_scc0 TAILK2_7
    buffer_load_dwordx4 v[160:163], v30, s[12:15], s59 offen sc1
TAILK2_7:
    s_bitcmp1_b32 s18, 8
    s_cbranch_scc0 TAILK2_8
    buffer_load_dwordx4 a[8:11], v18, s[12:15], s60 offen sc1
TAILK2_8:
    s_bitcmp1_b32 s18, 9
    s_cbranch_scc0 TAILK2_9
    buffer_load_dwordx4 a[28:31], v30, s[12:15], s60 offen sc1
TAILK2_9:
    s_bitcmp1_b32 s18, 10
    s_cbranch_scc0 TAILK2_10
    buffer_load_dwordx4 a[48:51], v18, s[12:15], s61 offen sc1
TAILK2_10:
    s_bitcmp1_b32 s18, 11
    s_cbranch_scc0 TAILK2_11
    buffer_load_dwordx4 a[68:71], v30, s[12:15], s61 offen sc1
TAILK2_11:
    s_bitcmp1_b32 s18, 12
    s_cbranch_scc0 TAILK2_12
    buffer_load_dwordx4 a[88:91], v18, s[12:15], s62 offen sc1
TAILK2_12:
    s_bitcmp1_b32 s18, 13
    s_cbranch_scc0 TAILK2_13
    buffer_load_dwordx4 a[108:111], v30, s[12:15], s62 offen sc1
TAILK2_13:
    s_bitcmp1_b32 s18, 14
    s_cbranch_scc0 TAILK2_14
    buffer_load_dwordx4 a[128:131], v18, s[12:15], s63 offen sc1
TAILK2_14:
    s_bitcmp1_b32 s18, 15
    s_cbranch_scc0 TAILK2_15
    buffer_load_dwordx4 a[148:151], v30, s[12:15], s63 offen sc1
TAILK2_15:
    s_cmp_ge_u32 s16, 16
    s_cbranch_scc1 TAILN4
TAILN2:
    s_add_u32 s17, s28, 5
    v_cmp_lt_i32 vcc, s17, v5
    s_nop 3
    s_and_b32 s19, vcc_lo, 0xff
    s_cmp_eq_u32 s19, 0xff
    s_cselect_b32 s19, -1, 0xff00
    s_add_u32 s17, s28, 6
    v_cmp_lt_i32 vcc, s17, v5
    s_nop 3
    s_or_b32 s18, vcc_lo, 0xff
    s_and_b32 s18, s18, s19
    s_andn2_b32 s18, s18, s45
    s_and_b32 s18, s18, 0xffff
    s_cbranch_scc0 TAILN3
    s_or_b32 s45, s45, s18
    s_bcnt1_i32_b32 s34, s18
    s_add_u32 s16, s16, s34
    s_bitcmp1_b32 s18, 0
    s_cbranch_scc0 TAILK3_0
    buffer_load_dwordx4 v[164:167], v19, s[12:15], s56 offen sc1
TAILK3_0:
    s_bitcmp1_b32 s18, 1
    s_cbranch_scc0 TAILK3_1
    buffer_load_dwordx4 v[168:171], v31, s[12:15], s56 offen sc1
TAILK3_1:
    s_bitcmp1_b32 s18, 2
    s_cbranch_scc0 TAILK3_2
    buffer_load_dwordx4 v[172:175], v19, s[12:15], s57 offen sc1
TAILK3_2:
    s_bitcmp1_b32 s18, 3
    s_cbranch_scc0 TAILK3_3
    buffer_load_dwordx4 v[176:179], v31, s[12:15], s57 offen sc1
TAILK3_3:
    s_bitcmp1_b32 s18, 4
    s_cbranch_scc0 TAILK3_4
    buffer_load_dwordx4 v[180:183], v19, s[12:15], s58 offen sc1
TAILK3_4:
    s_bitcmp1_b32 s18, 5
    s_cbranch_scc0 TAILK3_5
    buffer_load_dwordx4 v[184:187], v31, s[12:15], s58 offen sc1
TAILK3_5:
    s_bitcmp1_b32 s18, 6
    s_cbranch_scc0 TAILK3_6
    buffer_load_dwordx4 v[188:191], v19, s[12:15], s59 offen sc1
TAILK3_6:
    s_bitcmp1_b32 s18, 7
    s_cbranch_scc0 TAILK3_7
    buffer_load_dwordx4 v[192:195], v31, s[12:15], s59 offen sc1
TAILK3_7:
    s_bitcmp1_b32 s18, 8
    s_cbranch_scc0 TAILK3_8
    buffer_load_dwordx4 a[12:15], v19, s[12:15], s60 offen sc1
TAILK3_8:
    s_bitcmp1_b32 s18, 9
    s_cbranch_scc0 TAILK3_9
    buffer_load_dwordx4 a[32:35], v31, s[12:15], s60 offen sc1
TAILK3_9:
    s_bitcmp1_b32 s18, 10
    s_cbranch_scc0 TAILK3_10
    buffer_load_dwordx4 a[52:55], v19, s[12:15], s61 offen sc1
TAILK3_10:
    s_bitcmp1_b32 s18, 11
    s_cbranch_scc0 TAILK3_11
    buffer_load_dwordx4 a[72:75], v31, s[12:15], s61 offen sc1
TAILK3_11:
    s_bitcmp1_b32 s18, 12
    s_cbranch_scc0 TAILK3_12
    buffer_load_dwordx4 a[92:95], v19, s[12:15], s62 offen sc1
TAILK3_12:
    s_bitcmp1_b32 s18, 13
    s_cbranch_scc0 TAILK3_13
    buffer_load_dwordx4 a[112:115], v31, s[12:15], s62 offen sc1
TAILK3_13:
    s_bitcmp1_b32 s18, 14
    s_cbranch_scc0 TAILK3_14
    buffer_load_dwordx4 a[132:135], v19, s[12:15], s63 offen sc1
TAILK3_14:
    s_bitcmp1_b32 s18, 15
    s_cbranch_scc0 TAILK3_15
    buffer_load_dwordx4 a[152:155], v31, s[12:15], s63 offen sc1
TAILK3_15:
    s_cmp_ge_u32 s16, 16
    s_cbranch_scc1 TAILN4
TAILN3:
    s_add_u32 s17, s28, 6
    v_cmp_lt_i32 vcc, s17, v5
    s_nop 3
    s_and_b32 s19, vcc_lo, 0xff
    s_cmp_eq_u32 s19, 0xff
    s_cselect_b32 s19, -1, 0xff00
    s_add_u32 s17, s28, 8
    v_cmp_lt_i32 vcc, s17, v5
    s_nop 3
    s_or_b32 s18, vcc_lo, 0xff
    s_and_b32 s18, s18, s19
    s_andn2_b32 s18, s18, s46
    s_and_b32 s18, s18, 0xffff
    s_cbranch_scc0 TAILN4
    s_or_b32 s46, s46, s18
    s_bcnt1_i32_b32 s34, s18
    s_add_u32 s16, s16, s34
    s_bitcmp1_b32 s18, 0
    s_cbranch_scc0 TAILK4_0
    buffer_load_dwordx4 v[196:199], v20, s[12:15], s56 offen sc1
TAILK4_0:
    s_bitcmp1_b32 s18, 1
    s_cbranch_scc0 TAILK4_1
    buffer_load_dwordx4 v[200:203], v32, s[12:15], s56 offen sc1
TAILK4_1:
    s_bitcmp1_b32 s18, 2
    s_cbranch_scc0 TAILK4_2
    buffer_load_dwordx4 v[204:207], v20, s[12:15], s57 offen sc1
TAILK4_2:
    s_bitcmp1_b32 s18, 3
    s_cbranch_scc0 TAILK4_3
    buffer_load_dwordx4 v[208:211], v32, s[12:15], s57 offen sc1
TAILK4_3:
    s_bitcmp1_b32 s18, 4
    s_cbranch_scc0 TAILK4_4
    buffer_load_dwordx4 v[212:215], v20, s[12:15], s58 offen sc1
TAILK4_4:
    s_bitcmp1_b32 s18, 5
    s_cbranch_scc0 TAILK4_5
    buffer_load_dwordx4 v[216:219], v32, s[12:15], s58 offen sc1
TAILK4_5:
    s_bitcmp1_b32 s18, 6
    s_cbranch_scc0 TAILK4_6
    buffer_load_dwordx4 v[220:223], v20, s[12:15], s59 offen sc1
TAILK4_6:
    s_bitcmp1_b32 s18, 7
    s_cbranch_scc0 TAILK4_7
    buffer_load_dwordx4 v[224:227], v32, s[12:15], s59 offen sc1
TAILK4_7:
    s_bitcmp1_b32 s18, 8
    s_cbranch_scc0 TAILK4_8
    buffer_load_dwordx4 a[16:19], v20, s[12:15], s60 offen sc1
TAILK4_8:
    s_bitcmp1_b32 s18, 9
    s_cbranch_scc0 TAILK4_9
    buffer_load_dwordx4 a[36:39], v32, s[12:15], s60 offen sc1
TAILK4_9:
    s_bitcmp1_b32 s18, 10
    s_cbranch_scc0 TAILK4_10
    buffer_load_dwordx4 a[56:59], v20, s[12:15], s61 offen sc1
TAILK4_10:
    s_bitcmp1_b32 s18, 11
    s_cbranch_scc0 TAILK4_11
    buffer_load_dwordx4 a[76:79], v32, s[12:15], s61 offen sc1
TAILK4_11:
    s_bitcmp1_b32 s18, 12
    s_cbranch_scc0 TAILK4_12
    buffer_load_dwordx4 a[96:99], v20, s[12:15], s62 offen sc1
TAILK4_12:
    s_bitcmp1_b32 s18, 13
    s_cbranch_scc0 TAILK4_13
    buffer_load_dwordx4 a[116:119], v32, s[12:15], s62 offen sc1
TAILK4_13:
    s_bitcmp1_b32 s18, 14
    s_cbranch_scc0 TAILK4_14
    buffer_load_dwordx4 a[136:139], v20, s[12:15], s63 offen sc1
TAILK4_14:
    s_bitcmp1_b32 s18, 15
    s_cbranch_scc0 TAILK4_15
    buffer_load_dwordx4 a[156:159], v32, s[12:15], s63 offen sc1
TAILK4_15:
TAILN4:
    s_bitcmp1_b32 s47, 3
    s_cbranch_scc1 TAILG3
    s_cmp_lt_u32 s51, 0xff00
    s_cbranch_scc1 TAILG3
    s_bitset1_b32 s47, 3
    v_mfma_f32_16x16x32_bf16 v[76:79], v[38:41], a[12:15], 0
    v_accvgpr_read_b32 v85, a244
    v_accvgpr_read_b32 v87, a245
    v_mfma_f32_16x16x32_bf16 v[80:83], v[36:39], a[12:15], 0
    v_accvgpr_read_b32 v89, a246
    v_accvgpr_read_b32 v91, a247
    v_mfma_f32_16x16x32_bf16 v[76:79], v[38:41], a[32:35], v[76:79]
    v_lshlrev_b32 v84, 16, v85
    v_lshlrev_b32 v86, 16, v87
    v_mfma_f32_16x16x32_bf16 v[80:83], v[36:39], a[32:35], v[80:83]
    v_lshlrev_b32 v88, 16, v89
    v_lshlrev_b32 v90, 16, v91
    v_mfma_f32_16x16x32_bf16 v[76:79], v[38:41], a[52:55], v[76:79]
    v_and_b32 v85, s94, v85
    v_and_b32 v87, s94, v87
    v_mfma_f32_16x16x32_bf16 v[80:83], v[36:39], a[52:55], v[80:83]
    v_and_b32 v89, s94, v89
    v_and_b32 v91, s94, v91
    v_mfma_f32_16x16x32_bf16 v[76:79], v[38:41], a[72:75], v[76:79]
    v_mfma_f32_16x16x32_bf16 v[80:83], v[36:39], a[72:75], v[80:83]
    v_mfma_f32_16x16x32_bf16 v[76:79], v[38:41], a[92:95], v[76:79]
    v_mfma_f32_16x16x32_bf16 v[80:83], v[36:39], a[92:95], v[80:83]
    v_mfma_f32_16x16x32_bf16 v[76:79], v[38:41], a[112:115], v[76:79]
    v_mfma_f32_16x16x32_bf16 v[80:83], v[36:39], a[112:115], v[80:83]
    v_mfma_f32_16x16x32_bf16 v[76:79], v[38:41], a[132:135], v[76:79]
    v_mfma_f32_16x16x32_bf16 v[80:83], v[36:39], a[132:135], v[80:83]
    v_mfma_f32_16x16x32_bf16 v[76:79], v[38:41], a[152:155], v[76:79]
    v_mfma_f32_16x16x32_bf16 v[80:83], v[36:39], a[152:155], v[80:83]
    s_nop 6
    v_mul_f32 v60, 0xc13504f3, v76
    v_mul_f32 v61, 0xc13504f3, v77
    v_mul_f32 v62, 0xc13504f3, v78
    v_mul_f32 v63, 0xc13504f3, v79
    v_mul_f32 v64, 0xc13504f3, v80
    v_mul_f32 v65, 0xc13504f3, v81
    v_mul_f32 v66, 0xc13504f3, v82
    v_mul_f32 v67, 0xc13504f3, v83
    v_exp_f32 v60, v60
    v_exp_f32 v61, v61
    v_exp_f32 v62, v62
    v_exp_f32 v63, v63
    v_exp_f32 v64, v64
    v_exp_f32 v65, v65
    v_exp_f32 v66, v66
    v_exp_f32 v67, v67
    v_fma_f32 v60, v60, s53, s53
    v_fma_f32 v61, v61, s53, s53
    v_fma_f32 v62, v62, s53, s53
    v_fma_f32 v63, v63, s53, s53
    v_fma_f32 v64, v64, s53, s53
    v_fma_f32 v65, v65, s53, s53
    v_fma_f32 v66, v66, s53, s53
    v_fma_f32 v67, v67, s53, s53
    v_rcp_f32 v60, v60
    v_rcp_f32 v61, v61
    v_rcp_f32 v62, v62
    v_rcp_f32 v63, v63
    v_rcp_f32 v64, v64
    v_rcp_f32 v65, v65
    v_rcp_f32 v66, v66
    v_rcp_f32 v67, v67
    v_mul_f32 v76, v76, v60
    v_mul_f32 v77, v77, v61
    v_mul_f32 v78, v78, v62
    v_mul_f32 v79, v79, v63
    v_mul_f32 v80, v80, v64
    v_mul_f32 v81, v81, v65
    v_mul_f32 v82, v82, v66
    v_mul_f32 v83, v83, v67
TAILG3:
    s_bitcmp1_b32 s47, 4
    s_cbranch_scc1 TAILG4
    s_cmp_lt_u32 s52, 0xff00
    s_cbranch_scc1 TAILG4
    s_bitset1_b32 s47, 4
    v_mfma_f32_16x16x32_bf16 v[92:95], v[38:41], a[16:19], 0
    v_accvgpr_read_b32 v101, a248
    v_accvgpr_read_b32 v103, a249
    v_mfma_f32_16x16x32_bf16 v[96:99], v[36:39], a[16:19], 0
    v_accvgpr_read_b32 v105, a250
    v_accvgpr_read_b32 v107, a251
    v_mfma_f32_16x16x32_bf16 v[92:95], v[38:41], a[36:39], v[92:95]
    v_lshlrev_b32 v100, 16, v101
    v_lshlrev_b32 v102, 16, v103
    v_mfma_f32_16x16x32_bf16 v[96:99], v[36:39], a[36:39], v[96:99]
    v_lshlrev_b32 v104, 16, v105
    v_lshlrev_b32 v106, 16, v107
    v_mfma_f32_16x16x32_bf16 v[92:95], v[38:41], a[56:59], v[92:95]
    v_and_b32 v101, s94, v101
    v_and_b32 v103, s94, v103
    v_mfma_f32_16x16x32_bf16 v[96:99], v[36:39], a[56:59], v[96:99]
    v_and_b32 v105, s94, v105
    v_and_b32 v107, s94, v107
    v_mfma_f32_16x16x32_bf16 v[92:95], v[38:41], a[76:79], v[92:95]
    v_mfma_f32_16x16x32_bf16 v[96:99], v[36:39], a[76:79], v[96:99]
    v_mfma_f32_16x16x32_bf16 v[92:95], v[38:41], a[96:99], v[92:95]
    v_mfma_f32_16x16x32_bf16 v[96:99], v[36:39], a[96:99], v[96:99]
    v_mfma_f32_16x16x32_bf16 v[92:95], v[38:41], a[116:119], v[92:95]
    v_mfma_f32_16x16x32_bf16 v[96:99], v[36:39], a[116:119], v[96:99]
    v_mfma_f32_16x16x32_bf16 v[92:95], v[38:41], a[136:139], v[92:95]
    v_mfma_f32_16x16x32_bf16 v[96:99], v[36:39], a[136:139], v[96:99]
    v_mfma_f32_16x16x32_bf16 v[92:95], v[38:41], a[156:159], v[92:95]
    v_mfma_f32_16x16x32_bf16 v[96:99], v[36:39], a[156:159], v[96:99]
    s_nop 6
    v_mul_f32 v60, 0xc13504f3, v92
    v_mul_f32 v61, 0xc13504f3, v93
    v_mul_f32 v62, 0xc13504f3, v94
    v_mul_f32 v63, 0xc13504f3, v95
    v_mul_f32 v64, 0xc13504f3, v96
    v_mul_f32 v65, 0xc13504f3, v97
    v_mul_f32 v66, 0xc13504f3, v98
    v_mul_f32 v67, 0xc13504f3, v99
    v_exp_f32 v60, v60
    v_exp_f32 v61, v61
    v_exp_f32 v62, v62
    v_exp_f32 v63, v63
    v_exp_f32 v64, v64
    v_exp_f32 v65, v65
    v_exp_f32 v66, v66
    v_exp_f32 v67, v67
    v_fma_f32 v60, v60, s53, s53
    v_fma_f32 v61, v61, s53, s53
    v_fma_f32 v62, v62, s53, s53
    v_fma_f32 v63, v63, s53, s53
    v_fma_f32 v64, v64, s53, s53
    v_fma_f32 v65, v65, s53, s53
    v_fma_f32 v66, v66, s53, s53
    v_fma_f32 v67, v67, s53, s53
    v_rcp_f32 v60, v60
    v_rcp_f32 v61, v61
    v_rcp_f32 v62, v62
    v_rcp_f32 v63, v63
    v_rcp_f32 v64, v64
    v_rcp_f32 v65, v65
    v_rcp_f32 v66, v66
    v_rcp_f32 v67, v67
    v_mul_f32 v92, v92, v60
    v_mul_f32 v93, v93, v61
    v_mul_f32 v94, v94, v62
    v_mul_f32 v95, v95, v63
    v_mul_f32 v96, v96, v64
    v_mul_f32 v97, v97, v65
    v_mul_f32 v98, v98, v66
    v_mul_f32 v99, v99, v67
TAILG4:
    s_cmp_lg_u32 s54, 0
    s_cbranch_scc1 TAILX0
    s_cmp_lt_u32 s48, 65535
    s_cbranch_scc1 TAILL
    v_mfma_f32_16x16x32_bf16 v[44:47], v[38:41], a[0:3], 0
    v_accvgpr_read_b32 v69, a232
    v_lshlrev_b32 v68, 16, v69
    v_mfma_f32_16x16x32_bf16 v[48:51], v[36:39], a[0:3], 0
    v_and_b32 v69, s94, v69
    v_accvgpr_read_b32 v71, a233
    v_mfma_f32_16x16x32_bf16 v[44:47], v[38:41], a[20:23], v[44:47]
    v_lshlrev_b32 v70, 16, v71
    v_and_b32 v71, s94, v71
    v_mfma_f32_16x16x32_bf16 v[48:51], v[36:39], a[20:23], v[48:51]
    v_accvgpr_read_b32 v73, a234
    v_lshlrev_b32 v72, 16, v73
    v_mfma_f32_16x16x32_bf16 v[44:47], v[38:41], a[40:43], v[44:47]
    v_and_b32 v73, s94, v73
    v_accvgpr_read_b32 v75, a235
    v_mfma_f32_16x16x32_bf16 v[48:51], v[36:39], a[40:43], v[48:51]
    v_lshlrev_b32 v74, 16, v75
    v_and_b32 v75, s94, v75
    v_mfma_f32_16x16x32_bf16 v[44:47], v[38:41], a[60:63], v[44:47]
    v_mfma_f32_16x16x32_bf16 v[48:51], v[36:39], a[60:63], v[48:51]
    v_mfma_f32_16x16x32_bf16 v[44:47], v[38:41], a[80:83], v[44:47]
    v_mfma_f32_16x16x32_bf16 v[48:51], v[36:39], a[80:83], v[48:51]
    v_mfma_f32_16x16x32_bf16 v[44:47], v[38:41], a[100:103], v[44:47]
    v_mfma_f32_16x16x32_bf16 v[48:51], v[36:39], a[100:103], v[48:51]
    v_mfma_f32_16x16x32_bf16 v[44:47], v[38:41], a[120:123], v[44:47]
    v_mfma_f32_16x16x32_bf16 v[48:51], v[36:39], a[120:123], v[48:51]
    v_mfma_f32_16x16x32_bf16 v[44:47], v[38:41], a[140:143], v[44:47]
    v_mfma_f32_16x16x32_bf16 v[48:51], v[36:39], a[140:143], v[48:51]
    v_mfma_f32_16x16x32_bf16 v[52:55], v[38:41], a[160:163], 0
    s_nop 5
    v_mul_f32 v60, 0xc13504f3, v44
    v_mfma_f32_16x16x32_bf16 v[56:59], v[36:39], a[160:163], 0
    v_mul_f32 v61, 0xc13504f3, v45
    v_mul_f32 v62, 0xc13504f3, v46
    v_mfma_f32_16x16x32_bf16 v[52:55], v[38:41], a[164:167], v[52:55]
    v_mul_f32 v63, 0xc13504f3, v47
    v_mul_f32 v64, 0xc13504f3, v48
    v_mfma_f32_16x16x32_bf16 v[56:59], v[36:39], a[164:167], v[56:59]
    v_mul_f32 v65, 0xc13504f3, v49
    v_mul_f32 v66, 0xc13504f3, v50
    v_mfma_f32_16x16x32_bf16 v[52:55], v[38:41], a[168:171], v[52:55]
    v_mul_f32 v67, 0xc13504f3, v51
    v_mfma_f32_16x16x32_bf16 v[56:59], v[36:39], a[168:171], v[56:59]
    v_exp_f32 v60, v60
    v_mfma_f32_16x16x32_bf16 v[52:55], v[38:41], a[172:175], v[52:55]
    v_exp_f32 v61, v61
    v_mfma_f32_16x16x32_bf16 v[56:59], v[36:39], a[172:175], v[56:59]
    v_exp_f32 v62, v62
    v_mfma_f32_16x16x32_bf16 v[52:55], v[38:41], a[176:179], v[52:55]
    v_exp_f32 v63, v63
    v_mfma_f32_16x16x32_bf16 v[56:59], v[36:39], a[176:179], v[56:59]
    v_exp_f32 v64, v64
    v_mfma_f32_16x16x32_bf16 v[52:55], v[38:41], a[180:183], v[52:55]
    v_exp_f32 v65, v65
    v_mfma_f32_16x16x32_bf16 v[56:59], v[36:39], a[180:183], v[56:59]
    v_exp_f32 v66, v66
    v_mfma_f32_16x16x32_bf16 v[52:55], v[38:41], a[184:187], v[52:55]
    v_exp_f32 v67, v67
    v_mfma_f32_16x16x32_bf16 v[56:59], v[36:39], a[184:187], v[56:59]
    v_fma_f32 v60, v60, s53, s53
    v_fma_f32 v61, v61, s53, s53
    v_mfma_f32_16x16x32_bf16 v[52:55], v[38:41], a[188:191], v[52:55]
    v_fma_f32 v62, v62, s53, s53
    v_fma_f32 v63, v63, s53, s53
    v_mfma_f32_16x16x32_bf16 v[56:59], v[36:39], a[188:191], v[56:59]
    v_fma_f32 v64, v64, s53, s53
    v_fma_f32 v65, v65, s53, s53
    v_fma_f32 v66, v66, s53, s53
    v_fma_f32 v67, v67, s53, s53
    v_rcp_f32 v60, v60
    v_rcp_f32 v61, v61
    v_rcp_f32 v62, v62
    v_rcp_f32 v63, v63
    v_rcp_f32 v64, v64
    v_rcp_f32 v65, v65
    v_rcp_f32 v66, v66
    v_rcp_f32 v67, v67
    v_mul_f32 v44, v44, v60
    v_mul_f32 v45, v45, v61
    v_mul_f32 v46, v46, v62
    v_mul_f32 v47, v47, v63
    v_mul_f32 v48, v48, v64
    v_mul_f32 v49, v49, v65
    v_mul_f32 v50, v50, v66
    v_mul_f32 v51, v51, v67
    v_mul_f32 v52, v52, v44
    v_mul_f32 v53, v53, v45
    v_mul_f32 v54, v54, v46
    v_mul_f32 v55, v55, v47
    v_mul_f32 v56, v56, v48
    v_mul_f32 v57, v57, v49
    v_mul_f32 v58, v58, v50
    v_mul_f32 v59, v59, v51
    v_cvt_pk_bf16_f32 v124, v52, v53
    v_cvt_pk_bf16_f32 v125, v54, v55
    v_cvt_pk_bf16_f32 v126, v56, v57
    v_cvt_pk_bf16_f32 v127, v58, v59
    ds_write_b64 v22, v[124:125] offset:0
    ds_write_b64 v22, v[126:127] offset:32
    ds_read_b128 v[124:127], v23 offset:0
    s_waitcnt lgkmcnt(0)
    v_lshlrev_b32 v2, 16, v124
    v_and_b32 v3, s94, v124
    v_add_f32 v2, v2, v68
    v_add_f32 v3, v3, v69
    v_cvt_pk_bf16_f32 v124, v2, v3
    v_lshlrev_b32 v2, 16, v125
    v_and_b32 v3, s94, v125
    v_add_f32 v2, v2, v70
    v_add_f32 v3, v3, v71
    v_cvt_pk_bf16_f32 v125, v2, v3
    v_lshlrev_b32 v2, 16, v126
    v_and_b32 v3, s94, v126
    v_add_f32 v2, v2, v72
    v_add_f32 v3, v3, v73
    v_cvt_pk_bf16_f32 v126, v2, v3
    v_lshlrev_b32 v2, 16, v127
    v_and_b32 v3, s94, v127
    v_add_f32 v2, v2, v74
    v_add_f32 v3, v3, v75
    v_cvt_pk_bf16_f32 v127, v2, v3
    buffer_store_dwordx4 v[124:127], v15, s[72:75], s41 offen offset:0
    s_mov_b32 s54, 1
TAILX0:
    s_cmp_lg_u32 s54, 1
    s_cbranch_scc1 TAILX1
    s_cmp_lt_u32 s49, 65535
    s_cbranch_scc1 TAILL
    v_mfma_f32_16x16x32_bf16 v[44:47], v[38:41], a[4:7], 0
    v_accvgpr_read_b32 v69, a236
    v_lshlrev_b32 v68, 16, v69
    v_mfma_f32_16x16x32_bf16 v[48:51], v[36:39], a[4:7], 0
    v_and_b32 v69, s94, v69
    v_accvgpr_read_b32 v71, a237
    v_mfma_f32_16x16x32_bf16 v[44:47], v[38:41], a[24:27], v[44:47]
    v_lshlrev_b32 v70, 16, v71
    v_and_b32 v71, s94, v71
    v_mfma_f32_16x16x32_bf16 v[48:51], v[36:39], a[24:27], v[48:51]
    v_accvgpr_read_b32 v73, a238
    v_lshlrev_b32 v72, 16, v73
    v_mfma_f32_16x16x32_bf16 v[44:47], v[38:41], a[44:47], v[44:47]
    v_and_b32 v73, s94, v73
    v_accvgpr_read_b32 v75, a239
    v_mfma_f32_16x16x32_bf16 v[48:51], v[36:39], a[44:47], v[48:51]
    v_lshlrev_b32 v74, 16, v75
    v_and_b32 v75, s94, v75
    v_mfma_f32_16x16x32_bf16 v[44:47], v[38:41], a[64:67], v[44:47]
    v_mfma_f32_16x16x32_bf16 v[48:51], v[36:39], a[64:67], v[48:51]
    v_mfma_f32_16x16x32_bf16 v[44:47], v[38:41], a[84:87], v[44:47]
    v_mfma_f32_16x16x32_bf16 v[48:51], v[36:39], a[84:87], v[48:51]
    v_mfma_f32_16x16x32_bf16 v[44:47], v[38:41], a[104:107], v[44:47]
    v_mfma_f32_16x16x32_bf16 v[48:51], v[36:39], a[104:107], v[48:51]
    v_mfma_f32_16x16x32_bf16 v[44:47], v[38:41], a[124:127], v[44:47]
    v_mfma_f32_16x16x32_bf16 v[48:51], v[36:39], a[124:127], v[48:51]
    v_mfma_f32_16x16x32_bf16 v[44:47], v[38:41], a[144:147], v[44:47]
    v_mfma_f32_16x16x32_bf16 v[48:51], v[36:39], a[144:147], v[48:51]
    v_mfma_f32_16x16x32_bf16 v[52:55], v[38:41], a[192:195], 0
    s_nop 5
    v_mul_f32 v60, 0xc13504f3, v44
    v_mfma_f32_16x16x32_bf16 v[56:59], v[36:39], a[192:195], 0
    v_mul_f32 v61, 0xc13504f3, v45
    v_mul_f32 v62, 0xc13504f3, v46
    v_mfma_f32_16x16x32_bf16 v[52:55], v[38:41], a[196:199], v[52:55]
    v_mul_f32 v63, 0xc13504f3, v47
    v_mul_f32 v64, 0xc13504f3, v48
    v_mfma_f32_16x16x32_bf16 v[56:59], v[36:39], a[196:199], v[56:59]
    v_mul_f32 v65, 0xc13504f3, v49
    v_mul_f32 v66, 0xc13504f3, v50
    v_mfma_f32_16x16x32_bf16 v[52:55], v[38:41], a[200:203], v[52:55]
    v_mul_f32 v67, 0xc13504f3, v51
    v_mfma_f32_16x16x32_bf16 v[56:59], v[36:39], a[200:203], v[56:59]
    v_exp_f32 v60, v60
    v_mfma_f32_16x16x32_bf16 v[52:55], v[38:41], a[204:207], v[52:55]
    v_exp_f32 v61, v61
    v_mfma_f32_16x16x32_bf16 v[56:59], v[36:39], a[204:207], v[56:59]
    v_exp_f32 v62, v62
    v_mfma_f32_16x16x32_bf16 v[52:55], v[38:41], a[208:211], v[52:55]
    v_exp_f32 v63, v63
    v_mfma_f32_16x16x32_bf16 v[56:59], v[36:39], a[208:211], v[56:59]
    v_exp_f32 v64, v64
    v_mfma_f32_16x16x32_bf16 v[52:55], v[38:41], a[212:215], v[52:55]
    v_exp_f32 v65, v65
    v_mfma_f32_16x16x32_bf16 v[56:59], v[36:39], a[212:215], v[56:59]
    v_exp_f32 v66, v66
    v_mfma_f32_16x16x32_bf16 v[52:55], v[38:41], a[216:219], v[52:55]
    v_exp_f32 v67, v67
    v_mfma_f32_16x16x32_bf16 v[56:59], v[36:39], a[216:219], v[56:59]
    v_fma_f32 v60, v60, s53, s53
    v_fma_f32 v61, v61, s53, s53
    v_mfma_f32_16x16x32_bf16 v[52:55], v[38:41], a[220:223], v[52:55]
    v_fma_f32 v62, v62, s53, s53
    v_fma_f32 v63, v63, s53, s53
    v_mfma_f32_16x16x32_bf16 v[56:59], v[36:39], a[220:223], v[56:59]
    v_fma_f32 v64, v64, s53, s53
    v_fma_f32 v65, v65, s53, s53
    v_fma_f32 v66, v66, s53, s53
    v_fma_f32 v67, v67, s53, s53
    v_rcp_f32 v60, v60
    v_rcp_f32 v61, v61
    v_rcp_f32 v62, v62
    v_rcp_f32 v63, v63
    v_rcp_f32 v64, v64
    v_rcp_f32 v65, v65
    v_rcp_f32 v66, v66
    v_rcp_f32 v67, v67
    v_mul_f32 v44, v44, v60
    v_mul_f32 v45, v45, v61
    v_mul_f32 v46, v46, v62
    v_mul_f32 v47, v47, v63
    v_mul_f32 v48, v48, v64
    v_mul_f32 v49, v49, v65
    v_mul_f32 v50, v50, v66
    v_mul_f32 v51, v51, v67
    v_mul_f32 v52, v52, v44
    v_mul_f32 v53, v53, v45
    v_mul_f32 v54, v54, v46
    v_mul_f32 v55, v55, v47
    v_mul_f32 v56, v56, v48
    v_mul_f32 v57, v57, v49
    v_mul_f32 v58, v58, v50
    v_mul_f32 v59, v59, v51
    v_cvt_pk_bf16_f32 v128, v52, v53
    v_cvt_pk_bf16_f32 v129, v54, v55
    v_cvt_pk_bf16_f32 v130, v56, v57
    v_cvt_pk_bf16_f32 v131, v58, v59
    ds_write_b64 v22, v[128:129] offset:1024
    ds_write_b64 v22, v[130:131] offset:1056
    ds_read_b128 v[128:131], v23 offset:1024
    s_waitcnt lgkmcnt(0)
    v_lshlrev_b32 v2, 16, v128
    v_and_b32 v3, s94, v128
    v_add_f32 v2, v2, v68
    v_add_f32 v3, v3, v69
    v_cvt_pk_bf16_f32 v128, v2, v3
    v_lshlrev_b32 v2, 16, v129
    v_and_b32 v3, s94, v129
    v_add_f32 v2, v2, v70
    v_add_f32 v3, v3, v71
    v_cvt_pk_bf16_f32 v129, v2, v3
    v_lshlrev_b32 v2, 16, v130
    v_and_b32 v3, s94, v130
    v_add_f32 v2, v2, v72
    v_add_f32 v3, v3, v73
    v_cvt_pk_bf16_f32 v130, v2, v3
    v_lshlrev_b32 v2, 16, v131
    v_and_b32 v3, s94, v131
    v_add_f32 v2, v2, v74
    v_add_f32 v3, v3, v75
    v_cvt_pk_bf16_f32 v131, v2, v3
    buffer_store_dwordx4 v[128:131], v15, s[72:75], s41 offen offset:256
    s_mov_b32 s54, 2
TAILX1:
    s_cmp_lg_u32 s54, 2
    s_cbranch_scc1 TAILX2
    s_cmp_lt_u32 s50, 65535
    s_cbranch_scc1 TAILL
    v_mfma_f32_16x16x32_bf16 v[44:47], v[38:41], a[8:11], 0
    v_accvgpr_read_b32 v69, a240
    v_lshlrev_b32 v68, 16, v69
    v_mfma_f32_16x16x32_bf16 v[48:51], v[36:39], a[8:11], 0
    v_and_b32 v69, s94, v69
    v_accvgpr_read_b32 v71, a241
    v_mfma_f32_16x16x32_bf16 v[44:47], v[38:41], a[28:31], v[44:47]
    v_lshlrev_b32 v70, 16, v71
    v_and_b32 v71, s94, v71
    v_mfma_f32_16x16x32_bf16 v[48:51], v[36:39], a[28:31], v[48:51]
    v_accvgpr_read_b32 v73, a242
    v_lshlrev_b32 v72, 16, v73
    v_mfma_f32_16x16x32_bf16 v[44:47], v[38:41], a[48:51], v[44:47]
    v_and_b32 v73, s94, v73
    v_accvgpr_read_b32 v75, a243
    v_mfma_f32_16x16x32_bf16 v[48:51], v[36:39], a[48:51], v[48:51]
    v_lshlrev_b32 v74, 16, v75
    v_and_b32 v75, s94, v75
    v_mfma_f32_16x16x32_bf16 v[44:47], v[38:41], a[68:71], v[44:47]
    v_mfma_f32_16x16x32_bf16 v[48:51], v[36:39], a[68:71], v[48:51]
    v_mfma_f32_16x16x32_bf16 v[44:47], v[38:41], a[88:91], v[44:47]
    v_mfma_f32_16x16x32_bf16 v[48:51], v[36:39], a[88:91], v[48:51]
    v_mfma_f32_16x16x32_bf16 v[44:47], v[38:41], a[108:111], v[44:47]
    v_mfma_f32_16x16x32_bf16 v[48:51], v[36:39], a[108:111], v[48:51]
    v_mfma_f32_16x16x32_bf16 v[44:47], v[38:41], a[128:131], v[44:47]
    v_mfma_f32_16x16x32_bf16 v[48:51], v[36:39], a[128:131], v[48:51]
    v_mfma_f32_16x16x32_bf16 v[44:47], v[38:41], a[148:151], v[44:47]
    v_mfma_f32_16x16x32_bf16 v[48:51], v[36:39], a[148:151], v[48:51]
    v_mfma_f32_16x16x32_bf16 v[52:55], v[38:41], v[132:135], 0
    s_nop 5
    v_mul_f32 v60, 0xc13504f3, v44
    v_mfma_f32_16x16x32_bf16 v[56:59], v[36:39], v[132:135], 0
    v_mul_f32 v61, 0xc13504f3, v45
    v_mul_f32 v62, 0xc13504f3, v46
    v_mfma_f32_16x16x32_bf16 v[52:55], v[38:41], v[136:139], v[52:55]
    v_mul_f32 v63, 0xc13504f3, v47
    v_mul_f32 v64, 0xc13504f3, v48
    v_mfma_f32_16x16x32_bf16 v[56:59], v[36:39], v[136:139], v[56:59]
    v_mul_f32 v65, 0xc13504f3, v49
    v_mul_f32 v66, 0xc13504f3, v50
    v_mfma_f32_16x16x32_bf16 v[52:55], v[38:41], v[140:143], v[52:55]
    v_mul_f32 v67, 0xc13504f3, v51
    v_mfma_f32_16x16x32_bf16 v[56:59], v[36:39], v[140:143], v[56:59]
    v_exp_f32 v60, v60
    v_mfma_f32_16x16x32_bf16 v[52:55], v[38:41], v[144:147], v[52:55]
    v_exp_f32 v61, v61
    v_mfma_f32_16x16x32_bf16 v[56:59], v[36:39], v[144:147], v[56:59]
    v_exp_f32 v62, v62
    v_mfma_f32_16x16x32_bf16 v[52:55], v[38:41], v[148:151], v[52:55]
    v_exp_f32 v63, v63
    v_mfma_f32_16x16x32_bf16 v[56:59], v[36:39], v[148:151], v[56:59]
    v_exp_f32 v64, v64
    v_mfma_f32_16x16x32_bf16 v[52:55], v[38:41], v[152:155], v[52:55]
    v_exp_f32 v65, v65
    v_mfma_f32_16x16x32_bf16 v[56:59], v[36:39], v[152:155], v[56:59]
    v_exp_f32 v66, v66
    v_mfma_f32_16x16x32_bf16 v[52:55], v[38:41], v[156:159], v[52:55]
    v_exp_f32 v67, v67
    v_mfma_f32_16x16x32_bf16 v[56:59], v[36:39], v[156:159], v[56:59]
    v_fma_f32 v60, v60, s53, s53
    v_fma_f32 v61, v61, s53, s53
    v_mfma_f32_16x16x32_bf16 v[52:55], v[38:41], v[160:163], v[52:55]
    v_fma_f32 v62, v62, s53, s53
    v_fma_f32 v63, v63, s53, s53
    v_mfma_f32_16x16x32_bf16 v[56:59], v[36:39], v[160:163], v[56:59]
    v_fma_f32 v64, v64, s53, s53
    v_fma_f32 v65, v65, s53, s53
    v_fma_f32 v66, v66, s53, s53
    v_fma_f32 v67, v67, s53, s53
    v_rcp_f32 v60, v60
    v_rcp_f32 v61, v61
    v_rcp_f32 v62, v62
    v_rcp_f32 v63, v63
    v_rcp_f32 v64, v64
    v_rcp_f32 v65, v65
    v_rcp_f32 v66, v66
    v_rcp_f32 v67, v67
    v_mul_f32 v44, v44, v60
    v_mul_f32 v45, v45, v61
    v_mul_f32 v46, v46, v62
    v_mul_f32 v47, v47, v63
    v_mul_f32 v48, v48, v64
    v_mul_f32 v49, v49, v65
    v_mul_f32 v50, v50, v66
    v_mul_f32 v51, v51, v67
    v_mul_f32 v52, v52, v44
    v_mul_f32 v53, v53, v45
    v_mul_f32 v54, v54, v46
    v_mul_f32 v55, v55, v47
    v_mul_f32 v56, v56, v48
    v_mul_f32 v57, v57, v49
    v_mul_f32 v58, v58, v50
    v_mul_f32 v59, v59, v51
    v_cvt_pk_bf16_f32 v124, v52, v53
    v_cvt_pk_bf16_f32 v125, v54, v55
    v_cvt_pk_bf16_f32 v126, v56, v57
    v_cvt_pk_bf16_f32 v127, v58, v59
    ds_write_b64 v22, v[124:125] offset:2048
    ds_write_b64 v22, v[126:127] offset:2080
    ds_read_b128 v[124:127], v23 offset:2048
    s_waitcnt lgkmcnt(0)
    v_lshlrev_b32 v2, 16, v124
    v_and_b32 v3, s94, v124
    v_add_f32 v2, v2, v68
    v_add_f32 v3, v3, v69
    v_cvt_pk_bf16_f32 v124, v2, v3
    v_lshlrev_b32 v2, 16, v125
    v_and_b32 v3, s94, v125
    v_add_f32 v2, v2, v70
    v_add_f32 v3, v3, v71
    v_cvt_pk_bf16_f32 v125, v2, v3
    v_lshlrev_b32 v2, 16, v126
    v_and_b32 v3, s94, v126
    v_add_f32 v2, v2, v72
    v_add_f32 v3, v3, v73
    v_cvt_pk_bf16_f32 v126, v2, v3
    v_lshlrev_b32 v2, 16, v127
    v_and_b32 v3, s94, v127
    v_add_f32 v2, v2, v74
    v_add_f32 v3, v3, v75
    v_cvt_pk_bf16_f32 v127, v2, v3
    buffer_store_dwordx4 v[124:127], v15, s[72:75], s41 offen offset:512
    s_mov_b32 s54, 3
    s_cmp_eq_u32 s55, 2
    s_cbranch_scc1 TAILE
TAILX2:
    s_cmp_lg_u32 s54, 3
    s_cbranch_scc1 TAILX3
    s_cmp_lt_u32 s51, 65280
    s_cbranch_scc1 TAILL
    s_branch TAILF3
TAILX3:
    s_cmp_lg_u32 s54, 4
    s_cbranch_scc1 TAILX4
    s_cmp_lt_u32 s52, 65280
    s_cbranch_scc1 TAILL
    s_branch TAILF4
TAILX4:
TAILF3:
    s_add_u32 s19, s28, 6
    s_mov_b32 s17, 0xff
    s_mov_b32 s16, 0
    s_cmp_eq_u32 s51, 0xffff
    s_cbranch_scc1 TAILF3c
    s_add_u32 s17, s28, 5
TAILF3w:
    v_cmp_ge_i32 vcc, s17, v5
    s_nop 3
    s_and_b32 s34, vcc_lo, 0xff
    s_cbranch_scc0 TAILF3wd
    s_sleep 2
    buffer_load_dword v5, v14, s[12:15], s81 offen offset:0 sc1
    s_waitcnt vmcnt(0)
    s_sub_u32 s87, s87, 1
    s_cbranch_scc0 TAILF3w
    s_mov_b32 s87, 0
TAILF3wd:
    s_mov_b32 s16, 0xff
TAILF3l:
    s_bitcmp1_b32 s16, 0
    s_cbranch_scc0 TAILF3k0
    buffer_load_dwordx4 v[164:167], v19, s[12:15], s56 offen sc1
TAILF3k0:
    s_bitcmp1_b32 s16, 1
    s_cbranch_scc0 TAILF3k1
    buffer_load_dwordx4 v[168:171], v31, s[12:15], s56 offen sc1
TAILF3k1:
    s_bitcmp1_b32 s16, 2
    s_cbranch_scc0 TAILF3k2
    buffer_load_dwordx4 v[172:175], v19, s[12:15], s57 offen sc1
TAILF3k2:
    s_bitcmp1_b32 s16, 3
    s_cbranch_scc0 TAILF3k3
    buffer_load_dwordx4 v[176:179], v31, s[12:15], s57 offen sc1
TAILF3k3:
    s_bitcmp1_b32 s16, 4
    s_cbranch_scc0 TAILF3k4
    buffer_load_dwordx4 v[180:183], v19, s[12:15], s58 offen sc1
TAILF3k4:
    s_bitcmp1_b32 s16, 5
    s_cbranch_scc0 TAILF3k5
    buffer_load_dwordx4 v[184:187], v31, s[12:15], s58 offen sc1
TAILF3k5:
    s_bitcmp1_b32 s16, 6
    s_cbranch_scc0 TAILF3k6
    buffer_load_dwordx4 v[188:191], v19, s[12:15], s59 offen sc1
TAILF3k6:
    s_bitcmp1_b32 s16, 7
    s_cbranch_scc0 TAILF3k7
    buffer_load_dwordx4 v[192:195], v31, s[12:15], s59 offen sc1
TAILF3k7:
    v_cmp_ge_i32 vcc, s19, v5
    buffer_load_dword v5, v14, s[12:15], s81 offen sc1
    s_nop 2
    s_and_b32 s17, s16, vcc_lo
    s_mov_b32 s16, 0
    s_waitcnt vmcnt(1)
TAILF3c:
    v_mfma_f32_16x16x32_bf16 v[52:55], v[38:41], v[164:167], 0
    v_mfma_f32_16x16x32_bf16 v[56:59], v[36:39], v[164:167], 0
    v_max3_u32 v60, v164, v165, v166
    v_max_u32 v60, v60, v167
    v_mfma_f32_16x16x32_bf16 v[52:55], v[38:41], v[168:171], v[52:55]
    v_mfma_f32_16x16x32_bf16 v[56:59], v[36:39], v[168:171], v[56:59]
    v_max3_u32 v61, v168, v169, v170
    v_max_u32 v61, v61, v171
    v_mfma_f32_16x16x32_bf16 v[52:55], v[38:41], v[172:175], v[52:55]
    v_mfma_f32_16x16x32_bf16 v[56:59], v[36:39], v[172:175], v[56:59]
    v_max3_u32 v62, v172, v173, v174
    v_max_u32 v62, v62, v175
    v_mfma_f32_16x16x32_bf16 v[52:55], v[38:41], v[176:179], v[52:55]
    v_mfma_f32_16x16x32_bf16 v[56:59], v[36:39], v[176:179], v[56:59]
    v_max3_u32 v63, v176, v177, v178
    v_max_u32 v63, v63, v179
    v_mfma_f32_16x16x32_bf16 v[52:55], v[38:41], v[180:183], v[52:55]
    v_mfma_f32_16x16x32_bf16 v[56:59], v[36:39], v[180:183], v[56:59]
    v_max3_u32 v64, v180, v181, v182
    v_max_u32 v64, v64, v183
    v_mfma_f32_16x16x32_bf16 v[52:55], v[38:41], v[184:187], v[52:55]
    v_mfma_f32_16x16x32_bf16 v[56:59], v[36:39], v[184:187], v[56:59]
    v_max3_u32 v65, v184, v185, v186
    v_max_u32 v65, v65, v187
    v_mfma_f32_16x16x32_bf16 v[52:55], v[38:41], v[188:191], v[52:55]
    v_mfma_f32_16x16x32_bf16 v[56:59], v[36:39], v[188:191], v[56:59]
    v_max3_u32 v66, v188, v189, v190
    v_max_u32 v66, v66, v191
    v_mfma_f32_16x16x32_bf16 v[52:55], v[38:41], v[192:195], v[52:55]
    v_mfma_f32_16x16x32_bf16 v[56:59], v[36:39], v[192:195], v[56:59]
    v_max3_u32 v67, v192, v193, v194
    v_max_u32 v67, v67, v195
    v_max3_u32 v2, v60, v61, v62
    v_max3_u32 v3, v63, v64, v65
    v_max3_u32 v2, v2, v66, v67
    v_max_u32 v2, v2, v3
    v_cmp_eq_u32 vcc, -1, v2
    s_nop 4
    s_cbranch_vccz TAILF3d
    v_cmp_eq_u32 vcc, -1, v60
    s_nop 3
    s_cmp_lg_u64 vcc, 0
    s_cselect_b32 s34, 1, 0
    s_or_b32 s16, s16, s34
    v_cmp_eq_u32 vcc, -1, v61
    s_nop 3
    s_cmp_lg_u64 vcc, 0
    s_cselect_b32 s34, 2, 0
    s_or_b32 s16, s16, s34
    v_cmp_eq_u32 vcc, -1, v62
    s_nop 3
    s_cmp_lg_u64 vcc, 0
    s_cselect_b32 s34, 4, 0
    s_or_b32 s16, s16, s34
    v_cmp_eq_u32 vcc, -1, v63
    s_nop 3
    s_cmp_lg_u64 vcc, 0
    s_cselect_b32 s34, 8, 0
    s_or_b32 s16, s16, s34
    v_cmp_eq_u32 vcc, -1, v64
    s_nop 3
    s_cmp_lg_u64 vcc, 0
    s_cselect_b32 s34, 16, 0
    s_or_b32 s16, s16, s34
    v_cmp_eq_u32 vcc, -1, v65
    s_nop 3
    s_cmp_lg_u64 vcc, 0
    s_cselect_b32 s34, 32, 0
    s_or_b32 s16, s16, s34
    v_cmp_eq_u32 vcc, -1, v66
    s_nop 3
    s_cmp_lg_u64 vcc, 0
    s_cselect_b32 s34, 64, 0
    s_or_b32 s16, s16, s34
    v_cmp_eq_u32 vcc, -1, v67
    s_nop 3
    s_cmp_lg_u64 vcc, 0
    s_cselect_b32 s34, 128, 0
    s_or_b32 s16, s16, s34
    s_and_b32 s16, s16, s17
    s_cbranch_scc0 TAILF3d
    s_waitcnt vmcnt(0)
    s_sub_u32 s87, s87, 1
    s_cbranch_scc0 TAILF3l
TAILF3d:
    v_mul_f32 v52, v52, v76
    v_mul_f32 v53, v53, v77
    v_mul_f32 v54, v54, v78
    v_mul_f32 v55, v55, v79
    v_mul_f32 v56, v56, v80
    v_mul_f32 v57, v57, v81
    v_mul_f32 v58, v58, v82
    v_mul_f32 v59, v59, v83
    v_cvt_pk_bf16_f32 v128, v52, v53
    v_cvt_pk_bf16_f32 v129, v54, v55
    v_cvt_pk_bf16_f32 v130, v56, v57
    v_cvt_pk_bf16_f32 v131, v58, v59
    ds_write_b64 v22, v[128:129] offset:3072
    ds_write_b64 v22, v[130:131] offset:3104
    ds_read_b128 v[128:131], v23 offset:3072
    s_waitcnt lgkmcnt(0)
    v_lshlrev_b32 v2, 16, v128
    v_and_b32 v3, s94, v128
    v_add_f32 v2, v2, v84
    v_add_f32 v3, v3, v85
    v_cvt_pk_bf16_f32 v128, v2, v3
    v_lshlrev_b32 v2, 16, v129
    v_and_b32 v3, s94, v129
    v_add_f32 v2, v2, v86
    v_add_f32 v3, v3, v87
    v_cvt_pk_bf16_f32 v129, v2, v3
    v_lshlrev_b32 v2, 16, v130
    v_and_b32 v3, s94, v130
    v_add_f32 v2, v2, v88
    v_add_f32 v3, v3, v89
    v_cvt_pk_bf16_f32 v130, v2, v3
    v_lshlrev_b32 v2, 16, v131
    v_and_b32 v3, s94, v131
    v_add_f32 v2, v2, v90
    v_add_f32 v3, v3, v91
    v_cvt_pk_bf16_f32 v131, v2, v3
    buffer_store_dwordx4 v[128:131], v15, s[72:75], s41 offen offset:768
    s_cmp_eq_u32 s55, 3
    s_cbranch_scc1 TAILE
    s_mov_b32 s54, 4
    s_branch TAILX3
TAILF4:
    s_add_u32 s19, s28, 8
    s_mov_b32 s17, 0xff
    s_mov_b32 s16, 0
    s_cmp_eq_u32 s52, 0xffff
    s_cbranch_scc1 TAILF4c
    s_add_u32 s17, s28, 6
TAILF4w:
    v_cmp_ge_i32 vcc, s17, v5
    s_nop 3
    s_and_b32 s34, vcc_lo, 0xff
    s_cbranch_scc0 TAILF4wd
    s_sleep 2
    buffer_load_dword v5, v14, s[12:15], s81 offen offset:0 sc1
    s_waitcnt vmcnt(0)
    s_sub_u32 s87, s87, 1
    s_cbranch_scc0 TAILF4w
    s_mov_b32 s87, 0
TAILF4wd:
    s_mov_b32 s16, 0xff
TAILF4l:
    s_bitcmp1_b32 s16, 0
    s_cbranch_scc0 TAILF4k0
    buffer_load_dwordx4 v[196:199], v20, s[12:15], s56 offen sc1
TAILF4k0:
    s_bitcmp1_b32 s16, 1
    s_cbranch_scc0 TAILF4k1
    buffer_load_dwordx4 v[200:203], v32, s[12:15], s56 offen sc1
TAILF4k1:
    s_bitcmp1_b32 s16, 2
    s_cbranch_scc0 TAILF4k2
    buffer_load_dwordx4 v[204:207], v20, s[12:15], s57 offen sc1
TAILF4k2:
    s_bitcmp1_b32 s16, 3
    s_cbranch_scc0 TAILF4k3
    buffer_load_dwordx4 v[208:211], v32, s[12:15], s57 offen sc1
TAILF4k3:
    s_bitcmp1_b32 s16, 4
    s_cbranch_scc0 TAILF4k4
    buffer_load_dwordx4 v[212:215], v20, s[12:15], s58 offen sc1
TAILF4k4:
    s_bitcmp1_b32 s16, 5
    s_cbranch_scc0 TAILF4k5
    buffer_load_dwordx4 v[216:219], v32, s[12:15], s58 offen sc1
TAILF4k5:
    s_bitcmp1_b32 s16, 6
    s_cbranch_scc0 TAILF4k6
    buffer_load_dwordx4 v[220:223], v20, s[12:15], s59 offen sc1
TAILF4k6:
    s_bitcmp1_b32 s16, 7
    s_cbranch_scc0 TAILF4k7
    buffer_load_dwordx4 v[224:227], v32, s[12:15], s59 offen sc1
TAILF4k7:
    v_cmp_ge_i32 vcc, s19, v5
    buffer_load_dword v5, v14, s[12:15], s81 offen sc1
    s_nop 2
    s_and_b32 s17, s16, vcc_lo
    s_mov_b32 s16, 0
    s_waitcnt vmcnt(1)
TAILF4c:
    v_mfma_f32_16x16x32_bf16 v[52:55], v[38:41], v[196:199], 0
    v_mfma_f32_16x16x32_bf16 v[56:59], v[36:39], v[196:199], 0
    v_max3_u32 v60, v196, v197, v198
    v_max_u32 v60, v60, v199
    v_mfma_f32_16x16x32_bf16 v[52:55], v[38:41], v[200:203], v[52:55]
    v_mfma_f32_16x16x32_bf16 v[56:59], v[36:39], v[200:203], v[56:59]
    v_max3_u32 v61, v200, v201, v202
    v_max_u32 v61, v61, v203
    v_mfma_f32_16x16x32_bf16 v[52:55], v[38:41], v[204:207], v[52:55]
    v_mfma_f32_16x16x32_bf16 v[56:59], v[36:39], v[204:207], v[56:59]
    v_max3_u32 v62, v204, v205, v206
    v_max_u32 v62, v62, v207
    v_mfma_f32_16x16x32_bf16 v[52:55], v[38:41], v[208:211], v[52:55]
    v_mfma_f32_16x16x32_bf16 v[56:59], v[36:39], v[208:211], v[56:59]
    v_max3_u32 v63, v208, v209, v210
    v_max_u32 v63, v63, v211
    v_mfma_f32_16x16x32_bf16 v[52:55], v[38:41], v[212:215], v[52:55]
    v_mfma_f32_16x16x32_bf16 v[56:59], v[36:39], v[212:215], v[56:59]
    v_max3_u32 v64, v212, v213, v214
    v_max_u32 v64, v64, v215
    v_mfma_f32_16x16x32_bf16 v[52:55], v[38:41], v[216:219], v[52:55]
    v_mfma_f32_16x16x32_bf16 v[56:59], v[36:39], v[216:219], v[56:59]
    v_max3_u32 v65, v216, v217, v218
    v_max_u32 v65, v65, v219
    v_mfma_f32_16x16x32_bf16 v[52:55], v[38:41], v[220:223], v[52:55]
    v_mfma_f32_16x16x32_bf16 v[56:59], v[36:39], v[220:223], v[56:59]
    v_max3_u32 v66, v220, v221, v222
    v_max_u32 v66, v66, v223
    v_mfma_f32_16x16x32_bf16 v[52:55], v[38:41], v[224:227], v[52:55]
    v_mfma_f32_16x16x32_bf16 v[56:59], v[36:39], v[224:227], v[56:59]
    v_max3_u32 v67, v224, v225, v226
    v_max_u32 v67, v67, v227
    v_max3_u32 v2, v60, v61, v62
    v_max3_u32 v3, v63, v64, v65
    v_max3_u32 v2, v2, v66, v67
    v_max_u32 v2, v2, v3
    v_cmp_eq_u32 vcc, -1, v2
    s_nop 4
    s_cbranch_vccz TAILF4d
    v_cmp_eq_u32 vcc, -1, v60
    s_nop 3
    s_cmp_lg_u64 vcc, 0
    s_cselect_b32 s34, 1, 0
    s_or_b32 s16, s16, s34
    v_cmp_eq_u32 vcc, -1, v61
    s_nop 3
    s_cmp_lg_u64 vcc, 0
    s_cselect_b32 s34, 2, 0
    s_or_b32 s16, s16, s34
    v_cmp_eq_u32 vcc, -1, v62
    s_nop 3
    s_cmp_lg_u64 vcc, 0
    s_cselect_b32 s34, 4, 0
    s_or_b32 s16, s16, s34
    v_cmp_eq_u32 vcc, -1, v63
    s_nop 3
    s_cmp_lg_u64 vcc, 0
    s_cselect_b32 s34, 8, 0
    s_or_b32 s16, s16, s34
    v_cmp_eq_u32 vcc, -1, v64
    s_nop 3
    s_cmp_lg_u64 vcc, 0
    s_cselect_b32 s34, 16, 0
    s_or_b32 s16, s16, s34
    v_cmp_eq_u32 vcc, -1, v65
    s_nop 3
    s_cmp_lg_u64 vcc, 0
    s_cselect_b32 s34, 32, 0
    s_or_b32 s16, s16, s34
    v_cmp_eq_u32 vcc, -1, v66
    s_nop 3
    s_cmp_lg_u64 vcc, 0
    s_cselect_b32 s34, 64, 0
    s_or_b32 s16, s16, s34
    v_cmp_eq_u32 vcc, -1, v67
    s_nop 3
    s_cmp_lg_u64 vcc, 0
    s_cselect_b32 s34, 128, 0
    s_or_b32 s16, s16, s34
    s_and_b32 s16, s16, s17
    s_cbranch_scc0 TAILF4d
    s_waitcnt vmcnt(0)
    s_sub_u32 s87, s87, 1
    s_cbranch_scc0 TAILF4l
TAILF4d:
    v_mul_f32 v52, v52, v92
    v_mul_f32 v53, v53, v93
    v_mul_f32 v54, v54, v94
    v_mul_f32 v55, v55, v95
    v_mul_f32 v56, v56, v96
    v_mul_f32 v57, v57, v97
    v_mul_f32 v58, v58, v98
    v_mul_f32 v59, v59, v99
    v_cvt_pk_bf16_f32 v124, v52, v53
    v_cvt_pk_bf16_f32 v125, v54, v55
    v_cvt_pk_bf16_f32 v126, v56, v57
    v_cvt_pk_bf16_f32 v127, v58, v59
    ds_write_b64 v22, v[124:125] offset:4096
    ds_write_b64 v22, v[126:127] offset:4128
    ds_read_b128 v[124:127], v23 offset:4096
    s_waitcnt lgkmcnt(0)
    v_lshlrev_b32 v2, 16, v124
    v_and_b32 v3, s94, v124
    v_add_f32 v2, v2, v100
    v_add_f32 v3, v3, v101
    v_cvt_pk_bf16_f32 v124, v2, v3
    v_lshlrev_b32 v2, 16, v125
    v_and_b32 v3, s94, v125
    v_add_f32 v2, v2, v102
    v_add_f32 v3, v3, v103
    v_cvt_pk_bf16_f32 v125, v2, v3
    v_lshlrev_b32 v2, 16, v126
    v_and_b32 v3, s94, v126
    v_add_f32 v2, v2, v104
    v_add_f32 v3, v3, v105
    v_cvt_pk_bf16_f32 v126, v2, v3
    v_lshlrev_b32 v2, 16, v127
    v_and_b32 v3, s94, v127
    v_add_f32 v2, v2, v106
    v_add_f32 v3, v3, v107
    v_cvt_pk_bf16_f32 v127, v2, v3
    buffer_store_dwordx4 v[124:127], v15, s[72:75], s41 offen offset:1024
    s_branch TAILE
TAILE:
    s_endpgm
TEXT_end:
.section .rodata,"a"
.p2align 6
.amdhsa_kernel recurrent_scan__sliding_block_cached__dense_activation_relu__prompt_kernel
  .amdhsa_next_free_vgpr 512
  .amdhsa_next_free_sgpr 100
  .amdhsa_accum_offset 256
  .amdhsa_group_segment_fixed_size 0
  .amdhsa_kernarg_size 88
  .amdhsa_user_sgpr_count 2
  .amdhsa_user_sgpr_kernarg_segment_ptr 1
  .amdhsa_system_sgpr_workgroup_id_x 1
.end_amdhsa_kernel
```
